```python
import torch

def _softmax(x, axis=-1):
    return torch.softmax(x, dim=axis)
def _gelu(x):
    return torch.nn.functional.gelu(x, approximate="tanh")
def _silu(x):
    return torch.nn.functional.silu(x)
def _sigmoid(x):
    return torch.sigmoid(x)
def _layernorm(x, axis=-1, eps=1e-5):
    m = x.mean(dim=axis, keepdim=True)
    v = x.var(dim=axis, keepdim=True, unbiased=False)
    return (x - m) / torch.sqrt(v + eps)
def _scatter_add(tgt, idx, src, axis=0):
    return tgt.clone().index_add_(axis, idx, src)
def _segment_sum(src, seg, n):
    out = torch.zeros((n,) + src.shape[1:], dtype=src.dtype)
    return out.index_add_(0, seg, src)
def _pad(x, pw):
    flat = tuple(v for pair in reversed(pw) for v in pair)
    return torch.nn.functional.pad(x, flat)

kernel_name = 'sequential_preLN__grouped_kv_mqa__dense_activation_gelu__prompt'

def setup_inputs():

    _w = (lambda a: (lambda t: t.to(torch.bfloat16) if t.is_floating_point() else t)(torch.as_tensor(a)))
    def _A_setup():
        B, S, D, H = 1, 2048, 448, 16
        Dh = D // H
        return {
            "x": _w((lambda *s: torch.randn(*s, dtype=torch.bfloat16) * 0.05)(B, S, D)),
            "wq": _w((lambda *s: torch.randn(*s, dtype=torch.bfloat16) * 0.05)(D, H * Dh)),
            "wk": _w((lambda *s: torch.randn(*s, dtype=torch.bfloat16) * 0.05)(D, Dh)),
            "wv": _w((lambda *s: torch.randn(*s, dtype=torch.bfloat16) * 0.05)(D, Dh)),
            "wo": _w((lambda *s: torch.randn(*s, dtype=torch.bfloat16) * 0.05)(H * Dh, D)),
        }
    _A_in = _A_setup()

    def _B_setup():
        B, S, D, F = 1, 2048, 448, 1792
        return {
            "x": _w((lambda *s: torch.randn(*s, dtype=torch.bfloat16) * 0.05)(B, S, D)),
            "w1": _w((lambda *s: torch.randn(*s, dtype=torch.bfloat16) * 0.8)(D, F) * (D ** -0.5)),
            "b1": _w((lambda *s: torch.randn(*s, dtype=torch.bfloat16) * 12.8)(F) * 0.01),
            "w2": _w((lambda *s: torch.randn(*s, dtype=torch.bfloat16) * 0.4)(F, D) * (F ** -0.5)),
            "b2": _w((lambda *s: torch.randn(*s, dtype=torch.bfloat16) * 6.4)(D) * 0.01),
        }
    _B_in = _B_setup()

    return {
        "A_x": _A_in["x"],
        "A_wq": _A_in["wq"],
        "A_wk": _A_in["wk"],
        "A_wv": _A_in["wv"],
        "A_wo": _A_in["wo"],
        "B_x": _B_in["x"],
        "B_w1": _B_in["w1"],
        "B_b1": _B_in["b1"],
        "B_w2": _B_in["w2"],
        "B_b2": _B_in["b2"],
    }

def reference(A_x, A_wq, A_wk, A_wv, A_wo, B_x, B_w1, B_b1, B_w2, B_b2):
    def _A_ref(x, wq, wk, wv, wo):
        B, S, D = x.shape
        H = 16
        Dh = D // H
        q = (lambda x, *d: x.permute(*d))((x @ wq).reshape(B, S, H, Dh), 0, 2, 1, 3)
        k = x @ wk
        v = x @ wv
        scores = torch.einsum("bhqd,bkd->bhqk", q, k) * (Dh ** -0.5)
        p = _softmax(scores, axis=-1)
        o = torch.einsum("bhqk,bkd->bhqd", p, v)
        return (lambda x, *d: x.permute(*d))(o, 0, 2, 1, 3).reshape(B, S, H * Dh) @ wo

    def _B_ref(x, w1, b1, w2, b2):
        h = torch.einsum("bsd,df->bsf", x, w1) + b1
        h = _gelu(h)
        return torch.einsum("bsf,fd->bsd", h, w2) + b2

    x = A_x
    h = x + _A_ref(_layernorm(x, axis=-1), A_wq, A_wk, A_wv, A_wo)
    h2 = h + _B_ref(_layernorm(h, axis=-1), B_w1, B_b1, B_w2, B_b2)
    return h2
```

```asm
; @launch grid=(256,1,1) block=(256,1,1) lds=163840
.amdgcn_target "amdgcn-amd-amdhsa--gfx950"
.text
.globl sequential_preLN__grouped_kv_mqa__dense_activation_gelu__prompt_kernel
.p2align 8
.type sequential_preLN__grouped_kv_mqa__dense_activation_gelu__prompt_kernel,@function
sequential_preLN__grouped_kv_mqa__dense_activation_gelu__prompt_kernel:
    s_cmp_ge_u32 s2, 256
    s_cbranch_scc1 L_end
    s_load_dwordx16 s[16:31], s[0:1], 0
    s_load_dwordx8 s[32:39], s[0:1], 64
    s_load_dwordx2 s[40:41], s[0:1], 96
    s_getpc_b64 s[64:65]
L_pcref:
    v_lshrrev_b32 v7, 6, v0
    v_and_b32 v0, 63, v0
    s_lshr_b32 s3, s2, 3
    v_lshl_add_u32 v8, s3, 2, v7
    v_min_u32 v9, 2, v0
    v_mad_u32_u24 v8, v8, 3, v9
    v_lshlrev_b32 v8, 7, v8
    v_min_u32 v8, L_code_end-L_pcref-4, v8
    global_load_dword v232, v8, s[64:65]
    v_readfirstlane_b32 s4, v7
    v_lshlrev_b32 v1, 4, v0
    v_mov_b32 v2, 0
    s_and_b32 s5, s3, 7
    s_lshr_b32 s3, s3, 3
    s_and_b32 s6, s2, 7
    s_lshl2_add_u32 s6, s6, s3
    s_lshr_b32 s95, s5, 1
    s_and_b32 s96, s5, 1
    v_lshrrev_b32 v7, 3, v0
    v_and_b32 v8, 7, v0
    v_xor_b32 v9, v8, v7
    v_mul_u32_u24 v7, 896, v7
    v_lshl_add_u32 v20, v9, 4, v7
    s_lshr_b32 s68, s4, 1
    s_and_b32 s69, s4, 1
    s_lshl1_add_u32 s83, s95, s69
    s_waitcnt lgkmcnt(0)
    s_mov_b32 s8, s16
    s_and_b32 s9, s17, 0xffff
    s_mov_b32 s10, 0x1c0000
    s_mov_b32 s11, 0x20000
    s_mov_b32 s12, s40
    s_and_b32 s13, s41, 0xffff
    s_mov_b32 s14, 0x10000000
    s_mov_b32 s15, 0x20000
    s_cmp_lt_u32 s4, 2
    s_cbranch_scc1 L_p1_A
    s_mul_i32 m0, s83, 7296
    s_add_u32 m0, m0, 16384
    s_lshl3_add_u32 s70, s6, s83
    s_mul_i32 s70, s70, 7168
    buffer_load_dwordx4 v20, s[8:11], s70 offen lds
    s_addk_i32 m0, 896
    s_nop 0
    buffer_load_dwordx4 v20, s[8:11], s70 offen offset:128 lds
    s_addk_i32 m0, 896
    s_nop 0
    buffer_load_dwordx4 v20, s[8:11], s70 offen offset:256 lds
    s_addk_i32 m0, 896
    s_nop 0
    buffer_load_dwordx4 v20, s[8:11], s70 offen offset:384 lds
    s_addk_i32 m0, 896
    s_nop 0
    buffer_load_dwordx4 v20, s[8:11], s70 offen offset:512 lds
    s_addk_i32 m0, 896
    s_nop 0
    buffer_load_dwordx4 v20, s[8:11], s70 offen offset:640 lds
    s_addk_i32 m0, 896
    s_nop 0
    buffer_load_dwordx4 v20, s[8:11], s70 offen offset:768 lds
    s_branch L_p1_B
L_p1_A:
    s_mov_b32 s60, s38
    s_and_b32 s61, s39, 0xffff
    s_mov_b32 s62, 0x100
    s_mov_b32 s63, 0x20000
    s_or_b32 s70, s2, s4
    s_cmp_lg_u32 s70, 0
    s_cbranch_scc1 L_p1_nst
    s_memrealtime s[66:67]
    s_waitcnt lgkmcnt(0)
    s_or_b32 s66, s66, 1
    v_mov_b32 v27, s66
    s_mov_b64 exec, 1
    buffer_store_dword v27, v2, s[60:63], 0 offen sc1
    s_mov_b64 exec, -1
L_p1_nst:
    s_cmp_eq_u32 s96, 0
    s_cselect_b32 s48, s20, s22
    s_cselect_b32 s49, s21, s23
    s_and_b32 s49, s49, 0xffff
    s_movk_i32 s50, 25088
    s_mov_b32 s51, 0x20000
    s_lshr_b32 s72, s2, 4
    s_mul_i32 s71, s72, 86
    s_lshr_b32 s71, s71, 8
    s_mul_i32 s71, s71, 3
    s_sub_u32 s72, s72, s71
    s_lshl_b32 s72, s72, 12
    s_mul_i32 s73, s4, 12288
    s_add_u32 s70, s72, s73
    s_add_u32 m0, s70, 132096
    s_addk_i32 s72, 4096
    s_cmpk_eq_u32 s72, 12288
    s_cselect_b32 s72, 0, s72
    buffer_load_dwordx4 v1, s[48:51], s70 offen lds
    buffer_load_dwordx4 v1, s[48:51], s70 offen offset:1024 lds
    buffer_load_dwordx4 v1, s[48:51], s70 offen offset:2048 lds
    buffer_load_dwordx4 v1, s[48:51], s70 offen offset:3072 lds
    s_mov_b32 s64, s24
    s_and_b32 s65, s25, 0xffff
    s_mov_b32 s66, 0x62000
    s_mov_b32 s67, 0x20000
    s_lshr_b32 s74, s2, 4
    s_mul_i32 s74, s74, 28
    s_and_b32 s75, s2, 8
    s_lshl1_add_u32 s74, s75, s74
    s_and_b32 s75, s2, 4
    s_add_u32 s74, s74, s75
    s_and_b32 s75, s2, 2
    s_lshl2_add_u32 s74, s75, s74
    s_and_b32 s75, s2, 1
    s_lshl1_add_u32 s74, s75, s74
    s_add_u32 s74, s74, s4
    s_mul_i32 s74, s74, 896
    v_cmp_gt_u32 vcc, 56, v0
    v_mov_b32 v7, 0x7f000000
    s_nop 0
    v_cndmask_b32 v7, v7, v1, vcc
    buffer_load_dwordx4 v[236:239], v7, s[64:67], s74 offen
    s_add_u32 s70, s72, s73
    s_add_u32 m0, s70, 132096
    s_addk_i32 s72, 4096
    s_cmpk_eq_u32 s72, 12288
    s_cselect_b32 s72, 0, s72
    buffer_load_dwordx4 v1, s[48:51], s70 offen lds
    buffer_load_dwordx4 v1, s[48:51], s70 offen offset:1024 lds
    buffer_load_dwordx4 v1, s[48:51], s70 offen offset:2048 lds
    buffer_load_dwordx4 v1, s[48:51], s70 offen offset:3072 lds
    s_add_u32 s70, s72, s73
    s_add_u32 m0, s70, 132096
    s_nop 0
    buffer_load_dwordx4 v1, s[48:51], s70 offen lds
    buffer_load_dwordx4 v1, s[48:51], s70 offen offset:1024 lds
    buffer_load_dwordx4 v1, s[48:51], s70 offen offset:2048 lds
    buffer_load_dwordx4 v1, s[48:51], s70 offen offset:3072 lds
    s_add_u32 s70, s73, 12288
    s_add_u32 m0, s70, 132096
    s_nop 0
    buffer_load_dwordx4 v1, s[48:51], s70 offen lds
    s_mov_b32 s44, s18
    s_and_b32 s45, s19, 0xffff
    s_mov_b32 s46, 0x62000
    s_mov_b32 s47, 0x20000
    s_lshr_b32 s71, s2, 3
    s_lshl1_add_u32 s71, s71, s4
    s_mul_i32 s71, s71, 6272
    v_min_u32 v7, 48, v0
    v_lshlrev_b32 v7, 7, v7
    buffer_load_dword v233, v7, s[44:47], s71 offen
    v_and_b32 v7, 15, v0
    v_lshrrev_b32 v8, 4, v0
    v_and_b32 v9, 7, v0
    v_xor_b32 v22, v8, v9
    v_lshlrev_b32 v22, 4, v22
    v_lshl_add_u32 v22, v9, 7, v22
    v_lshrrev_b32 v9, 3, v7
    s_lshl_b32 s71, s95, 1
    v_add_u32 v9, s71, v9
    v_mul_u32_u24 v9, 7296, v9
    v_add_u32 v22, v22, v9
    v_add_u32 v22, 16384, v22
    v_xor_b32 v23, 64, v22
    v_lshrrev_b32 v9, 2, v7
    v_lshl_add_u32 v9, v8, 3, v9
    v_mul_u32_u24 v9, 56, v9
    v_and_b32 v24, 3, v0
    v_lshl_add_u32 v9, v24, 3, v9
    s_lshl_b32 s71, s4, 5
    s_add_u32 s71, s71, 132096
    v_add_u32 v24, s71, v9
    v_lshlrev_b32 v9, 3, v7
    v_lshlrev_b32 v25, 5, v8
    s_cmp_eq_u32 s96, 0
    s_cselect_b64 vcc, -1, 0
    v_cndmask_b32 v25, v25, v9, vcc
    s_lshl_b32 s71, s95, 7
    s_add_u32 s71, s71, 256
    v_add_u32 v25, s71, v25
    v_bfe_u32 v9, v0, 4, 1
    v_lshl_add_u32 v7, v9, 5, v7
    v_lshlrev_b32 v7, 4, v7
    v_lshrrev_b32 v8, 5, v0
    v_lshl_add_u32 v26, v8, 3, v7
    s_and_b32 s71, s95, 1
    s_cmp_eq_u32 s96, 0
    s_cselect_b32 s72, s4, s71
    s_cselect_b32 s73, s71, s4
    s_lshl_b32 s72, s72, 10
    s_lshl_b32 s73, s73, 8
    s_add_u32 s72, s72, s73
    s_lshl_b32 s73, s96, 11
    s_add_u32 s72, s72, s73
    s_lshr_b32 s73, s95, 1
    s_lshl1_add_u32 s71, s6, s73
    s_and_b32 s73, s71, 0x30
    s_add_u32 s71, s71, s73
    s_lshl_b32 s71, s71, 12
    s_add_u32 s72, s72, s71
    s_add_u32 s101, s72, 131072
    s_add_u32 s71, s83, 2
    s_and_b32 s71, s71, 7
    s_mul_i32 s70, s71, 7296
    s_add_u32 s70, s70, 16384
    v_add_u32 v168, s70, v1
    s_lshl_b32 s70, s71, 6
    s_add_u32 s70, s70, 256
    v_and_b32 v171, 0x38, v0
    v_add_u32 v171, s70, v171
    s_add_u32 s71, s83, 4
    s_and_b32 s71, s71, 7
    s_mul_i32 s70, s71, 7296
    s_add_u32 s70, s70, 16384
    v_add_u32 v169, s70, v1
    s_lshl_b32 s70, s71, 6
    s_add_u32 s70, s70, 256
    v_and_b32 v172, 0x38, v0
    v_add_u32 v172, s70, v172
    v_and_b32 v7, 7, v0
    v_lshrrev_b32 v8, 5, v0
    v_xor_b32 v9, v7, v8
    s_lshl_b32 s70, s68, 2
    v_xor_b32 v9, s70, v9
    v_lshlrev_b32 v9, 4, v9
    v_lshl_add_u32 v9, v7, 7, v9
    v_bfe_u32 v7, v0, 3, 2
    v_add_u32 v7, s70, v7
    v_mul_u32_u24 v7, 7296, v7
    v_add_u32 v152, v7, v9
    v_xor_b32 v153, 32, v152
    v_xor_b32 v154, 64, v152
    v_xor_b32 v155, 96, v152
    v_bfe_u32 v7, v0, 2, 2
    v_lshl_add_u32 v8, v8, 3, v7
    v_lshlrev_b32 v8, 7, v8
    v_lshrrev_b32 v7, 1, v7
    v_lshlrev_b32 v7, 6, v7
    v_and_b32 v9, 3, v0
    v_lshl_add_u32 v7, v9, 3, v7
    v_bfe_u32 v9, v0, 4, 1
    v_lshl_add_u32 v7, v9, 5, v7
    s_mul_i32 s70, s69, 56
    v_add_u32 v7, s70, v7
    v_and_b32 v7, 127, v7
    v_add_u32 v7, v7, v8
    s_lshl_b32 s70, s68, 12
    s_add_u32 s71, s70, 74752
    v_add_u32 v156, s71, v7
    s_sub_u32 s71, 78848, s70
    v_add_u32 v157, s71, v7
    s_lshl_b32 s70, s5, 7
    s_lshl_b32 s71, s69, 6
    s_add_u32 s70, s70, s71
    s_lshl_b32 s71, s68, 5
    s_add_u32 s97, s70, s71
    v_lshrrev_b32 v8, 5, v0
    v_lshlrev_b32 v8, 3, v8
    v_and_b32 v7, 7, v0
    v_lshl_add_u32 v8, v7, 7, v8
    v_bfe_u32 v9, v0, 3, 2
    v_mul_u32_u24 v9, 7296, v9
    v_add_u32 v8, v8, v9
    s_lshr_b32 s70, s97, 4
    s_and_b32 s71, s70, 7
    s_lshr_b32 s70, s70, 3
    s_lshl_b32 s70, s70, 10
    v_xor_b32 v9, s71, v7
    v_lshl_add_u32 v9, v9, 4, v8
    v_add_u32 v158, s70, v9
    s_lshr_b32 s70, s97, 4
    s_add_u32 s70, s70, 1
    s_and_b32 s71, s70, 7
    s_lshr_b32 s70, s70, 3
    s_lshl_b32 s70, s70, 10
    v_xor_b32 v9, s71, v7
    v_lshl_add_u32 v9, v9, 4, v8
    v_add_u32 v159, s70, v9
    v_and_b32 v7, 31, v0
    s_lshl_b32 s70, s68, 8
    s_add_u32 s70, s70, 256
    v_lshl_add_u32 v162, v7, 3, s70
    s_lshl_b32 s70, s4, 11
    v_add_u32 v163, s70, v1
    v_lshlrev_b32 v164, 7, v0
    v_lshlrev_b32 v165, 2, v0
    s_lshl_b32 s70, s4, 8
    v_add_u32 v166, s70, v165
    v_xor_b32 v161, 0x200, v166
    v_mov_b32 v140, 0x3f803f80
    v_mov_b32 v141, 0x3f803f80
    v_mov_b32 v142, 0x3f803f80
    v_mov_b32 v143, 0x3f803f80
    s_mov_b32 s98, 0
    s_mov_b32 s99, -1
    s_lshl_b32 s70, s68, 8
    v_xor_b32 v195, s70, v1
    s_lshl_b32 s84, s4, 17
    s_lshl_b32 s70, s2, 9
    s_and_b32 s70, s70, 0
    s_add_u32 s84, s84, s70
    s_add_u32 s84, s84, 131072
    s_and_b32 s40, s2, 63
    s_lshl_b32 s40, s40, 7
    s_lshr_b32 s70, s2, 6
    s_lshl3_add_u32 s40, s70, s40
    v_mov_b32 v28, 0
    v_mov_b32 v29, 0
    v_mov_b32 v30, 0
    v_mov_b32 v31, 0
    ds_write_b128 v2, v[28:31] offset:0
    ds_write_b128 v2, v[28:31] offset:16
    s_mov_b32 s94, 0
    buffer_load_dword v27, v2, s[60:63], 0 offen sc1
    s_waitcnt vmcnt(11)
    v_dot2_f32_bf16 v240, v236, v140, 0
    v_dot2_f32_bf16 v240, v237, v140, v240
    v_dot2_f32_bf16 v240, v238, v140, v240
    v_dot2_f32_bf16 v240, v239, v140, v240
    s_nop 2
    v_add_f32_dpp v240, v240, v240 row_ror:1 row_mask:0xf bank_mask:0xf
    s_nop 1
    v_add_f32_dpp v240, v240, v240 row_ror:2 row_mask:0xf bank_mask:0xf
    s_nop 1
    v_add_f32_dpp v240, v240, v240 row_ror:4 row_mask:0xf bank_mask:0xf
    s_nop 1
    v_add_f32_dpp v240, v240, v240 row_ror:8 row_mask:0xf bank_mask:0xf
    s_nop 0
    v_readlane_b32 s70, v240, 16
    v_readlane_b32 s71, v240, 32
    v_readlane_b32 s72, v240, 48
    v_add_f32 v240, s70, v240
    v_add_f32 v240, s71, v240
    v_add_f32 v240, s72, v240
    v_mul_f32 v240, 0x3b124925, v240
    v_cvt_pk_bf16_f32 v240, v240, v240
    s_and_b32 s70, s2, 3
    s_lshl1_add_u32 s70, s70, s4
    s_lshr_b32 s71, s2, 2
    s_lshl_b32 s71, s71, 7
    s_lshl1_add_u32 s70, s70, s71
    s_add_u32 s70, s70, 32768
    s_mov_b64 exec, 1
    buffer_store_short v240, v2, s[12:15], s70 offen sc1
    s_mov_b64 exec, -1
    s_waitcnt vmcnt(3)
    s_waitcnt lgkmcnt(0)
    s_barrier
    ds_read_b128 v[28:31], v22 offset:0
    ds_read_b64_tr_b16 v[84:85], v24 offset:0
    ds_read_b64_tr_b16 v[86:87], v24 offset:224
    ds_read_b128 v[32:35], v23 offset:0
    ds_read_b64_tr_b16 v[88:89], v24 offset:1792
    ds_read_b64_tr_b16 v[90:91], v24 offset:2016
    ds_read_b128 v[36:39], v22 offset:1024
    ds_read_b64_tr_b16 v[92:93], v24 offset:3584
    ds_read_b64_tr_b16 v[94:95], v24 offset:3808
    ds_read_b128 v[40:43], v23 offset:1024
    ds_read_b64_tr_b16 v[96:97], v24 offset:5376
    ds_read_b64_tr_b16 v[98:99], v24 offset:5600
    ds_read_b128 v[44:47], v22 offset:2048
    ds_read_b64_tr_b16 v[100:101], v24 offset:7168
    ds_read_b64_tr_b16 v[102:103], v24 offset:7392
    s_cmp_lg_u32 s96, 0
    s_cbranch_scc1 L_p1_vk
    ds_read_b128 v[48:51], v23 offset:2048
    ds_read_b64_tr_b16 v[104:105], v24 offset:8960
    ds_read_b64_tr_b16 v[106:107], v24 offset:9184
    s_waitcnt lgkmcnt(15)
    v_mfma_f32_16x16x32_bf16 v[144:147], v[84:87], v[28:31], 0
    v_mfma_f32_16x16x32_bf16 v[148:151], v[84:87], v[140:143], 0
    ds_read_b128 v[52:55], v22 offset:3072
    ds_read_b64_tr_b16 v[108:109], v24 offset:10752
    ds_read_b64_tr_b16 v[110:111], v24 offset:10976
    s_waitcnt lgkmcnt(15)
    v_mfma_f32_16x16x32_bf16 v[144:147], v[88:91], v[32:35], v[144:147]
    v_mfma_f32_16x16x32_bf16 v[148:151], v[88:91], v[140:143], v[148:151]
    ds_read_b128 v[56:59], v23 offset:3072
    ds_read_b64_tr_b16 v[112:113], v24 offset:12544
    ds_read_b64_tr_b16 v[114:115], v24 offset:12768
    s_waitcnt lgkmcnt(15)
    v_mfma_f32_16x16x32_bf16 v[144:147], v[92:95], v[36:39], v[144:147]
    v_mfma_f32_16x16x32_bf16 v[148:151], v[92:95], v[140:143], v[148:151]
    ds_read_b128 v[60:63], v22 offset:4096
    ds_read_b64_tr_b16 v[116:117], v24 offset:14336
    ds_read_b64_tr_b16 v[118:119], v24 offset:14560
    s_waitcnt lgkmcnt(15)
    v_mfma_f32_16x16x32_bf16 v[144:147], v[96:99], v[40:43], v[144:147]
    v_mfma_f32_16x16x32_bf16 v[148:151], v[96:99], v[140:143], v[148:151]
    ds_read_b128 v[64:67], v23 offset:4096
    ds_read_b64_tr_b16 v[120:121], v24 offset:16128
    ds_read_b64_tr_b16 v[122:123], v24 offset:16352
    s_waitcnt lgkmcnt(15)
    v_mfma_f32_16x16x32_bf16 v[144:147], v[100:103], v[44:47], v[144:147]
    v_mfma_f32_16x16x32_bf16 v[148:151], v[100:103], v[140:143], v[148:151]
    ds_read_b128 v[68:71], v22 offset:5120
    ds_read_b64_tr_b16 v[124:125], v24 offset:17920
    ds_read_b64_tr_b16 v[126:127], v24 offset:18144
    s_waitcnt lgkmcnt(15)
    v_mfma_f32_16x16x32_bf16 v[144:147], v[104:107], v[48:51], v[144:147]
    v_mfma_f32_16x16x32_bf16 v[148:151], v[104:107], v[140:143], v[148:151]
    ds_read_b128 v[72:75], v23 offset:5120
    ds_read_b64_tr_b16 v[128:129], v24 offset:19712
    ds_read_b64_tr_b16 v[130:131], v24 offset:19936
    s_waitcnt lgkmcnt(15)
    v_mfma_f32_16x16x32_bf16 v[144:147], v[108:111], v[52:55], v[144:147]
    v_mfma_f32_16x16x32_bf16 v[148:151], v[108:111], v[140:143], v[148:151]
    ds_read_b128 v[76:79], v22 offset:6144
    ds_read_b64_tr_b16 v[132:133], v24 offset:21504
    ds_read_b64_tr_b16 v[134:135], v24 offset:21728
    s_waitcnt lgkmcnt(15)
    v_mfma_f32_16x16x32_bf16 v[144:147], v[112:115], v[56:59], v[144:147]
    v_mfma_f32_16x16x32_bf16 v[148:151], v[112:115], v[140:143], v[148:151]
    ds_read_b128 v[80:83], v23 offset:6144
    ds_read_b64_tr_b16 v[136:137], v24 offset:23296
    ds_read_b64_tr_b16 v[138:139], v24 offset:23520
    s_waitcnt lgkmcnt(15)
    v_mfma_f32_16x16x32_bf16 v[144:147], v[116:119], v[60:63], v[144:147]
    v_mfma_f32_16x16x32_bf16 v[148:151], v[116:119], v[140:143], v[148:151]
    s_waitcnt lgkmcnt(12)
    v_mfma_f32_16x16x32_bf16 v[144:147], v[120:123], v[64:67], v[144:147]
    v_mfma_f32_16x16x32_bf16 v[148:151], v[120:123], v[140:143], v[148:151]
    s_waitcnt lgkmcnt(9)
    v_mfma_f32_16x16x32_bf16 v[144:147], v[124:127], v[68:71], v[144:147]
    v_mfma_f32_16x16x32_bf16 v[148:151], v[124:127], v[140:143], v[148:151]
    s_waitcnt lgkmcnt(6)
    v_mfma_f32_16x16x32_bf16 v[144:147], v[128:131], v[72:75], v[144:147]
    v_mfma_f32_16x16x32_bf16 v[148:151], v[128:131], v[140:143], v[148:151]
    s_waitcnt lgkmcnt(3)
    v_mfma_f32_16x16x32_bf16 v[144:147], v[132:135], v[76:79], v[144:147]
    v_mfma_f32_16x16x32_bf16 v[148:151], v[132:135], v[140:143], v[148:151]
    s_waitcnt lgkmcnt(0)
    v_mfma_f32_16x16x32_bf16 v[144:147], v[136:139], v[80:83], v[144:147]
    v_mfma_f32_16x16x32_bf16 v[148:151], v[136:139], v[140:143], v[148:151]
    s_lshl_b32 s71, s4, 16
    s_mul_i32 s71, s71, 0xffff
    s_mov_b32 vcc_lo, 0
    s_mov_b32 vcc_hi, s71
    s_barrier
    ds_read_b64 v[28:29], v25
    s_waitcnt lgkmcnt(0)
    s_nop 0
    v_fma_f32 v144, -v28, v148, v144
    v_fma_f32 v145, -v28, v149, v145
    v_fma_f32 v146, -v28, v150, v146
    v_fma_f32 v147, -v28, v151, v147
    v_mul_f32 v144, v29, v144
    v_mul_f32 v145, v29, v145
    v_mul_f32 v146, v29, v146
    v_mul_f32 v147, v29, v147
    v_cndmask_b32 v144, v144, v2, vcc
    v_cndmask_b32 v145, v145, v2, vcc
    v_cndmask_b32 v146, v146, v2, vcc
    v_cndmask_b32 v147, v147, v2, vcc
    v_cvt_pk_bf16_f32 v148, v144, v145
    v_cvt_pk_bf16_f32 v149, v146, v147
    buffer_store_dwordx2 v[148:149], v26, s[12:15], s101 offen sc1
    v_max3_f32 v150, abs(v144), abs(v145), abs(v146)
    v_max_f32 v150, v150, abs(v147)
    s_branch L_p1_kvst
L_p1_vk:
    ds_read_b128 v[48:51], v23 offset:2048
    ds_read_b64_tr_b16 v[104:105], v24 offset:8960
    ds_read_b64_tr_b16 v[106:107], v24 offset:9184
    s_waitcnt lgkmcnt(15)
    v_mfma_f32_16x16x32_bf16 v[144:147], v[28:31], v[84:87], 0
    v_mfma_f32_16x16x32_bf16 v[148:151], v[140:143], v[84:87], 0
    ds_read_b128 v[52:55], v22 offset:3072
    ds_read_b64_tr_b16 v[108:109], v24 offset:10752
    ds_read_b64_tr_b16 v[110:111], v24 offset:10976
    s_waitcnt lgkmcnt(15)
    v_mfma_f32_16x16x32_bf16 v[144:147], v[32:35], v[88:91], v[144:147]
    v_mfma_f32_16x16x32_bf16 v[148:151], v[140:143], v[88:91], v[148:151]
    ds_read_b128 v[56:59], v23 offset:3072
    ds_read_b64_tr_b16 v[112:113], v24 offset:12544
    ds_read_b64_tr_b16 v[114:115], v24 offset:12768
    s_waitcnt lgkmcnt(15)
    v_mfma_f32_16x16x32_bf16 v[144:147], v[36:39], v[92:95], v[144:147]
    v_mfma_f32_16x16x32_bf16 v[148:151], v[140:143], v[92:95], v[148:151]
    ds_read_b128 v[60:63], v22 offset:4096
    ds_read_b64_tr_b16 v[116:117], v24 offset:14336
    ds_read_b64_tr_b16 v[118:119], v24 offset:14560
    s_waitcnt lgkmcnt(15)
    v_mfma_f32_16x16x32_bf16 v[144:147], v[40:43], v[96:99], v[144:147]
    v_mfma_f32_16x16x32_bf16 v[148:151], v[140:143], v[96:99], v[148:151]
    ds_read_b128 v[64:67], v23 offset:4096
    ds_read_b64_tr_b16 v[120:121], v24 offset:16128
    ds_read_b64_tr_b16 v[122:123], v24 offset:16352
    s_waitcnt lgkmcnt(15)
    v_mfma_f32_16x16x32_bf16 v[144:147], v[44:47], v[100:103], v[144:147]
    v_mfma_f32_16x16x32_bf16 v[148:151], v[140:143], v[100:103], v[148:151]
    ds_read_b128 v[68:71], v22 offset:5120
    ds_read_b64_tr_b16 v[124:125], v24 offset:17920
    ds_read_b64_tr_b16 v[126:127], v24 offset:18144
    s_waitcnt lgkmcnt(15)
    v_mfma_f32_16x16x32_bf16 v[144:147], v[48:51], v[104:107], v[144:147]
    v_mfma_f32_16x16x32_bf16 v[148:151], v[140:143], v[104:107], v[148:151]
    ds_read_b128 v[72:75], v23 offset:5120
    ds_read_b64_tr_b16 v[128:129], v24 offset:19712
    ds_read_b64_tr_b16 v[130:131], v24 offset:19936
    s_waitcnt lgkmcnt(15)
    v_mfma_f32_16x16x32_bf16 v[144:147], v[52:55], v[108:111], v[144:147]
    v_mfma_f32_16x16x32_bf16 v[148:151], v[140:143], v[108:111], v[148:151]
    ds_read_b128 v[76:79], v22 offset:6144
    ds_read_b64_tr_b16 v[132:133], v24 offset:21504
    ds_read_b64_tr_b16 v[134:135], v24 offset:21728
    s_waitcnt lgkmcnt(15)
    v_mfma_f32_16x16x32_bf16 v[144:147], v[56:59], v[112:115], v[144:147]
    v_mfma_f32_16x16x32_bf16 v[148:151], v[140:143], v[112:115], v[148:151]
    ds_read_b128 v[80:83], v23 offset:6144
    ds_read_b64_tr_b16 v[136:137], v24 offset:23296
    ds_read_b64_tr_b16 v[138:139], v24 offset:23520
    s_waitcnt lgkmcnt(15)
    v_mfma_f32_16x16x32_bf16 v[144:147], v[60:63], v[116:119], v[144:147]
    v_mfma_f32_16x16x32_bf16 v[148:151], v[140:143], v[116:119], v[148:151]
    s_waitcnt lgkmcnt(12)
    v_mfma_f32_16x16x32_bf16 v[144:147], v[64:67], v[120:123], v[144:147]
    v_mfma_f32_16x16x32_bf16 v[148:151], v[140:143], v[120:123], v[148:151]
    s_waitcnt lgkmcnt(9)
    v_mfma_f32_16x16x32_bf16 v[144:147], v[68:71], v[124:127], v[144:147]
    v_mfma_f32_16x16x32_bf16 v[148:151], v[140:143], v[124:127], v[148:151]
    s_waitcnt lgkmcnt(6)
    v_mfma_f32_16x16x32_bf16 v[144:147], v[72:75], v[128:131], v[144:147]
    v_mfma_f32_16x16x32_bf16 v[148:151], v[140:143], v[128:131], v[148:151]
    s_waitcnt lgkmcnt(3)
    v_mfma_f32_16x16x32_bf16 v[144:147], v[76:79], v[132:135], v[144:147]
    v_mfma_f32_16x16x32_bf16 v[148:151], v[140:143], v[132:135], v[148:151]
    s_waitcnt lgkmcnt(0)
    v_mfma_f32_16x16x32_bf16 v[144:147], v[80:83], v[136:139], v[144:147]
    v_mfma_f32_16x16x32_bf16 v[148:151], v[140:143], v[136:139], v[148:151]
    v_and_b32 v7, 15, v0
    s_lshl_b32 s71, s4, 4
    v_add_u32 v7, s71, v7
    v_cmp_lt_u32 vcc, 27, v7
    v_cmp_eq_u32 s[72:73], 28, v7
    s_barrier
    ds_read_b128 v[32:35], v25
    ds_read_b128 v[36:39], v25 offset:16
    s_waitcnt lgkmcnt(1)
    v_fma_f32 v144, -v32, v148, v144
    v_fma_f32 v145, -v34, v149, v145
    s_waitcnt lgkmcnt(0)
    v_fma_f32 v146, -v36, v150, v146
    v_fma_f32 v147, -v38, v151, v147
    v_mul_f32 v144, v33, v144
    v_mul_f32 v145, v35, v145
    v_mul_f32 v146, v37, v146
    v_mul_f32 v147, v39, v147
    v_cvt_pk_bf16_f32 v148, v144, v145
    v_cvt_pk_bf16_f32 v149, v146, v147
    v_cndmask_b32 v148, v148, v2, vcc
    v_cndmask_b32 v149, v149, v2, vcc
    v_cndmask_b32 v148, v148, v140, s[72:73]
    v_cndmask_b32 v149, v149, v140, s[72:73]
    buffer_store_dwordx2 v[148:149], v26, s[12:15], s101 offen sc1
    v_max3_f32 v150, abs(v144), abs(v145), abs(v146)
    v_max_f32 v150, v150, abs(v147)
    v_cmp_ngt_f32 vcc, 0x49800000, v150
    v_mov_b32 v150, 0x7f800000
    s_nop 0
    v_cndmask_b32 v150, v2, v150, vcc
L_p1_kvst:
    s_nop 1
    v_max_u32_dpp v150, v150, v150 row_ror:1 row_mask:0xf bank_mask:0xf
    s_nop 1
    v_max_u32_dpp v150, v150, v150 row_ror:2 row_mask:0xf bank_mask:0xf
    s_nop 1
    v_max_u32_dpp v150, v150, v150 row_ror:4 row_mask:0xf bank_mask:0xf
    s_nop 1
    v_max_u32_dpp v150, v150, v150 row_ror:8 row_mask:0xf bank_mask:0xf
    s_nop 0
    v_readlane_b32 s72, v150, 0
    v_readlane_b32 s73, v150, 16
    s_nop 0
    s_max_u32 s72, s72, s73
    v_readlane_b32 s73, v150, 32
    s_nop 0
    s_max_u32 s72, s72, s73
    v_readlane_b32 s73, v150, 48
    s_nop 0
    s_max_u32 s72, s72, s73
    v_mov_b32 v150, s72
    ds_max_u32 v2, v150 offset:16
L_p1_nchk:
    s_waitcnt vmcnt(2)
    v_readfirstlane_b32 s7, v27
    s_nop 0
    s_cmp_lg_u32 s7, 0
    s_cbranch_scc1 L_p1_ngot
    s_add_u32 s94, s94, 1
    s_cmp_gt_u32 s94, 131072
    s_cbranch_scc1 L_p1_ngot
    buffer_load_dword v27, v2, s[60:63], 0 offen sc1
    s_waitcnt vmcnt(0)
    s_branch L_p1_nchk
L_p1_ngot:
    ds_write_b32 v2, v27 offset:0
    s_lshl_b32 s70, s6, 16
    s_add_u32 s71, s70, 1048576
    s_lshl1_add_u32 s72, s69, s68
    s_lshl2_add_u32 s72, s5, s72
    s_lshl_b32 s85, s72, 10
    s_add_u32 s85, s85, s71
    s_lshl_b32 s86, s4, 13
    s_add_u32 s86, s86, s71
    s_add_u32 s71, s70, 3145728
    s_lshl1_add_u32 s72, s69, s68
    s_lshl2_add_u32 s72, s5, s72
    s_lshl_b32 s72, s72, 10
    s_add_u32 s87, s72, s71
    s_mul_i32 s72, s4, 7168
    s_add_u32 s88, s72, s71
    s_mul_i32 s71, s6, 229376
    s_add_u32 s71, s71, 5242880
    s_lshl2_add_u32 s72, s5, s4
    s_lshl_b32 s72, s72, 12
    s_add_u32 s89, s72, s71
    s_mul_i32 s90, s4, 28672
    s_add_u32 s90, s90, s71
    s_lshl_b32 s71, s5, 7
    s_mul_i32 s91, s4, 100352
    s_add_u32 s91, s91, s71
    s_mul_i32 s93, s4, 401408
    s_add_u32 s93, s93, s71
    s_lshl2_add_u32 s92, s5, s4
    s_lshl_b32 s92, s92, 7
    s_mul_i32 s100, s4, 36864
    s_add_u32 s100, s100, 16384
    v_bfe_u32 v7, v0, 2, 2
    v_lshrrev_b32 v8, 5, v0
    v_lshl_add_u32 v8, v8, 2, v7
    v_lshl_add_u32 v8, v8, 7, s100
    v_lshrrev_b32 v7, 1, v7
    v_lshl_add_u32 v8, v7, 6, v8
    v_and_b32 v7, 3, v0
    v_lshl_add_u32 v8, v7, 3, v8
    v_bfe_u32 v7, v0, 4, 1
    v_lshl_add_u32 v5, v7, 5, v8
    v_xor_b32 v250, 64, v5
    s_lshl1_add_u32 s72, s69, s68
    s_lshl_b32 s72, s72, 5
    v_xor_b32 v18, s72, v5
    v_xor_b32 v19, 64, v18
    v_mov_b32 v244, -1
    v_mov_b32 v245, -1
    v_mov_b32 v246, -1
    v_mov_b32 v247, -1
    s_waitcnt vmcnt(0)
    v_mov_b32 v150, 1
    s_mov_b64 exec, 1
    ds_add_rtn_u32 v150, v2, v150 offset:4
    s_mov_b64 exec, -1
    ds_read_b32 v149, v2 offset:16
    v_mov_b32 v148, s7
    s_waitcnt lgkmcnt(1)
    v_readfirstlane_b32 s70, v150
    s_nop 0
    s_cmp_lg_u32 s70, 1
    s_cbranch_scc1 L_p1_nofl
    s_mov_b64 exec, 1
    s_waitcnt lgkmcnt(0)
    buffer_store_dwordx2 v[148:149], v2, s[12:15], s40 offen sc1
    s_mov_b64 exec, -1
L_p1_nofl:
    ds_read_b128 v[28:31], v168 offset:0
    ds_read_b128 v[32:35], v168 offset:1024
    ds_read_b128 v[36:39], v168 offset:2048
    ds_read_b128 v[40:43], v168 offset:3072
    ds_read_b128 v[44:47], v168 offset:4096
    ds_read_b128 v[48:51], v168 offset:5120
    ds_read_b128 v[52:55], v168 offset:6144
    ds_read_b128 v[64:67], v169 offset:0
    ds_read_b128 v[68:71], v169 offset:1024
    ds_read_b128 v[72:75], v169 offset:2048
    ds_read_b128 v[76:79], v169 offset:3072
    ds_read_b128 v[80:83], v169 offset:4096
    ds_read_b128 v[84:87], v169 offset:5120
    ds_read_b128 v[88:91], v169 offset:6144
    s_waitcnt lgkmcnt(13)
    v_dot2_f32_bf16 v56, v28, v140, 0
    v_dot2_f32_bf16 v58, v28, v28, 0
    v_dot2_f32_bf16 v57, v29, v140, 0
    v_dot2_f32_bf16 v59, v29, v29, 0
    v_dot2_f32_bf16 v56, v30, v140, v56
    v_dot2_f32_bf16 v58, v30, v30, v58
    v_dot2_f32_bf16 v57, v31, v140, v57
    v_dot2_f32_bf16 v59, v31, v31, v59
    s_waitcnt lgkmcnt(12)
    v_dot2_f32_bf16 v56, v32, v140, v56
    v_dot2_f32_bf16 v58, v32, v32, v58
    v_dot2_f32_bf16 v57, v33, v140, v57
    v_dot2_f32_bf16 v59, v33, v33, v59
    v_dot2_f32_bf16 v56, v34, v140, v56
    v_dot2_f32_bf16 v58, v34, v34, v58
    v_dot2_f32_bf16 v57, v35, v140, v57
    v_dot2_f32_bf16 v59, v35, v35, v59
    s_waitcnt lgkmcnt(11)
    v_dot2_f32_bf16 v56, v36, v140, v56
    v_dot2_f32_bf16 v58, v36, v36, v58
    v_dot2_f32_bf16 v57, v37, v140, v57
    v_dot2_f32_bf16 v59, v37, v37, v59
    v_dot2_f32_bf16 v56, v38, v140, v56
    v_dot2_f32_bf16 v58, v38, v38, v58
    v_dot2_f32_bf16 v57, v39, v140, v57
    v_dot2_f32_bf16 v59, v39, v39, v59
    s_waitcnt lgkmcnt(10)
    v_dot2_f32_bf16 v56, v40, v140, v56
    v_dot2_f32_bf16 v58, v40, v40, v58
    v_dot2_f32_bf16 v57, v41, v140, v57
    v_dot2_f32_bf16 v59, v41, v41, v59
    v_dot2_f32_bf16 v56, v42, v140, v56
    v_dot2_f32_bf16 v58, v42, v42, v58
    v_dot2_f32_bf16 v57, v43, v140, v57
    v_dot2_f32_bf16 v59, v43, v43, v59
    s_waitcnt lgkmcnt(9)
    v_dot2_f32_bf16 v56, v44, v140, v56
    v_dot2_f32_bf16 v58, v44, v44, v58
    v_dot2_f32_bf16 v57, v45, v140, v57
    v_dot2_f32_bf16 v59, v45, v45, v59
    v_dot2_f32_bf16 v56, v46, v140, v56
    v_dot2_f32_bf16 v58, v46, v46, v58
    v_dot2_f32_bf16 v57, v47, v140, v57
    v_dot2_f32_bf16 v59, v47, v47, v59
    s_waitcnt lgkmcnt(8)
    v_dot2_f32_bf16 v56, v48, v140, v56
    v_dot2_f32_bf16 v58, v48, v48, v58
    v_dot2_f32_bf16 v57, v49, v140, v57
    v_dot2_f32_bf16 v59, v49, v49, v59
    v_dot2_f32_bf16 v56, v50, v140, v56
    v_dot2_f32_bf16 v58, v50, v50, v58
    v_dot2_f32_bf16 v57, v51, v140, v57
    v_dot2_f32_bf16 v59, v51, v51, v59
    s_waitcnt lgkmcnt(7)
    v_dot2_f32_bf16 v56, v52, v140, v56
    v_dot2_f32_bf16 v58, v52, v52, v58
    v_dot2_f32_bf16 v57, v53, v140, v57
    v_dot2_f32_bf16 v59, v53, v53, v59
    v_dot2_f32_bf16 v56, v54, v140, v56
    v_dot2_f32_bf16 v58, v54, v54, v58
    v_dot2_f32_bf16 v57, v55, v140, v57
    v_dot2_f32_bf16 v59, v55, v55, v59
    s_waitcnt lgkmcnt(6)
    v_dot2_f32_bf16 v92, v64, v140, 0
    v_dot2_f32_bf16 v94, v64, v64, 0
    v_dot2_f32_bf16 v93, v65, v140, 0
    v_dot2_f32_bf16 v95, v65, v65, 0
    v_dot2_f32_bf16 v92, v66, v140, v92
    v_dot2_f32_bf16 v94, v66, v66, v94
    v_dot2_f32_bf16 v93, v67, v140, v93
    v_dot2_f32_bf16 v95, v67, v67, v95
    s_waitcnt lgkmcnt(5)
    v_dot2_f32_bf16 v92, v68, v140, v92
    v_dot2_f32_bf16 v94, v68, v68, v94
    v_dot2_f32_bf16 v93, v69, v140, v93
    v_dot2_f32_bf16 v95, v69, v69, v95
    v_dot2_f32_bf16 v92, v70, v140, v92
    v_dot2_f32_bf16 v94, v70, v70, v94
    v_dot2_f32_bf16 v93, v71, v140, v93
    v_dot2_f32_bf16 v95, v71, v71, v95
    s_waitcnt lgkmcnt(4)
    v_dot2_f32_bf16 v92, v72, v140, v92
    v_dot2_f32_bf16 v94, v72, v72, v94
    v_dot2_f32_bf16 v93, v73, v140, v93
    v_dot2_f32_bf16 v95, v73, v73, v95
    v_dot2_f32_bf16 v92, v74, v140, v92
    v_dot2_f32_bf16 v94, v74, v74, v94
    v_dot2_f32_bf16 v93, v75, v140, v93
    v_dot2_f32_bf16 v95, v75, v75, v95
    s_waitcnt lgkmcnt(3)
    v_dot2_f32_bf16 v92, v76, v140, v92
    v_dot2_f32_bf16 v94, v76, v76, v94
    v_dot2_f32_bf16 v93, v77, v140, v93
    v_dot2_f32_bf16 v95, v77, v77, v95
    v_dot2_f32_bf16 v92, v78, v140, v92
    v_dot2_f32_bf16 v94, v78, v78, v94
    v_dot2_f32_bf16 v93, v79, v140, v93
    v_dot2_f32_bf16 v95, v79, v79, v95
    s_waitcnt lgkmcnt(2)
    v_dot2_f32_bf16 v92, v80, v140, v92
    v_dot2_f32_bf16 v94, v80, v80, v94
    v_dot2_f32_bf16 v93, v81, v140, v93
    v_dot2_f32_bf16 v95, v81, v81, v95
    v_dot2_f32_bf16 v92, v82, v140, v92
    v_dot2_f32_bf16 v94, v82, v82, v94
    v_dot2_f32_bf16 v93, v83, v140, v93
    v_dot2_f32_bf16 v95, v83, v83, v95
    s_waitcnt lgkmcnt(1)
    v_dot2_f32_bf16 v92, v84, v140, v92
    v_dot2_f32_bf16 v94, v84, v84, v94
    v_dot2_f32_bf16 v93, v85, v140, v93
    v_dot2_f32_bf16 v95, v85, v85, v95
    v_dot2_f32_bf16 v92, v86, v140, v92
    v_dot2_f32_bf16 v94, v86, v86, v94
    v_dot2_f32_bf16 v93, v87, v140, v93
    v_dot2_f32_bf16 v95, v87, v87, v95
    s_waitcnt lgkmcnt(0)
    v_dot2_f32_bf16 v92, v88, v140, v92
    v_dot2_f32_bf16 v94, v88, v88, v94
    v_dot2_f32_bf16 v93, v89, v140, v93
    v_dot2_f32_bf16 v95, v89, v89, v95
    v_dot2_f32_bf16 v92, v90, v140, v92
    v_dot2_f32_bf16 v94, v90, v90, v94
    v_dot2_f32_bf16 v93, v91, v140, v93
    v_dot2_f32_bf16 v95, v91, v91, v95
    v_add_f32 v56, v56, v57
    v_add_f32 v58, v58, v59
    v_add_f32 v92, v92, v93
    v_add_f32 v94, v94, v95
    v_add_f32_dpp v56, v56, v56 quad_perm:[1,0,3,2] row_mask:0xf bank_mask:0xf
    v_add_f32_dpp v58, v58, v58 quad_perm:[1,0,3,2] row_mask:0xf bank_mask:0xf
    v_add_f32_dpp v92, v92, v92 quad_perm:[1,0,3,2] row_mask:0xf bank_mask:0xf
    v_add_f32_dpp v94, v94, v94 quad_perm:[1,0,3,2] row_mask:0xf bank_mask:0xf
    v_add_f32_dpp v56, v56, v56 quad_perm:[2,3,0,1] row_mask:0xf bank_mask:0xf
    v_add_f32_dpp v58, v58, v58 quad_perm:[2,3,0,1] row_mask:0xf bank_mask:0xf
    v_add_f32_dpp v92, v92, v92 quad_perm:[2,3,0,1] row_mask:0xf bank_mask:0xf
    v_add_f32_dpp v94, v94, v94 quad_perm:[2,3,0,1] row_mask:0xf bank_mask:0xf
    v_add_f32_dpp v56, v56, v56 row_half_mirror row_mask:0xf bank_mask:0xf
    v_add_f32_dpp v58, v58, v58 row_half_mirror row_mask:0xf bank_mask:0xf
    v_add_f32_dpp v92, v92, v92 row_half_mirror row_mask:0xf bank_mask:0xf
    v_add_f32_dpp v94, v94, v94 row_half_mirror row_mask:0xf bank_mask:0xf
    v_mul_f32 v62, 0x3b124925, v56
    v_mul_f32 v98, 0x3b124925, v92
    v_mul_f32 v58, 0x3b124925, v58
    v_mul_f32 v94, 0x3b124925, v94
    v_fma_f32 v58, -v62, v62, v58
    v_fma_f32 v94, -v98, v98, v94
    v_max_f32 v58, 0, v58
    v_max_f32 v94, 0, v94
    v_cvt_pk_bf16_f32 v58, v2, v58
    v_cvt_pk_bf16_f32 v94, v2, v94
    v_add_f32 v58, 0x3727c5ac, v58
    v_add_f32 v94, 0x3727c5ac, v94
    v_cvt_pk_bf16_f32 v58, v2, v58
    v_cvt_pk_bf16_f32 v94, v2, v94
    v_sqrt_f32 v58, v58
    v_sqrt_f32 v94, v94
    v_cvt_pk_bf16_f32 v58, v2, v58
    v_cvt_pk_bf16_f32 v94, v2, v94
    v_rcp_f32 v63, v58
    v_rcp_f32 v99, v94
    s_nop 0
    ds_write_b64 v171, v[62:63]
    ds_write_b64 v172, v[98:99]
    s_xor_b32 s70, s4, 1
    s_mul_i32 s70, s70, 36864
    s_add_u32 s70, s70, 16384
    v_add_u32 v188, s70, v1
    s_xor_b32 s70, s4, 2
    s_mul_i32 s70, s70, 36864
    s_add_u32 s70, s70, 18432
    v_add_u32 v189, s70, v1
    s_xor_b32 s70, s4, 3
    s_mul_i32 s70, s70, 36864
    s_add_u32 s70, s70, 20480
    v_add_u32 v190, s70, v1
    s_lshl2_add_u32 s70, s69, s4
    s_lshl_b32 s70, s70, 8
    v_lshl_add_u32 v191, v0, 2, s70
    s_mov_b32 s44, s24
    s_and_b32 s45, s25, 0xffff
    s_mov_b32 s46, 0x62000
    s_mov_b32 s47, 0x20000
    s_mov_b32 s48, s28
    s_and_b32 s49, s29, 0xffff
    s_mov_b32 s50, 0x188000
    s_mov_b32 s51, 0x20000
    s_mov_b32 s52, s32
    s_and_b32 s53, s33, 0xffff
    s_mov_b32 s54, 0x188000
    s_mov_b32 s55, 0x20000
    s_mov_b32 s56, s36
    s_and_b32 s57, s37, 0xffff
    s_mov_b32 s58, 0x1c0000
    s_mov_b32 s59, 0x20000
    s_cmp_eq_u32 s5, 7
    s_cselect_b32 s72, 0x7f000000, 0
    v_add_u32 v248, s72, v1
    v_lshrrev_b32 v7, 3, v0
    v_bfe_u32 v8, v0, 4, 1
    v_lshl_add_u32 v8, v8, 2, v0
    v_and_b32 v8, 7, v8
    v_lshl_add_u32 v8, v8, 4, s72
    v_mul_u32_u24 v7, 896, v7
    v_add_u32 v3, v7, v8
    v_lshl_add_u32 v4, v7, 2, v8
    v_add_u32 v6, 6144, v3
    v_add_u32 v251, 27648, v4
    v_add_u32 v184, 55296, v4
    v_add_u32 v185, 82944, v4
    v_min_u32 v186, 24, v0
    v_lshlrev_b32 v186, 7, v186
    s_lshl1_add_u32 s70, s3, s5
    s_lshl_b32 s70, s70, 12
    s_sub_u32 s71, s70, 28672
    s_min_u32 s16, s70, s71
    s_add_u32 s70, s16, 4096
    s_sub_u32 s71, s16, 24576
    s_min_u32 s17, s70, s71
    s_add_u32 s70, s17, 4096
    s_sub_u32 s71, s17, 24576
    s_min_u32 s18, s70, s71
    s_add_u32 s70, s18, 4096
    s_sub_u32 s71, s18, 24576
    s_min_u32 s19, s70, s71
    s_add_u32 s70, s19, 4096
    s_sub_u32 s71, s19, 24576
    s_min_u32 s20, s70, s71
    s_add_u32 s70, s20, 4096
    s_sub_u32 s71, s20, 24576
    s_min_u32 s21, s70, s71
    s_add_u32 s70, s21, 4096
    s_sub_u32 s71, s21, 24576
    s_min_u32 s22, s70, s71
    s_add_u32 s38, s85, 0x8000
    s_add_u32 s39, s87, 28672
    s_add_u32 s33, s89, 114688
    s_lshl_b32 s32, s6, 7
    s_add_u32 s32, s32, 16384
    s_sub_u32 s34, 0, s68
    s_mov_b32 s35, s34
    s_mov_b32 s36, 0
    s_mov_b32 s37, s34
    s_add_u32 s70, s5, 0
    s_and_b32 s70, s70, 3
    s_lshl_b32 s23, s70, 11
    s_mul_i32 s27, s70, 3584
    s_add_u32 s70, s5, 1
    s_and_b32 s70, s70, 3
    s_lshl_b32 s24, s70, 11
    s_mul_i32 s28, s70, 3584
    s_add_u32 s70, s5, 2
    s_and_b32 s70, s70, 3
    s_lshl_b32 s25, s70, 11
    s_mul_i32 s29, s70, 3584
    s_add_u32 s70, s5, 3
    s_and_b32 s70, s70, 3
    s_lshl_b32 s26, s70, 11
    s_mul_i32 s30, s70, 3584
    s_branch L_p1_b3
L_p1_B:
    s_mul_i32 s70, s83, 7296
    s_add_u32 s70, s70, 16384
    v_add_u32 v168, s70, v1
    s_lshl_b32 s70, s83, 6
    s_add_u32 s70, s70, 256
    v_and_b32 v171, 0x38, v0
    v_add_u32 v171, s70, v171
    s_mov_b32 s44, s18
    s_and_b32 s45, s19, 0xffff
    s_mov_b32 s46, 0x62000
    s_mov_b32 s47, 0x20000
    s_mov_b32 s64, s30
    s_and_b32 s65, s31, 0xffff
    s_mov_b32 s66, 0xe00
    s_mov_b32 s67, 0x20000
    s_mov_b32 s60, s34
    s_and_b32 s61, s35, 0xffff
    s_mov_b32 s62, 0x380
    s_mov_b32 s63, 0x20000
    s_lshl_b32 s70, s5, 9
    s_lshl_b32 s71, s69, 8
    s_add_u32 s70, s70, s71
    v_lshlrev_b32 v7, 1, v0
    v_add_u32 v8, s70, v7
    buffer_load_ushort v240, v8, s[64:67], 0 offen
    buffer_load_ushort v241, v8, s[64:67], 0 offen offset:128
    s_lshl_b32 s70, s5, 7
    v_add_u32 v8, s70, v7
    buffer_load_ushort v242, v8, s[60:63], 0 offen
    v_lshrrev_b32 v7, 3, v0
    v_bfe_u32 v8, v0, 4, 1
    v_lshl_add_u32 v8, v8, 2, v0
    v_and_b32 v8, 7, v8
    v_mul_u32_u24 v7, 896, v7
    v_lshl_add_u32 v3, v8, 4, v7
    v_and_b32 v7, 7, v0
    v_lshrrev_b32 v8, 5, v0
    v_xor_b32 v9, v7, v8
    s_lshl_b32 s70, s68, 2
    v_xor_b32 v9, s70, v9
    v_lshlrev_b32 v9, 4, v9
    v_lshl_add_u32 v9, v7, 7, v9
    v_bfe_u32 v7, v0, 3, 2
    v_add_u32 v7, s70, v7
    v_mul_u32_u24 v7, 7296, v7
    v_add_u32 v152, v7, v9
    v_xor_b32 v153, 32, v152
    v_xor_b32 v154, 64, v152
    v_xor_b32 v155, 96, v152
    v_bfe_u32 v7, v0, 2, 2
    v_lshl_add_u32 v8, v8, 3, v7
    v_lshlrev_b32 v8, 7, v8
    v_lshrrev_b32 v7, 1, v7
    v_lshlrev_b32 v7, 6, v7
    v_and_b32 v9, 3, v0
    v_lshl_add_u32 v7, v9, 3, v7
    v_bfe_u32 v9, v0, 4, 1
    v_lshl_add_u32 v7, v9, 5, v7
    s_mul_i32 s70, s69, 56
    v_add_u32 v7, s70, v7
    v_and_b32 v7, 127, v7
    v_add_u32 v7, v7, v8
    s_lshl_b32 s70, s68, 12
    s_add_u32 s71, s70, 74752
    v_add_u32 v156, s71, v7
    s_sub_u32 s71, 78848, s70
    v_add_u32 v157, s71, v7
    s_lshl_b32 s70, s5, 7
    s_lshl_b32 s71, s69, 6
    s_add_u32 s70, s70, s71
    s_lshl_b32 s71, s68, 5
    s_add_u32 s97, s70, s71
    v_lshrrev_b32 v8, 5, v0
    v_lshlrev_b32 v8, 3, v8
    v_and_b32 v7, 7, v0
    v_lshl_add_u32 v8, v7, 7, v8
    v_bfe_u32 v9, v0, 3, 2
    v_mul_u32_u24 v9, 7296, v9
    v_add_u32 v8, v8, v9
    s_lshr_b32 s70, s97, 4
    s_and_b32 s71, s70, 7
    s_lshr_b32 s70, s70, 3
    s_lshl_b32 s70, s70, 10
    v_xor_b32 v9, s71, v7
    v_lshl_add_u32 v9, v9, 4, v8
    v_add_u32 v158, s70, v9
    s_lshr_b32 s70, s97, 4
    s_add_u32 s70, s70, 1
    s_and_b32 s71, s70, 7
    s_lshr_b32 s70, s70, 3
    s_lshl_b32 s70, s70, 10
    v_xor_b32 v9, s71, v7
    v_lshl_add_u32 v9, v9, 4, v8
    v_add_u32 v159, s70, v9
    v_and_b32 v7, 31, v0
    s_lshl_b32 s70, s68, 8
    s_add_u32 s70, s70, 256
    v_lshl_add_u32 v162, v7, 3, s70
    s_lshl_b32 s70, s4, 11
    v_add_u32 v163, s70, v1
    v_lshlrev_b32 v164, 7, v0
    v_lshlrev_b32 v165, 2, v0
    s_lshl_b32 s70, s4, 8
    v_add_u32 v166, s70, v165
    v_xor_b32 v161, 0x200, v166
    v_mov_b32 v140, 0x3f803f80
    v_mov_b32 v141, 0x3f803f80
    v_mov_b32 v142, 0x3f803f80
    v_mov_b32 v143, 0x3f803f80
    s_mov_b32 s98, 0
    s_mov_b32 s99, -1
    s_lshl_b32 s70, s68, 8
    v_xor_b32 v195, s70, v1
    s_lshl_b32 s84, s4, 17
    s_lshl_b32 s70, s2, 9
    s_and_b32 s70, s70, 0
    s_add_u32 s84, s84, s70
    s_add_u32 s84, s84, 131072
    s_add_u32 s83, s83, 2
    s_and_b32 s83, s83, 7
    s_mul_i32 m0, s83, 7296
    s_add_u32 m0, m0, 16384
    s_lshl3_add_u32 s70, s6, s83
    s_mul_i32 s70, s70, 7168
    buffer_load_dwordx4 v20, s[8:11], s70 offen lds
    s_addk_i32 m0, 896
    s_nop 0
    buffer_load_dwordx4 v20, s[8:11], s70 offen offset:128 lds
    s_addk_i32 m0, 896
    s_nop 0
    buffer_load_dwordx4 v20, s[8:11], s70 offen offset:256 lds
    s_addk_i32 m0, 896
    s_nop 0
    buffer_load_dwordx4 v20, s[8:11], s70 offen offset:384 lds
    s_addk_i32 m0, 896
    s_nop 0
    buffer_load_dwordx4 v20, s[8:11], s70 offen offset:512 lds
    s_addk_i32 m0, 896
    s_nop 0
    buffer_load_dwordx4 v20, s[8:11], s70 offen offset:640 lds
    s_addk_i32 m0, 896
    s_nop 0
    buffer_load_dwordx4 v20, s[8:11], s70 offen offset:768 lds
    s_add_u32 s83, s83, 2
    s_and_b32 s83, s83, 7
    s_mul_i32 m0, s83, 7296
    s_add_u32 m0, m0, 16384
    s_lshl3_add_u32 s70, s6, s83
    s_mul_i32 s70, s70, 7168
    buffer_load_dwordx4 v20, s[8:11], s70 offen lds
    s_addk_i32 m0, 896
    s_nop 0
    buffer_load_dwordx4 v20, s[8:11], s70 offen offset:128 lds
    s_addk_i32 m0, 896
    s_nop 0
    buffer_load_dwordx4 v20, s[8:11], s70 offen offset:256 lds
    s_addk_i32 m0, 896
    s_nop 0
    buffer_load_dwordx4 v20, s[8:11], s70 offen offset:384 lds
    s_addk_i32 m0, 896
    s_nop 0
    buffer_load_dwordx4 v20, s[8:11], s70 offen offset:512 lds
    s_addk_i32 m0, 896
    s_nop 0
    buffer_load_dwordx4 v20, s[8:11], s70 offen offset:640 lds
    s_addk_i32 m0, 896
    s_nop 0
    buffer_load_dwordx4 v20, s[8:11], s70 offen offset:768 lds
    s_add_u32 s83, s83, 2
    s_and_b32 s83, s83, 7
    s_mul_i32 s70, s83, 7296
    s_add_u32 s70, s70, 16384
    v_add_u32 v169, s70, v1
    s_lshl_b32 s70, s83, 6
    s_add_u32 s70, s70, 256
    v_and_b32 v172, 0x38, v0
    v_add_u32 v172, s70, v172
    s_waitcnt vmcnt(17)
    s_barrier
    s_mul_i32 m0, s83, 7296
    s_add_u32 m0, m0, 16384
    s_lshl3_add_u32 s70, s6, s83
    s_mul_i32 s70, s70, 7168
    buffer_load_dwordx4 v20, s[8:11], s70 offen lds
    s_addk_i32 m0, 896
    s_nop 0
    buffer_load_dwordx4 v20, s[8:11], s70 offen offset:128 lds
    s_addk_i32 m0, 896
    s_nop 0
    buffer_load_dwordx4 v20, s[8:11], s70 offen offset:256 lds
    s_addk_i32 m0, 896
    s_nop 0
    buffer_load_dwordx4 v20, s[8:11], s70 offen offset:384 lds
    s_addk_i32 m0, 896
    s_nop 0
    buffer_load_dwordx4 v20, s[8:11], s70 offen offset:512 lds
    s_addk_i32 m0, 896
    s_nop 0
    buffer_load_dwordx4 v20, s[8:11], s70 offen offset:640 lds
    s_addk_i32 m0, 896
    s_nop 0
    buffer_load_dwordx4 v20, s[8:11], s70 offen offset:768 lds
    ds_read_b128 v[28:31], v168 offset:0
    ds_read_b128 v[32:35], v168 offset:1024
    ds_read_b128 v[36:39], v168 offset:2048
    ds_read_b128 v[40:43], v168 offset:3072
    ds_read_b128 v[44:47], v168 offset:4096
    ds_read_b128 v[48:51], v168 offset:5120
    ds_read_b128 v[52:55], v168 offset:6144
    s_waitcnt lgkmcnt(6)
    v_dot2_f32_bf16 v56, v28, v140, 0
    v_dot2_f32_bf16 v58, v28, v28, 0
    v_dot2_f32_bf16 v57, v29, v140, 0
    v_dot2_f32_bf16 v59, v29, v29, 0
    v_dot2_f32_bf16 v56, v30, v140, v56
    v_dot2_f32_bf16 v58, v30, v30, v58
    v_dot2_f32_bf16 v57, v31, v140, v57
    v_dot2_f32_bf16 v59, v31, v31, v59
    s_waitcnt lgkmcnt(5)
    v_dot2_f32_bf16 v56, v32, v140, v56
    v_dot2_f32_bf16 v58, v32, v32, v58
    v_dot2_f32_bf16 v57, v33, v140, v57
    v_dot2_f32_bf16 v59, v33, v33, v59
    v_dot2_f32_bf16 v56, v34, v140, v56
    v_dot2_f32_bf16 v58, v34, v34, v58
    v_dot2_f32_bf16 v57, v35, v140, v57
    v_dot2_f32_bf16 v59, v35, v35, v59
    s_waitcnt lgkmcnt(4)
    v_dot2_f32_bf16 v56, v36, v140, v56
    v_dot2_f32_bf16 v58, v36, v36, v58
    v_dot2_f32_bf16 v57, v37, v140, v57
    v_dot2_f32_bf16 v59, v37, v37, v59
    v_dot2_f32_bf16 v56, v38, v140, v56
    v_dot2_f32_bf16 v58, v38, v38, v58
    v_dot2_f32_bf16 v57, v39, v140, v57
    v_dot2_f32_bf16 v59, v39, v39, v59
    s_waitcnt lgkmcnt(3)
    v_dot2_f32_bf16 v56, v40, v140, v56
    v_dot2_f32_bf16 v58, v40, v40, v58
    v_dot2_f32_bf16 v57, v41, v140, v57
    v_dot2_f32_bf16 v59, v41, v41, v59
    v_dot2_f32_bf16 v56, v42, v140, v56
    v_dot2_f32_bf16 v58, v42, v42, v58
    v_dot2_f32_bf16 v57, v43, v140, v57
    v_dot2_f32_bf16 v59, v43, v43, v59
    s_waitcnt lgkmcnt(2)
    v_dot2_f32_bf16 v56, v44, v140, v56
    v_dot2_f32_bf16 v58, v44, v44, v58
    v_dot2_f32_bf16 v57, v45, v140, v57
    v_dot2_f32_bf16 v59, v45, v45, v59
    v_dot2_f32_bf16 v56, v46, v140, v56
    v_dot2_f32_bf16 v58, v46, v46, v58
    v_dot2_f32_bf16 v57, v47, v140, v57
    v_dot2_f32_bf16 v59, v47, v47, v59
    s_waitcnt lgkmcnt(1)
    v_dot2_f32_bf16 v56, v48, v140, v56
    v_dot2_f32_bf16 v58, v48, v48, v58
    v_dot2_f32_bf16 v57, v49, v140, v57
    v_dot2_f32_bf16 v59, v49, v49, v59
    v_dot2_f32_bf16 v56, v50, v140, v56
    v_dot2_f32_bf16 v58, v50, v50, v58
    v_dot2_f32_bf16 v57, v51, v140, v57
    v_dot2_f32_bf16 v59, v51, v51, v59
    s_waitcnt lgkmcnt(0)
    v_dot2_f32_bf16 v56, v52, v140, v56
    v_dot2_f32_bf16 v58, v52, v52, v58
    v_dot2_f32_bf16 v57, v53, v140, v57
    v_dot2_f32_bf16 v59, v53, v53, v59
    v_dot2_f32_bf16 v56, v54, v140, v56
    v_dot2_f32_bf16 v58, v54, v54, v58
    v_dot2_f32_bf16 v57, v55, v140, v57
    v_dot2_f32_bf16 v59, v55, v55, v59
    s_nop 1
    v_add_f32 v56, v56, v57
    v_add_f32 v58, v58, v59
    s_nop 0
    v_add_f32_dpp v56, v56, v56 quad_perm:[1,0,3,2] row_mask:0xf bank_mask:0xf
    v_add_f32_dpp v58, v58, v58 quad_perm:[1,0,3,2] row_mask:0xf bank_mask:0xf
    s_nop 0
    v_add_f32_dpp v56, v56, v56 quad_perm:[2,3,0,1] row_mask:0xf bank_mask:0xf
    v_add_f32_dpp v58, v58, v58 quad_perm:[2,3,0,1] row_mask:0xf bank_mask:0xf
    s_nop 0
    v_add_f32_dpp v56, v56, v56 row_half_mirror row_mask:0xf bank_mask:0xf
    v_add_f32_dpp v58, v58, v58 row_half_mirror row_mask:0xf bank_mask:0xf
    v_mul_f32 v62, 0x3b124925, v56
    v_mul_f32 v58, 0x3b124925, v58
    v_fma_f32 v58, -v62, v62, v58
    v_max_f32 v58, 0, v58
    v_cvt_pk_bf16_f32 v58, v2, v58
    v_add_f32 v58, 0x3727c5ac, v58
    v_cvt_pk_bf16_f32 v58, v2, v58
    v_sqrt_f32 v58, v58
    s_nop 0
    v_cvt_pk_bf16_f32 v58, v2, v58
    v_rcp_f32 v63, v58
    s_nop 0
    ds_write_b64 v171, v[62:63]
    s_waitcnt vmcnt(7)
    s_waitcnt lgkmcnt(0)
    s_barrier
    s_mul_i32 s75, s5, 112
    s_mul_i32 s71, s69, 200704
    s_add_u32 s75, s75, s71
    s_mul_i32 s73, s69, 28672
    s_add_u32 m0, s73, 74752
    s_nop 0
    buffer_load_dwordx4 v3, s[44:47], s75 offen lds
    s_addk_i32 m0, 1024
    s_addk_i32 s75, 7168
    buffer_load_dwordx4 v3, s[44:47], s75 offen lds
    s_addk_i32 m0, 1024
    s_addk_i32 s75, 7168
    buffer_load_dwordx4 v3, s[44:47], s75 offen lds
    s_addk_i32 m0, 1024
    s_addk_i32 s75, 7168
    buffer_load_dwordx4 v3, s[44:47], s75 offen lds
    s_addk_i32 m0, 1024
    s_addk_i32 s75, 7168
    buffer_load_dwordx4 v3, s[44:47], s75 offen lds
    s_addk_i32 m0, 1024
    s_addk_i32 s75, 7168
    buffer_load_dwordx4 v3, s[44:47], s75 offen lds
    s_addk_i32 m0, 1024
    s_addk_i32 s75, 7168
    s_lshl_b32 s70, s6, 16
    s_add_u32 s71, s70, 1048576
    s_lshl1_add_u32 s72, s69, s68
    s_lshl2_add_u32 s72, s5, s72
    s_lshl_b32 s85, s72, 10
    buffer_load_dwordx4 v3, s[44:47], s75 offen lds
    s_addk_i32 m0, 1024
    s_addk_i32 s75, 7168
    s_add_u32 s85, s85, s71
    s_lshl_b32 s86, s4, 13
    s_add_u32 s86, s86, s71
    s_add_u32 s71, s70, 3145728
    s_lshl1_add_u32 s72, s69, s68
    s_lshl2_add_u32 s72, s5, s72
    buffer_load_dwordx4 v3, s[44:47], s75 offen lds
    s_addk_i32 m0, 1024
    s_addk_i32 s75, 7168
    s_lshl_b32 s72, s72, 10
    s_add_u32 s87, s72, s71
    s_mul_i32 s72, s4, 7168
    s_add_u32 s88, s72, s71
    s_mul_i32 s71, s6, 229376
    s_add_u32 s71, s71, 5242880
    buffer_load_dwordx4 v3, s[44:47], s75 offen lds
    s_addk_i32 m0, 1024
    s_addk_i32 s75, 7168
    s_lshl2_add_u32 s72, s5, s4
    s_lshl_b32 s72, s72, 12
    s_add_u32 s89, s72, s71
    s_mul_i32 s90, s4, 28672
    s_add_u32 s90, s90, s71
    s_lshl_b32 s71, s5, 7
    buffer_load_dwordx4 v3, s[44:47], s75 offen lds
    s_addk_i32 m0, 1024
    s_addk_i32 s75, 7168
    s_mul_i32 s91, s4, 100352
    s_add_u32 s91, s91, s71
    s_mul_i32 s93, s4, 401408
    s_add_u32 s93, s93, s71
    s_lshl2_add_u32 s92, s5, s4
    s_lshl_b32 s92, s92, 7
    buffer_load_dwordx4 v3, s[44:47], s75 offen lds
    s_addk_i32 m0, 1024
    s_addk_i32 s75, 7168
    s_mul_i32 s100, s4, 36864
    s_add_u32 s100, s100, 16384
    v_bfe_u32 v7, v0, 2, 2
    v_lshrrev_b32 v8, 5, v0
    v_lshl_add_u32 v8, v8, 2, v7
    buffer_load_dwordx4 v3, s[44:47], s75 offen lds
    s_addk_i32 m0, 1024
    s_addk_i32 s75, 7168
    v_lshl_add_u32 v8, v8, 7, s100
    v_lshrrev_b32 v7, 1, v7
    v_lshl_add_u32 v8, v7, 6, v8
    v_and_b32 v7, 3, v0
    v_lshl_add_u32 v8, v7, 3, v8
    v_bfe_u32 v7, v0, 4, 1
    buffer_load_dwordx4 v3, s[44:47], s75 offen lds
    s_addk_i32 m0, 1024
    s_addk_i32 s75, 7168
    v_lshl_add_u32 v5, v7, 5, v8
    v_xor_b32 v250, 64, v5
    s_lshl1_add_u32 s72, s69, s68
    s_lshl_b32 s72, s72, 5
    v_xor_b32 v18, s72, v5
    v_xor_b32 v19, 64, v18
    buffer_load_dwordx4 v3, s[44:47], s75 offen lds
    s_addk_i32 m0, 1024
    s_addk_i32 s75, 7168
    v_mov_b32 v244, -1
    v_mov_b32 v245, -1
    v_mov_b32 v246, -1
    v_mov_b32 v247, -1
    s_waitcnt vmcnt(14)
    ds_read_b128 v[28:31], v169 offset:0
    buffer_load_dwordx4 v3, s[44:47], s75 offen lds
    s_addk_i32 m0, 1024
    s_addk_i32 s75, 7168
    ds_read_b128 v[32:35], v169 offset:1024
    ds_read_b128 v[36:39], v169 offset:2048
    ds_read_b128 v[40:43], v169 offset:3072
    ds_read_b128 v[44:47], v169 offset:4096
    ds_read_b128 v[48:51], v169 offset:5120
    ds_read_b128 v[52:55], v169 offset:6144
    buffer_load_dwordx4 v3, s[44:47], s75 offen lds
    s_addk_i32 m0, 1024
    s_addk_i32 s75, 7168
    s_waitcnt lgkmcnt(6)
    v_dot2_f32_bf16 v56, v28, v140, 0
    v_dot2_f32_bf16 v58, v28, v28, 0
    v_dot2_f32_bf16 v57, v29, v140, 0
    v_dot2_f32_bf16 v59, v29, v29, 0
    v_dot2_f32_bf16 v56, v30, v140, v56
    v_dot2_f32_bf16 v58, v30, v30, v58
    buffer_load_dwordx4 v3, s[44:47], s75 offen lds
    s_addk_i32 m0, 1024
    s_addk_i32 s75, 7168
    v_dot2_f32_bf16 v57, v31, v140, v57
    v_dot2_f32_bf16 v59, v31, v31, v59
    s_waitcnt lgkmcnt(5)
    v_dot2_f32_bf16 v56, v32, v140, v56
    v_dot2_f32_bf16 v58, v32, v32, v58
    v_dot2_f32_bf16 v57, v33, v140, v57
    buffer_load_dwordx4 v3, s[44:47], s75 offen lds
    s_addk_i32 m0, 1024
    s_addk_i32 s75, 7168
    v_dot2_f32_bf16 v59, v33, v33, v59
    v_dot2_f32_bf16 v56, v34, v140, v56
    v_dot2_f32_bf16 v58, v34, v34, v58
    v_dot2_f32_bf16 v57, v35, v140, v57
    v_dot2_f32_bf16 v59, v35, v35, v59
    s_waitcnt lgkmcnt(4)
    v_dot2_f32_bf16 v56, v36, v140, v56
    buffer_load_dwordx4 v3, s[44:47], s75 offen lds
    s_addk_i32 m0, 1024
    s_addk_i32 s75, 7168
    v_dot2_f32_bf16 v58, v36, v36, v58
    v_dot2_f32_bf16 v57, v37, v140, v57
    v_dot2_f32_bf16 v59, v37, v37, v59
    v_dot2_f32_bf16 v56, v38, v140, v56
    v_dot2_f32_bf16 v58, v38, v38, v58
    v_dot2_f32_bf16 v57, v39, v140, v57
    buffer_load_dwordx4 v3, s[44:47], s75 offen lds
    s_addk_i32 m0, 1024
    s_addk_i32 s75, 7168
    v_dot2_f32_bf16 v59, v39, v39, v59
    s_waitcnt lgkmcnt(3)
    v_dot2_f32_bf16 v56, v40, v140, v56
    v_dot2_f32_bf16 v58, v40, v40, v58
    v_dot2_f32_bf16 v57, v41, v140, v57
    v_dot2_f32_bf16 v59, v41, v41, v59
    v_dot2_f32_bf16 v56, v42, v140, v56
    buffer_load_dwordx4 v3, s[44:47], s75 offen lds
    s_addk_i32 m0, 1024
    s_addk_i32 s75, 7168
    v_dot2_f32_bf16 v58, v42, v42, v58
    v_dot2_f32_bf16 v57, v43, v140, v57
    v_dot2_f32_bf16 v59, v43, v43, v59
    s_waitcnt lgkmcnt(2)
    v_dot2_f32_bf16 v56, v44, v140, v56
    v_dot2_f32_bf16 v58, v44, v44, v58
    v_dot2_f32_bf16 v57, v45, v140, v57
    buffer_load_dwordx4 v3, s[44:47], s75 offen lds
    s_addk_i32 m0, 1024
    s_addk_i32 s75, 7168
    v_dot2_f32_bf16 v59, v45, v45, v59
    v_dot2_f32_bf16 v56, v46, v140, v56
    v_dot2_f32_bf16 v58, v46, v46, v58
    v_dot2_f32_bf16 v57, v47, v140, v57
    v_dot2_f32_bf16 v59, v47, v47, v59
    s_waitcnt lgkmcnt(1)
    v_dot2_f32_bf16 v56, v48, v140, v56
    buffer_load_dwordx4 v3, s[44:47], s75 offen lds
    s_addk_i32 m0, 1024
    s_addk_i32 s75, 7168
    v_dot2_f32_bf16 v58, v48, v48, v58
    v_dot2_f32_bf16 v57, v49, v140, v57
    v_dot2_f32_bf16 v59, v49, v49, v59
    v_dot2_f32_bf16 v56, v50, v140, v56
    v_dot2_f32_bf16 v58, v50, v50, v58
    buffer_load_dwordx4 v3, s[44:47], s75 offen lds
    s_addk_i32 m0, 1024
    s_addk_i32 s75, 7168
    v_dot2_f32_bf16 v57, v51, v140, v57
    v_dot2_f32_bf16 v59, v51, v51, v59
    s_waitcnt lgkmcnt(0)
    v_dot2_f32_bf16 v56, v52, v140, v56
    v_dot2_f32_bf16 v58, v52, v52, v58
    v_dot2_f32_bf16 v57, v53, v140, v57
    v_dot2_f32_bf16 v59, v53, v53, v59
    buffer_load_dwordx4 v3, s[44:47], s75 offen lds
    s_addk_i32 m0, 1024
    s_addk_i32 s75, 7168
    v_dot2_f32_bf16 v56, v54, v140, v56
    v_dot2_f32_bf16 v58, v54, v54, v58
    v_dot2_f32_bf16 v57, v55, v140, v57
    v_dot2_f32_bf16 v59, v55, v55, v59
    s_nop 1
    v_add_f32 v56, v56, v57
    v_add_f32 v58, v58, v59
    buffer_load_dwordx4 v3, s[44:47], s75 offen lds
    s_addk_i32 m0, 1024
    s_addk_i32 s75, 7168
    v_add_f32_dpp v56, v56, v56 quad_perm:[1,0,3,2] row_mask:0xf bank_mask:0xf
    v_add_f32_dpp v58, v58, v58 quad_perm:[1,0,3,2] row_mask:0xf bank_mask:0xf
    s_nop 0
    v_add_f32_dpp v56, v56, v56 quad_perm:[2,3,0,1] row_mask:0xf bank_mask:0xf
    v_add_f32_dpp v58, v58, v58 quad_perm:[2,3,0,1] row_mask:0xf bank_mask:0xf
    s_nop 0
    v_add_f32_dpp v56, v56, v56 row_half_mirror row_mask:0xf bank_mask:0xf
    v_add_f32_dpp v58, v58, v58 row_half_mirror row_mask:0xf bank_mask:0xf
    buffer_load_dwordx4 v3, s[44:47], s75 offen lds
    s_addk_i32 m0, 1024
    s_addk_i32 s75, 7168
    v_mul_f32 v62, 0x3b124925, v56
    v_mul_f32 v58, 0x3b124925, v58
    v_fma_f32 v58, -v62, v62, v58
    v_max_f32 v58, 0, v58
    v_cvt_pk_bf16_f32 v58, v2, v58
    v_add_f32 v58, 0x3727c5ac, v58
    buffer_load_dwordx4 v3, s[44:47], s75 offen lds
    v_cvt_pk_bf16_f32 v58, v2, v58
    v_sqrt_f32 v58, v58
    s_nop 0
    v_cvt_pk_bf16_f32 v58, v2, v58
    v_rcp_f32 v63, v58
    s_nop 0
    ds_write_b64 v172, v[62:63]
    s_xor_b32 s70, s4, 1
    s_mul_i32 s70, s70, 36864
    s_add_u32 s70, s70, 16384
    v_add_u32 v188, s70, v1
    s_xor_b32 s70, s4, 2
    s_mul_i32 s70, s70, 36864
    s_add_u32 s70, s70, 18432
    v_add_u32 v189, s70, v1
    s_xor_b32 s70, s4, 3
    s_mul_i32 s70, s70, 36864
    s_add_u32 s70, s70, 20480
    v_add_u32 v190, s70, v1
    s_lshl2_add_u32 s70, s69, s4
    s_lshl_b32 s70, s70, 8
    v_lshl_add_u32 v191, v0, 2, s70
    s_mov_b32 s44, s24
    s_and_b32 s45, s25, 0xffff
    s_mov_b32 s46, 0x62000
    s_mov_b32 s47, 0x20000
    s_mov_b32 s48, s28
    s_and_b32 s49, s29, 0xffff
    s_mov_b32 s50, 0x188000
    s_mov_b32 s51, 0x20000
    s_mov_b32 s52, s32
    s_and_b32 s53, s33, 0xffff
    s_mov_b32 s54, 0x188000
    s_mov_b32 s55, 0x20000
    s_mov_b32 s56, s36
    s_and_b32 s57, s37, 0xffff
    s_mov_b32 s58, 0x1c0000
    s_mov_b32 s59, 0x20000
    s_cmp_eq_u32 s5, 7
    s_cselect_b32 s72, 0x7f000000, 0
    v_add_u32 v248, s72, v1
    v_lshrrev_b32 v7, 3, v0
    v_bfe_u32 v8, v0, 4, 1
    v_lshl_add_u32 v8, v8, 2, v0
    v_and_b32 v8, 7, v8
    v_lshl_add_u32 v8, v8, 4, s72
    v_mul_u32_u24 v7, 896, v7
    v_add_u32 v3, v7, v8
    v_lshl_add_u32 v4, v7, 2, v8
    v_add_u32 v6, 6144, v3
    v_add_u32 v251, 27648, v4
    v_add_u32 v184, 55296, v4
    v_add_u32 v185, 82944, v4
    v_min_u32 v186, 24, v0
    v_lshlrev_b32 v186, 7, v186
    s_lshl1_add_u32 s70, s3, s5
    s_lshl_b32 s70, s70, 12
    s_sub_u32 s71, s70, 28672
    s_min_u32 s16, s70, s71
    s_add_u32 s70, s16, 4096
    s_sub_u32 s71, s16, 24576
    s_min_u32 s17, s70, s71
    s_add_u32 s70, s17, 4096
    s_sub_u32 s71, s17, 24576
    s_min_u32 s18, s70, s71
    s_add_u32 s70, s18, 4096
    s_sub_u32 s71, s18, 24576
    s_min_u32 s19, s70, s71
    s_add_u32 s70, s19, 4096
    s_sub_u32 s71, s19, 24576
    s_min_u32 s20, s70, s71
    s_add_u32 s70, s20, 4096
    s_sub_u32 s71, s20, 24576
    s_min_u32 s21, s70, s71
    s_add_u32 s70, s21, 4096
    s_sub_u32 s71, s21, 24576
    s_min_u32 s22, s70, s71
    s_add_u32 s38, s85, 0x8000
    s_add_u32 s39, s87, 28672
    s_add_u32 s33, s89, 114688
    s_lshl_b32 s32, s6, 7
    s_add_u32 s32, s32, 16384
    s_sub_u32 s34, 0, s68
    s_mov_b32 s35, s34
    s_mov_b32 s36, 0
    s_mov_b32 s37, s34
    s_add_u32 s70, s5, 0
    s_and_b32 s70, s70, 3
    s_lshl_b32 s23, s70, 11
    s_mul_i32 s27, s70, 3584
    s_add_u32 s70, s5, 1
    s_and_b32 s70, s70, 3
    s_lshl_b32 s24, s70, 11
    s_mul_i32 s28, s70, 3584
    s_add_u32 s70, s5, 2
    s_and_b32 s70, s70, 3
    s_lshl_b32 s25, s70, 11
    s_mul_i32 s29, s70, 3584
    s_add_u32 s70, s5, 3
    s_and_b32 s70, s70, 3
    s_lshl_b32 s26, s70, 11
    s_mul_i32 s30, s70, 3584
    s_lshl1_add_u32 s70, s2, s69
    s_mul_i32 s71, s70, 3136
    buffer_load_dword v234, v186, s[48:51], s71 offen
    buffer_load_dword v235, v186, s[52:55], s71 offen
    v_min_u32 v7, 768, v186
    s_mul_i32 s71, s70, 784
    buffer_load_dword v236, v7, s[44:47], s71 offen
    s_lshl_b32 s70, s69, 9
    v_add_u32 v8, s70, v165
    v_lshlrev_b32 v240, 16, v240
    v_lshlrev_b32 v241, 16, v241
    v_lshlrev_b32 v242, 16, v242
    v_mul_f32 v240, 0x3eeff558, v240
    v_mul_f32 v241, 0x3eeff558, v241
    ds_write_b32 v8, v240 offset:768
    ds_write_b32 v8, v241 offset:1024
    ds_write_b32 v165, v242 offset:1792
    s_waitcnt vmcnt(3)
L_p1_b3:
    s_waitcnt lgkmcnt(0)
    s_barrier
    ds_read_b128 v[32:35], v152 offset:16384
    ds_read_b64_tr_b16 v[64:65], v156 offset:0
    ds_read_b64_tr_b16 v[66:67], v156 offset:512
    ds_read_b128 v[36:39], v153 offset:16384
    ds_read_b64_tr_b16 v[68:69], v156 offset:2048
    ds_read_b64_tr_b16 v[70:71], v156 offset:2560
    ds_read_b128 v[40:43], v152 offset:17408
    ds_read_b64_tr_b16 v[72:73], v156 offset:8192
    ds_read_b64_tr_b16 v[74:75], v156 offset:8704
    ds_read_b128 v[44:47], v153 offset:17408
    ds_read_b64_tr_b16 v[76:77], v156 offset:10240
    ds_read_b64_tr_b16 v[78:79], v156 offset:10752
    s_waitcnt lgkmcnt(9)
    v_mfma_f32_32x32x16_bf16 v[104:119], v[64:67], v[32:35], 0
    ds_read_b128 v[48:51], v152 offset:18432
    ds_read_b64_tr_b16 v[80:81], v156 offset:16384
    ds_read_b64_tr_b16 v[82:83], v156 offset:16896
    v_mfma_f32_32x32x16_bf16 v[120:135], v[140:143], v[64:67], 0
    ds_read_b128 a[0:3], v154 offset:16384
    ds_read_b64_tr_b16 a[56:57], v157 offset:0
    ds_read_b64_tr_b16 a[58:59], v157 offset:512
    s_waitcnt lgkmcnt(12)
    v_mfma_f32_32x32x16_bf16 v[104:119], v[68:71], v[36:39], v[104:119]
    ds_read_b128 v[52:55], v153 offset:18432
    ds_read_b64_tr_b16 v[84:85], v156 offset:18432
    ds_read_b64_tr_b16 v[86:87], v156 offset:18944
    v_mfma_f32_32x32x16_bf16 v[120:135], v[140:143], v[68:71], v[120:135]
    ds_read_b128 a[4:7], v155 offset:16384
    ds_read_b64_tr_b16 a[60:61], v157 offset:2048
    ds_read_b64_tr_b16 a[62:63], v157 offset:2560
    s_waitcnt lgkmcnt(15)
    v_mfma_f32_32x32x16_bf16 v[104:119], v[72:75], v[40:43], v[104:119]
    ds_read_b128 v[56:59], v152 offset:19456
    ds_read_b64_tr_b16 v[88:89], v156 offset:24576
    ds_read_b64_tr_b16 v[90:91], v156 offset:25088
    v_mfma_f32_32x32x16_bf16 v[120:135], v[140:143], v[72:75], v[120:135]
    ds_read_b128 a[8:11], v154 offset:17408
    ds_read_b64_tr_b16 a[64:65], v157 offset:8192
    ds_read_b64_tr_b16 a[66:67], v157 offset:8704
    ds_read_b64 v[10:11], v158 offset:16384
    ds_read_b64 v[12:13], v159 offset:16384
    ds_read_b64 v[14:15], v158 offset:45568
    ds_read_b64 v[16:17], v159 offset:45568
    ds_read_b64 v[136:137], v162
    s_cmp_lg_u32 s4, 0
    s_cbranch_scc1 L_p1_np
    buffer_load_dwordx4 v[96:99], v164, s[12:15], 0 offen sc1
    buffer_load_dwordx4 v[100:103], v164, s[12:15], 0 offen offset:16 sc1
L_p1_np:
    s_waitcnt lgkmcnt(15)
    v_mfma_f32_32x32x16_bf16 v[104:119], v[76:79], v[44:47], v[104:119]
    ds_read_b128 v[60:63], v153 offset:19456
    ds_read_b64_tr_b16 v[92:93], v156 offset:26624
    ds_read_b64_tr_b16 v[94:95], v156 offset:27136
    v_mfma_f32_32x32x16_bf16 v[120:135], v[140:143], v[76:79], v[120:135]
    ds_read_b128 a[12:15], v155 offset:17408
    ds_read_b64_tr_b16 a[68:69], v157 offset:10240
    ds_read_b64_tr_b16 a[70:71], v157 offset:10752
    v_mfma_f32_32x32x16_bf16 v[104:119], v[80:83], v[48:51], v[104:119]
    ds_read_b128 v[32:35], v152 offset:20480
    ds_read_b64_tr_b16 v[64:65], v156 offset:32768
    ds_read_b64_tr_b16 v[66:67], v156 offset:33280
    v_mfma_f32_32x32x16_bf16 v[120:135], v[140:143], v[80:83], v[120:135]
    ds_read_b128 a[16:19], v154 offset:18432
    ds_read_b64_tr_b16 a[72:73], v157 offset:16384
    ds_read_b64_tr_b16 a[74:75], v157 offset:16896
    s_waitcnt lgkmcnt(15)
    v_mfma_f32_32x32x16_bf16 v[104:119], v[84:87], v[52:55], v[104:119]
    ds_read_b128 v[36:39], v153 offset:20480
    ds_read_b64_tr_b16 v[68:69], v156 offset:34816
    ds_read_b64_tr_b16 v[70:71], v156 offset:35328
    v_mfma_f32_32x32x16_bf16 v[120:135], v[140:143], v[84:87], v[120:135]
    ds_read_b128 a[20:23], v155 offset:18432
    ds_read_b64_tr_b16 a[76:77], v157 offset:18432
    ds_read_b64_tr_b16 a[78:79], v157 offset:18944
    v_mfma_f32_32x32x16_bf16 v[104:119], v[88:91], v[56:59], v[104:119]
    ds_read_b128 v[40:43], v152 offset:21504
    ds_read_b64_tr_b16 v[72:73], v156 offset:40960
    ds_read_b64_tr_b16 v[74:75], v156 offset:41472
    v_mfma_f32_32x32x16_bf16 v[120:135], v[140:143], v[88:91], v[120:135]
    ds_read_b128 a[24:27], v154 offset:19456
    ds_read_b64_tr_b16 a[80:81], v157 offset:24576
    ds_read_b64_tr_b16 a[82:83], v157 offset:25088
    s_waitcnt lgkmcnt(15)
    v_mul_f32 v137, 0x3e8b97f6, v137
    v_sub_f32 v136, 0, v136
    v_cvt_pk_bf16_f32 v148, v136, v136
    v_lshlrev_b32 v149, 16, v148
    v_mfma_f32_32x32x16_bf16 v[104:119], v[92:95], v[60:63], v[104:119]
    ds_read_b128 v[44:47], v153 offset:21504
    ds_read_b64_tr_b16 v[76:77], v156 offset:43008
    ds_read_b64_tr_b16 v[78:79], v156 offset:43520
    v_mfma_f32_32x32x16_bf16 v[120:135], v[140:143], v[92:95], v[120:135]
    ds_read_b128 a[28:31], v155 offset:19456
    ds_read_b64_tr_b16 a[84:85], v157 offset:26624
    ds_read_b64_tr_b16 a[86:87], v157 offset:27136
    v_sub_f32 v149, v136, v149
    v_cvt_pk_bf16_f32 v149, v149, v2
    v_cndmask_b32 v148, v148, v2, s[98:99]
    v_cndmask_b32 v149, v149, v2, s[98:99]
    v_mfma_f32_32x32x16_bf16 v[104:119], v[64:67], v[32:35], v[104:119]
    ds_read_b128 v[48:51], v152 offset:22528
    ds_read_b64_tr_b16 v[80:81], v156 offset:49152
    ds_read_b64_tr_b16 v[82:83], v156 offset:49664
    v_mfma_f32_32x32x16_bf16 v[120:135], v[140:143], v[64:67], v[120:135]
    ds_read_b128 a[32:35], v154 offset:20480
    ds_read_b64_tr_b16 a[88:89], v157 offset:32768
    ds_read_b64_tr_b16 a[90:91], v157 offset:33280
    v_mov_b32 v146, 0
    v_mov_b32 v147, 0
    v_mov_b32 v150, 0
    v_mov_b32 v151, 0
    s_waitcnt lgkmcnt(15)
    v_mfma_f32_32x32x16_bf16 v[104:119], v[68:71], v[36:39], v[104:119]
    ds_read_b128 v[52:55], v153 offset:22528
    ds_read_b64_tr_b16 v[84:85], v156 offset:51200
    ds_read_b64_tr_b16 v[86:87], v156 offset:51712
    v_mfma_f32_32x32x16_bf16 v[120:135], v[140:143], v[68:71], v[120:135]
    ds_read_b128 a[36:39], v155 offset:20480
    ds_read_b64_tr_b16 a[92:93], v157 offset:34816
    ds_read_b64_tr_b16 a[94:95], v157 offset:35328
    v_mfma_f32_32x32x16_bf16 v[104:119], v[72:75], v[40:43], v[104:119]
    ds_read_b128 a[40:43], v154 offset:21504
    ds_read_b64_tr_b16 a[96:97], v157 offset:40960
    ds_read_b64_tr_b16 a[98:99], v157 offset:41472
    v_mfma_f32_32x32x16_bf16 v[120:135], v[140:143], v[72:75], v[120:135]
    s_waitcnt lgkmcnt(15)
    v_mfma_f32_32x32x16_bf16 v[104:119], v[76:79], v[44:47], v[104:119]
    ds_read_b128 a[44:47], v155 offset:21504
    ds_read_b64_tr_b16 a[100:101], v157 offset:43008
    ds_read_b64_tr_b16 a[102:103], v157 offset:43520
    v_mfma_f32_32x32x16_bf16 v[120:135], v[140:143], v[76:79], v[120:135]
    s_waitcnt lgkmcnt(15)
    v_mfma_f32_32x32x16_bf16 v[104:119], v[80:83], v[48:51], v[104:119]
    ds_read_b128 a[48:51], v154 offset:22528
    ds_read_b64_tr_b16 a[104:105], v157 offset:49152
    ds_read_b64_tr_b16 a[106:107], v157 offset:49664
    v_mfma_f32_32x32x16_bf16 v[120:135], v[140:143], v[80:83], v[120:135]
    s_waitcnt lgkmcnt(12)
    v_mfma_f32_32x32x16_bf16 v[104:119], v[84:87], v[52:55], v[104:119]
    ds_read_b128 a[52:55], v155 offset:22528
    ds_read_b64_tr_b16 a[108:109], v157 offset:51200
    ds_read_b64_tr_b16 a[110:111], v157 offset:51712
    v_mfma_f32_32x32x16_bf16 v[120:135], v[140:143], v[84:87], v[120:135]
    v_mfma_f32_32x32x16_bf16 v[104:119], a[56:59], a[0:3], v[104:119]
    v_mfma_f32_32x32x16_bf16 v[104:119], a[60:63], a[4:7], v[104:119]
    s_cmp_lg_u32 s4, 0
    s_cbranch_scc1 L_p1_nt
    s_waitcnt vmcnt(0)
    v_xor_b32 v96, s7, v96
    v_xor_b32 v98, s7, v98
    v_xor_b32 v100, s7, v100
    v_xor_b32 v102, s7, v102
    v_or3_b32 v96, v96, v98, v100
    v_or_b32 v96, v96, v102
    v_cmp_ne_u32 vcc, 0, v96
    s_nop 0
    s_cbranch_vccnz L_p1_again
    v_max3_u32 v97, v97, v99, v101
    v_max_u32 v97, v97, v103
    ds_write_b32 v165, v97 offset:2048
    v_mov_b32 v96, 1
    ds_write_b32 v2, v96 offset:24
    s_branch L_p1_nt
L_p1_again:
    buffer_load_dwordx4 v[96:99], v164, s[12:15], 0 offen sc1
    buffer_load_dwordx4 v[100:103], v164, s[12:15], 0 offen offset:16 sc1
L_p1_nt:
    v_mfma_f32_32x32x16_bf16 v[104:119], a[64:67], a[8:11], v[104:119]
    s_nop 6
    ds_write_b32 v166, v120 offset:4096
    v_mfma_f32_32x32x16_bf16 v[104:119], a[68:71], a[12:15], v[104:119]
    v_mfma_f32_32x32x16_bf16 v[104:119], a[72:75], a[16:19], v[104:119]
    s_waitcnt lgkmcnt(0)
    s_barrier
    ds_read_b32 v253, v2 offset:24
    ds_read_b32 v138, v161 offset:4096
    v_mfma_f32_32x32x16_bf16 v[104:119], a[76:79], a[20:23], v[104:119]
    v_mfma_f32_32x32x16_bf16 v[104:119], a[80:83], a[24:27], v[104:119]
    s_waitcnt lgkmcnt(1)
    v_readfirstlane_b32 s41, v253
    v_mfma_f32_32x32x16_bf16 v[104:119], a[84:87], a[28:31], v[104:119]
    s_cmp_eq_u32 s41, 0
    s_cbranch_scc1 L_p1_late21
    buffer_load_dwordx4 a[112:115], v1, s[12:15], s84 offen sc1
    buffer_load_dwordx4 a[116:119], v1, s[12:15], s84 offen offset:1024 sc1
    buffer_load_dwordx4 a[120:123], v195, s[12:15], s84 offen offset:2048 sc1
    buffer_load_dwordx4 a[124:127], v195, s[12:15], s84 offen offset:3072 sc1
    s_addk_i32 s84, 4096
L_p1_late21:
    v_mfma_f32_32x32x16_bf16 v[104:119], a[88:91], a[32:35], v[104:119]
    v_mfma_f32_32x32x16_bf16 v[104:119], a[92:95], a[36:39], v[104:119]
    v_mfma_f32_32x32x16_bf16 v[104:119], a[96:99], a[40:43], v[104:119]
    ds_read_b32 v254, v2 offset:0
    s_waitcnt lgkmcnt(1)
    v_add_f32 v138, v138, v120
    v_cvt_pk_bf16_f32 v145, v138, v2
    v_lshlrev_b32 v139, 16, v145
    v_sub_f32 v139, v138, v139
    v_cvt_pk_bf16_f32 v144, v138, v139
    v_mfma_f32_32x32x16_bf16 v[104:119], a[100:103], a[44:47], v[104:119]
    s_cmp_eq_u32 s41, 0
    s_cbranch_scc1 L_p1_late25
    buffer_load_dwordx4 a[128:131], v1, s[12:15], s84 offen sc1
    buffer_load_dwordx4 a[132:135], v1, s[12:15], s84 offen offset:1024 sc1
    buffer_load_dwordx4 a[136:139], v195, s[12:15], s84 offen offset:2048 sc1
    buffer_load_dwordx4 a[140:143], v195, s[12:15], s84 offen offset:3072 sc1
    s_addk_i32 s84, 4096
L_p1_late25:
    v_mfma_f32_32x32x16_bf16 v[104:119], a[104:107], a[48:51], v[104:119]
    v_mfma_f32_32x32x16_bf16 v[104:119], a[108:111], a[52:55], v[104:119]
    s_waitcnt lgkmcnt(0)
    v_readfirstlane_b32 s7, v254
    v_mfma_f32_32x32x16_bf16 v[104:119], v[144:147], v[148:151], v[104:119]
    s_nop 11
    v_mul_f32 v104, v137, v104
    v_mul_f32 v105, v137, v105
    v_mul_f32 v106, v137, v106
    v_mul_f32 v107, v137, v107
    v_mul_f32 v108, v137, v108
    v_mul_f32 v109, v137, v109
    v_mul_f32 v110, v137, v110
    v_mul_f32 v111, v137, v111
    v_mul_f32 v112, v137, v112
    v_mul_f32 v113, v137, v113
    v_mul_f32 v114, v137, v114
    v_mul_f32 v115, v137, v115
    v_mul_f32 v116, v137, v116
    v_mul_f32 v117, v137, v117
    v_mul_f32 v118, v137, v118
    v_mul_f32 v119, v137, v119
    v_cndmask_b32 v116, v116, v2, s[98:99]
    v_cndmask_b32 v117, v117, v2, s[98:99]
    v_cndmask_b32 v118, v118, v2, s[98:99]
    v_cndmask_b32 v119, v119, v2, s[98:99]
    v_cvt_pk_bf16_f32 v48, v104, v105
    v_cvt_pk_bf16_f32 v49, v106, v107
    v_cvt_pk_bf16_f32 v50, v108, v109
    v_cvt_pk_bf16_f32 v51, v110, v111
    v_cvt_pk_bf16_f32 v52, v112, v113
    v_cvt_pk_bf16_f32 v53, v114, v115
    v_cvt_pk_bf16_f32 v54, v116, v117
    v_cvt_pk_bf16_f32 v55, v118, v119
    ds_write_b128 v163, v[48:51] offset:8192
    ds_write_b128 v163, v[52:55] offset:9216
    v_add_f32 v58, abs(v104), abs(v105)
    v_add_f32 v59, abs(v106), abs(v107)
    v_add_f32 v58, v58, abs(v108)
    v_add_f32 v59, v59, abs(v109)
    v_add_f32 v58, v58, abs(v110)
    v_add_f32 v59, v59, abs(v111)
    v_add_f32 v58, v58, abs(v112)
    v_add_f32 v59, v59, abs(v113)
    v_add_f32 v58, v58, abs(v114)
    v_add_f32 v59, v59, abs(v115)
    v_add_f32 v58, v58, abs(v116)
    v_add_f32 v59, v59, abs(v117)
    v_add_f32 v58, v58, abs(v118)
    v_add_f32 v59, v59, abs(v119)
    v_add_f32 v58, v58, v59
    ds_write_b32 v166, v58 offset:7168
    s_or_b32 s70, s4, s41
    s_cmp_lg_u32 s70, 0
    s_cbranch_scc1 L_p1_b5
    s_mov_b32 s94, 0
L_f1_chk:
    s_waitcnt vmcnt(0)
    v_xor_b32 v96, s7, v96
    v_xor_b32 v98, s7, v98
    v_xor_b32 v100, s7, v100
    v_xor_b32 v102, s7, v102
    v_or3_b32 v96, v96, v98, v100
    v_or_b32 v96, v96, v102
    v_cmp_ne_u32 vcc, 0, v96
    s_nop 0
    s_cbranch_vccz L_f1_ok
    s_add_u32 s94, s94, 1
    s_cmp_gt_u32 s94, 131072
    s_cbranch_scc1 L_f1_ok
    buffer_load_dwordx4 v[96:99], v164, s[12:15], 0 offen sc1
    buffer_load_dwordx4 v[100:103], v164, s[12:15], 0 offen offset:16 sc1
    s_waitcnt vmcnt(0)
    s_branch L_f1_chk
L_f1_ok:
    v_max3_u32 v97, v97, v99, v101
    v_max_u32 v97, v97, v103
    ds_write_b32 v165, v97 offset:2048
L_p1_b5:
    s_waitcnt lgkmcnt(0)
    s_barrier
    s_cmp_lg_u32 s41, 0
    s_cbranch_scc1 L_p1_have
    buffer_load_dwordx4 a[112:115], v1, s[12:15], s84 offen sc1
    buffer_load_dwordx4 a[116:119], v1, s[12:15], s84 offen offset:1024 sc1
    buffer_load_dwordx4 a[120:123], v195, s[12:15], s84 offen offset:2048 sc1
    buffer_load_dwordx4 a[124:127], v195, s[12:15], s84 offen offset:3072 sc1
    s_addk_i32 s84, 4096
    buffer_load_dwordx4 a[128:131], v1, s[12:15], s84 offen sc1
    buffer_load_dwordx4 a[132:135], v1, s[12:15], s84 offen offset:1024 sc1
    buffer_load_dwordx4 a[136:139], v195, s[12:15], s84 offen offset:2048 sc1
    buffer_load_dwordx4 a[140:143], v195, s[12:15], s84 offen offset:3072 sc1
    s_addk_i32 s84, 4096
L_p1_have:
    s_lshl_b32 s70, s69, 11
    v_add_u32 v7, s70, v1
    v_xor_b32 v8, 0x800, v7
    ds_read_b128 a[232:235], v8 offset:8192
    ds_read_b128 a[236:239], v8 offset:9216
    ds_read_b128 a[224:227], v7 offset:8192
    ds_read_b128 a[228:231], v7 offset:9216
    ds_read_b128 a[248:251], v8 offset:12288
    ds_read_b128 a[252:255], v8 offset:13312
    ds_read_b128 a[240:243], v7 offset:12288
    ds_read_b128 a[244:247], v7 offset:13312
    v_and_b32 v7, 31, v0
    v_lshlrev_b32 v7, 2, v7
    v_add_u32 v7, 7168, v7
    ds_read2_b32 v[140:141], v7 offset0:0 offset1:32
    ds_read2_b32 v[142:143], v7 offset0:64 offset1:96
    ds_read2_b32 v[144:145], v7 offset0:128 offset1:160
    ds_read2_b32 v[146:147], v7 offset0:192 offset1:224
    v_lshlrev_b32 v8, 2, v0
    ds_read_b32 v148, v8 offset:2048
    s_waitcnt vmcnt(6)
    s_waitcnt lgkmcnt(12)
    v_mfma_f32_32x32x16_bf16 v[20:35], a[112:115], a[232:235], 0
    s_waitcnt lgkmcnt(11)
    v_mfma_f32_32x32x16_bf16 v[20:35], a[116:119], a[236:239], v[20:35]
    s_waitcnt lgkmcnt(4)
    v_add_f32 v140, v140, v141
    s_waitcnt lgkmcnt(3)
    v_add_f32 v142, v142, v143
    s_waitcnt lgkmcnt(2)
    v_add_f32 v144, v144, v145
    s_waitcnt lgkmcnt(1)
    v_add_f32 v146, v146, v147
    v_max3_f32 v140, v140, v142, v144
    v_max_f32 v140, v140, v146
    s_waitcnt lgkmcnt(0)
    v_max_u32_dpp v148, v148, v148 row_ror:1 row_mask:0xf bank_mask:0xf
    s_nop 1
    v_max_u32_dpp v148, v148, v148 row_ror:2 row_mask:0xf bank_mask:0xf
    s_nop 1
    v_max_u32_dpp v148, v148, v148 row_ror:4 row_mask:0xf bank_mask:0xf
    s_nop 1
    v_max_u32_dpp v148, v148, v148 row_ror:8 row_mask:0xf bank_mask:0xf
    s_nop 0
    v_readlane_b32 s70, v148, 0
    v_readlane_b32 s71, v148, 16
    s_nop 0
    s_max_u32 s70, s70, s71
    v_readlane_b32 s71, v148, 32
    s_nop 0
    s_max_u32 s70, s70, s71
    v_readlane_b32 s71, v148, 48
    s_nop 0
    s_max_u32 s70, s70, s71
    v_mul_f32 v140, s70, v140
    v_cmp_ngt_f32 vcc, 0x42c00000, v140
    s_nop 0
    s_cbranch_vccnz L_slow
.p2align 3
    v_mfma_f32_32x32x16_bf16 v[36:51], a[112:115], a[224:227], 0
    buffer_load_dwordx4 a[144:147], v1, s[12:15], s84 offen sc1
    buffer_load_dwordx4 a[148:151], v1, s[12:15], s84 offen offset:1024 sc1
    v_exp_f32 v20, v20
    v_exp_f32 v21, v21
    v_exp_f32 v22, v22
    v_exp_f32 v23, v23
    v_cvt_pk_bf16_f32 v52, v20, v21
    v_mfma_f32_32x32x16_bf16 v[36:51], a[116:119], a[228:231], v[36:51]
    buffer_load_dwordx4 a[152:155], v195, s[12:15], s84 offen offset:2048 sc1
    v_exp_f32 v24, v24
    v_exp_f32 v25, v25
    v_exp_f32 v26, v26
    v_exp_f32 v27, v27
    v_cvt_pk_bf16_f32 v53, v22, v23
    v_cvt_pk_bf16_f32 v54, v24, v25
    buffer_load_dwordx4 a[156:159], v195, s[12:15], s84 offen offset:3072 sc1
    v_exp_f32 v28, v28
    v_exp_f32 v29, v29
    v_exp_f32 v30, v30
    v_exp_f32 v31, v31
    v_cvt_pk_bf16_f32 v55, v26, v27
    v_cvt_pk_bf16_f32 v56, v28, v29
    s_addk_i32 s84, 4096
    v_exp_f32 v32, v32
    v_exp_f32 v33, v33
    v_exp_f32 v34, v34
    v_exp_f32_e64 v35, v35
    v_cvt_pk_bf16_f32 v57, v30, v31
    v_cvt_pk_bf16_f32 v58, v32, v33
    v_cvt_pk_bf16_f32 v59, v34, v35
    v_mfma_f32_32x32x16_bf16 v[20:35], a[112:115], a[248:251], 0
    buffer_load_dwordx4 a[160:163], v1, s[12:15], s84 offen sc1
    buffer_load_dwordx4 a[164:167], v1, s[12:15], s84 offen offset:1024 sc1
    v_exp_f32 v36, v36
    v_exp_f32 v37, v37
    v_exp_f32 v38, v38
    v_exp_f32 v39, v39
    v_cvt_pk_bf16_f32 v60, v36, v37
    v_mfma_f32_32x32x16_bf16 v[20:35], a[116:119], a[252:255], v[20:35]
    buffer_load_dwordx4 a[168:171], v195, s[12:15], s84 offen offset:2048 sc1
    v_exp_f32 v40, v40
    v_exp_f32 v41, v41
    v_exp_f32 v42, v42
    v_exp_f32 v43, v43
    v_cvt_pk_bf16_f32 v61, v38, v39
    v_cvt_pk_bf16_f32 v62, v40, v41
    s_waitcnt vmcnt(11)
    v_mfma_f32_32x32x16_bf16 v[84:99], a[120:123], v[52:55], 0
    buffer_load_dwordx4 a[172:175], v195, s[12:15], s84 offen offset:3072 sc1
    v_exp_f32 v44, v44
    v_exp_f32 v45, v45
    v_exp_f32 v46, v46
    v_exp_f32_e64 v47, v47
    v_cvt_pk_bf16_f32 v63, v42, v43
    v_cvt_pk_bf16_f32 v64, v44, v45
    v_mfma_f32_32x32x16_bf16 v[84:99], a[124:127], v[56:59], v[84:99]
    s_addk_i32 s84, 4096
    v_exp_f32 v48, v48
    v_exp_f32 v49, v49
    v_exp_f32 v50, v50
    v_exp_f32_e64 v51, v51
    v_cvt_pk_bf16_f32 v65, v46, v47
    v_cvt_pk_bf16_f32 v66, v48, v49
    v_cvt_pk_bf16_f32 v67, v50, v51
    v_mfma_f32_32x32x16_bf16 v[36:51], a[112:115], a[240:243], 0
    buffer_load_dwordx4 a[176:179], v1, s[12:15], s84 offen sc1
    buffer_load_dwordx4 a[180:183], v1, s[12:15], s84 offen offset:1024 sc1
    v_exp_f32 v20, v20
    v_exp_f32 v21, v21
    v_exp_f32 v22, v22
    v_exp_f32 v23, v23
    v_cvt_pk_bf16_f32 v52, v20, v21
    v_mfma_f32_32x32x16_bf16 v[36:51], a[116:119], a[244:247], v[36:51]
    buffer_load_dwordx4 a[184:187], v195, s[12:15], s84 offen offset:2048 sc1
    v_exp_f32 v24, v24
    v_exp_f32 v25, v25
    v_exp_f32 v26, v26
    v_exp_f32 v27, v27
    v_cvt_pk_bf16_f32 v53, v22, v23
    v_cvt_pk_bf16_f32 v54, v24, v25
    v_mfma_f32_32x32x16_bf16 v[68:83], a[120:123], v[60:63], 0
    buffer_load_dwordx4 a[188:191], v195, s[12:15], s84 offen offset:3072 sc1
    v_exp_f32 v28, v28
    v_exp_f32 v29, v29
    v_exp_f32 v30, v30
    v_exp_f32 v31, v31
    v_cvt_pk_bf16_f32 v55, v26, v27
    v_cvt_pk_bf16_f32 v56, v28, v29
    v_mfma_f32_32x32x16_bf16 v[68:83], a[124:127], v[64:67], v[68:83]
    s_addk_i32 s84, 4096
    v_exp_f32 v32, v32
    v_exp_f32 v33, v33
    v_exp_f32 v34, v34
    v_exp_f32_e64 v35, v35
    v_cvt_pk_bf16_f32 v57, v30, v31
    v_cvt_pk_bf16_f32 v58, v32, v33
    v_cvt_pk_bf16_f32 v59, v34, v35
    s_waitcnt vmcnt(8)
    v_mfma_f32_32x32x16_bf16 v[20:35], a[128:131], a[232:235], 0
    s_add_u32 m0, s100, 12288
    v_exp_f32 v36, v36
    v_exp_f32 v37, v37
    v_exp_f32 v38, v38
    v_exp_f32_e64 v39, v39
    v_cvt_pk_bf16_f32 v60, v36, v37
    v_mfma_f32_32x32x16_bf16 v[20:35], a[132:135], a[236:239], v[20:35]
    s_add_u32 s74, s91, 0
    v_exp_f32 v40, v40
    v_exp_f32 v41, v41
    v_exp_f32 v42, v42
    v_exp_f32_e64 v43, v43
    v_cvt_pk_bf16_f32 v61, v38, v39
    v_cvt_pk_bf16_f32 v62, v40, v41
    v_mfma_f32_32x32x16_bf16 v[116:131], a[120:123], v[52:55], 0
    buffer_load_dwordx4 v3, s[44:47], s74 offen lds
    v_exp_f32 v44, v44
    v_exp_f32 v45, v45
    v_exp_f32 v46, v46
    v_exp_f32 v47, v47
    v_cvt_pk_bf16_f32 v63, v42, v43
    v_cvt_pk_bf16_f32 v64, v44, v45
    v_mfma_f32_32x32x16_bf16 v[116:131], a[124:127], v[56:59], v[116:131]
    buffer_load_dwordx4 v6, s[44:47], s74 offen offset:1024 lds
    v_exp_f32 v48, v48
    v_exp_f32 v49, v49
    v_exp_f32 v50, v50
    v_exp_f32 v51, v51
    v_cvt_pk_bf16_f32 v65, v46, v47
    v_cvt_pk_bf16_f32 v66, v48, v49
    v_cvt_pk_bf16_f32 v67, v50, v51
    v_mfma_f32_32x32x16_bf16 v[36:51], a[128:131], a[224:227], 0
    s_add_u32 m0, s100, 14336
    v_exp_f32 v20, v20
    v_exp_f32 v21, v21
    v_exp_f32 v22, v22
    v_exp_f32 v23, v23
    v_cvt_pk_bf16_f32 v52, v20, v21
    v_mfma_f32_32x32x16_bf16 v[36:51], a[132:135], a[228:231], v[36:51]
    s_add_u32 s74, s91, 14336
    v_exp_f32 v24, v24
    v_exp_f32 v25, v25
    v_exp_f32 v26, v26
    v_exp_f32 v27, v27
    v_cvt_pk_bf16_f32 v53, v22, v23
    v_cvt_pk_bf16_f32 v54, v24, v25
    v_mfma_f32_32x32x16_bf16 v[100:115], a[120:123], v[60:63], 0
    buffer_load_dwordx4 v3, s[44:47], s74 offen lds
    v_exp_f32 v28, v28
    v_exp_f32 v29, v29
    v_exp_f32 v30, v30
    v_exp_f32 v31, v31
    v_cvt_pk_bf16_f32 v55, v26, v27
    v_cvt_pk_bf16_f32 v56, v28, v29
    v_mfma_f32_32x32x16_bf16 v[100:115], a[124:127], v[64:67], v[100:115]
    buffer_load_dwordx4 v6, s[44:47], s74 offen offset:1024 lds
    v_exp_f32 v32, v32
    v_exp_f32 v33, v33
    v_exp_f32 v34, v34
    v_exp_f32 v35, v35
    v_cvt_pk_bf16_f32 v57, v30, v31
    v_cvt_pk_bf16_f32 v58, v32, v33
    v_cvt_pk_bf16_f32 v59, v34, v35
    v_mfma_f32_32x32x16_bf16 v[20:35], a[128:131], a[248:251], 0
    buffer_load_dwordx4 a[112:115], v1, s[12:15], s84 offen sc1
    buffer_load_dwordx4 a[116:119], v1, s[12:15], s84 offen offset:1024 sc1
    buffer_load_dwordx4 a[120:123], v195, s[12:15], s84 offen offset:2048 sc1
    v_exp_f32 v36, v36
    v_exp_f32 v37, v37
    v_exp_f32 v38, v38
    v_exp_f32 v39, v39
    v_cvt_pk_bf16_f32 v60, v36, v37
    v_mfma_f32_32x32x16_bf16 v[20:35], a[132:135], a[252:255], v[20:35]
    buffer_load_dwordx4 a[124:127], v195, s[12:15], s84 offen offset:3072 sc1
    s_addk_i32 s84, 4096
    v_exp_f32 v40, v40
    v_exp_f32 v41, v41
    v_exp_f32 v42, v42
    v_exp_f32_e64 v43, v43
    v_cvt_pk_bf16_f32 v61, v38, v39
    v_cvt_pk_bf16_f32 v62, v40, v41
    v_mfma_f32_32x32x16_bf16 v[84:99], a[136:139], v[52:55], v[84:99]
    buffer_store_dwordx4 v[244:247], v1, s[12:15], s85 offen sc1
    s_add_u32 m0, s100, 16384
    s_add_u32 s74, s91, 28672
    v_exp_f32 v44, v44
    v_exp_f32 v45, v45
    v_exp_f32 v46, v46
    v_exp_f32 v47, v47
    v_cvt_pk_bf16_f32 v63, v42, v43
    v_cvt_pk_bf16_f32 v64, v44, v45
    v_mfma_f32_32x32x16_bf16 v[84:99], a[140:143], v[56:59], v[84:99]
    buffer_load_dwordx4 v3, s[44:47], s74 offen lds
    buffer_load_dwordx4 v6, s[44:47], s74 offen offset:1024 lds
    v_exp_f32 v48, v48
    v_exp_f32 v49, v49
    v_exp_f32 v50, v50
    v_exp_f32 v51, v51
    v_cvt_pk_bf16_f32 v65, v46, v47
    v_cvt_pk_bf16_f32 v66, v48, v49
    v_cvt_pk_bf16_f32 v67, v50, v51
    v_mfma_f32_32x32x16_bf16 v[36:51], a[128:131], a[240:243], 0
    s_add_u32 m0, s100, 18432
    v_exp_f32 v20, v20
    v_exp_f32 v21, v21
    v_exp_f32 v22, v22
    v_exp_f32 v23, v23
    v_cvt_pk_bf16_f32 v52, v20, v21
    v_mfma_f32_32x32x16_bf16 v[36:51], a[132:135], a[244:247], v[36:51]
    s_add_u32 s74, s91, 43008
    v_exp_f32 v24, v24
    v_exp_f32 v25, v25
    v_exp_f32 v26, v26
    v_exp_f32 v27, v27
    v_cvt_pk_bf16_f32 v53, v22, v23
    v_cvt_pk_bf16_f32 v54, v24, v25
    v_mfma_f32_32x32x16_bf16 v[68:83], a[136:139], v[60:63], v[68:83]
    buffer_load_dwordx4 v3, s[44:47], s74 offen lds
    v_exp_f32 v28, v28
    v_exp_f32 v29, v29
    v_exp_f32 v30, v30
    v_exp_f32 v31, v31
    v_cvt_pk_bf16_f32 v55, v26, v27
    v_cvt_pk_bf16_f32 v56, v28, v29
    v_mfma_f32_32x32x16_bf16 v[68:83], a[140:143], v[64:67], v[68:83]
    buffer_load_dwordx4 v6, s[44:47], s74 offen offset:1024 lds
    v_exp_f32 v32, v32
    v_exp_f32 v33, v33
    v_exp_f32 v34, v34
    v_exp_f32 v35, v35
    v_cvt_pk_bf16_f32 v57, v30, v31
    v_cvt_pk_bf16_f32 v58, v32, v33
    v_cvt_pk_bf16_f32 v59, v34, v35
    v_mfma_f32_32x32x16_bf16 v[20:35], a[144:147], a[232:235], 0
    s_add_u32 m0, s100, 20480
    v_exp_f32 v36, v36
    v_exp_f32 v37, v37
    v_exp_f32 v38, v38
    v_exp_f32 v39, v39
    v_cvt_pk_bf16_f32 v60, v36, v37
    v_mfma_f32_32x32x16_bf16 v[20:35], a[148:151], a[236:239], v[20:35]
    s_add_u32 s74, s91, 57344
    v_exp_f32 v40, v40
    v_exp_f32 v41, v41
    v_exp_f32 v42, v42
    v_exp_f32 v43, v43
    v_cvt_pk_bf16_f32 v61, v38, v39
    v_cvt_pk_bf16_f32 v62, v40, v41
    v_mfma_f32_32x32x16_bf16 v[116:131], a[136:139], v[52:55], v[116:131]
    buffer_load_dwordx4 v3, s[44:47], s74 offen lds
    v_exp_f32 v44, v44
    v_exp_f32 v45, v45
    v_exp_f32 v46, v46
    v_exp_f32 v47, v47
    v_cvt_pk_bf16_f32 v63, v42, v43
    v_cvt_pk_bf16_f32 v64, v44, v45
    v_mfma_f32_32x32x16_bf16 v[116:131], a[140:143], v[56:59], v[116:131]
    buffer_load_dwordx4 v6, s[44:47], s74 offen offset:1024 lds
    v_exp_f32 v48, v48
    v_exp_f32 v49, v49
    v_exp_f32 v50, v50
    v_exp_f32 v51, v51
    v_cvt_pk_bf16_f32 v65, v46, v47
    v_cvt_pk_bf16_f32 v66, v48, v49
    v_cvt_pk_bf16_f32 v67, v50, v51
    v_mfma_f32_32x32x16_bf16 v[36:51], a[144:147], a[224:227], 0
    buffer_store_dwordx4 v[244:247], v1, s[12:15], s38 offen sc1
    s_add_u32 m0, s100, 22528
    v_exp_f32 v20, v20
    v_exp_f32 v21, v21
    v_exp_f32 v22, v22
    v_exp_f32 v23, v23
    v_cvt_pk_bf16_f32 v52, v20, v21
    v_mfma_f32_32x32x16_bf16 v[36:51], a[148:151], a[228:231], v[36:51]
    s_add_u32 s74, s91, 71680
    v_exp_f32 v24, v24
    v_exp_f32 v25, v25
    v_exp_f32 v26, v26
    v_exp_f32 v27, v27
    v_cvt_pk_bf16_f32 v53, v22, v23
    v_cvt_pk_bf16_f32 v54, v24, v25
    v_mfma_f32_32x32x16_bf16 v[100:115], a[136:139], v[60:63], v[100:115]
    buffer_load_dwordx4 v3, s[44:47], s74 offen lds
    v_exp_f32 v28, v28
    v_exp_f32 v29, v29
    v_exp_f32 v30, v30
    v_exp_f32 v31, v31
    v_cvt_pk_bf16_f32 v55, v26, v27
    v_cvt_pk_bf16_f32 v56, v28, v29
    v_mfma_f32_32x32x16_bf16 v[100:115], a[140:143], v[64:67], v[100:115]
    buffer_load_dwordx4 v6, s[44:47], s74 offen offset:1024 lds
    v_exp_f32 v32, v32
    v_exp_f32 v33, v33
    v_exp_f32 v34, v34
    v_exp_f32 v35, v35
    v_cvt_pk_bf16_f32 v57, v30, v31
    v_cvt_pk_bf16_f32 v58, v32, v33
    v_cvt_pk_bf16_f32 v59, v34, v35
    v_mfma_f32_32x32x16_bf16 v[20:35], a[144:147], a[248:251], 0
    buffer_load_dwordx4 a[128:131], v1, s[12:15], s84 offen sc1
    buffer_load_dwordx4 a[132:135], v1, s[12:15], s84 offen offset:1024 sc1
    buffer_load_dwordx4 a[136:139], v195, s[12:15], s84 offen offset:2048 sc1
    v_exp_f32 v36, v36
    v_exp_f32 v37, v37
    v_exp_f32 v38, v38
    v_exp_f32 v39, v39
    v_cvt_pk_bf16_f32 v60, v36, v37
    v_mfma_f32_32x32x16_bf16 v[20:35], a[148:151], a[252:255], v[20:35]
    buffer_load_dwordx4 a[140:143], v195, s[12:15], s84 offen offset:3072 sc1
    s_addk_i32 s84, 4096
    v_exp_f32 v40, v40
    v_exp_f32 v41, v41
    v_exp_f32 v42, v42
    v_exp_f32_e64 v43, v43
    v_cvt_pk_bf16_f32 v61, v38, v39
    v_cvt_pk_bf16_f32 v62, v40, v41
    v_mfma_f32_32x32x16_bf16 v[84:99], a[152:155], v[52:55], v[84:99]
    s_add_u32 m0, s100, 24576
    s_add_u32 s74, s91, 86016
    v_exp_f32 v44, v44
    v_exp_f32 v45, v45
    v_exp_f32 v46, v46
    v_exp_f32 v47, v47
    v_cvt_pk_bf16_f32 v63, v42, v43
    v_cvt_pk_bf16_f32 v64, v44, v45
    v_mfma_f32_32x32x16_bf16 v[84:99], a[156:159], v[56:59], v[84:99]
    buffer_load_dwordx4 v3, s[44:47], s74 offen lds
    buffer_load_dwordx4 v6, s[44:47], s74 offen offset:1024 lds
    v_exp_f32 v48, v48
    v_exp_f32 v49, v49
    v_exp_f32 v50, v50
    v_exp_f32 v51, v51
    v_cvt_pk_bf16_f32 v65, v46, v47
    v_cvt_pk_bf16_f32 v66, v48, v49
    v_cvt_pk_bf16_f32 v67, v50, v51
    v_mfma_f32_32x32x16_bf16 v[36:51], a[144:147], a[240:243], 0
    s_add_u32 m0, s100, 0
    s_add_u32 s74, s92, 0
    v_exp_f32 v20, v20
    v_exp_f32 v21, v21
    v_exp_f32 v22, v22
    v_exp_f32 v23, v23
    v_cvt_pk_bf16_f32 v52, v20, v21
    v_mfma_f32_32x32x16_bf16 v[36:51], a[148:151], a[244:247], v[36:51]
    buffer_load_dwordx4 v4, s[48:51], s74 offen lds
    v_exp_f32 v24, v24
    v_exp_f32 v25, v25
    v_exp_f32 v26, v26
    v_exp_f32 v27, v27
    v_cvt_pk_bf16_f32 v53, v22, v23
    v_cvt_pk_bf16_f32 v54, v24, v25
    v_mfma_f32_32x32x16_bf16 v[68:83], a[152:155], v[60:63], v[68:83]
    buffer_load_dwordx4 v251, s[48:51], s74 offen offset:1024 lds
    buffer_load_dwordx4 v184, s[48:51], s74 offen offset:2048 lds
    v_exp_f32 v28, v28
    v_exp_f32 v29, v29
    v_exp_f32 v30, v30
    v_exp_f32 v31, v31
    v_cvt_pk_bf16_f32 v55, v26, v27
    v_cvt_pk_bf16_f32 v56, v28, v29
    v_mfma_f32_32x32x16_bf16 v[68:83], a[156:159], v[64:67], v[68:83]
    buffer_load_dwordx4 v185, s[48:51], s74 offen offset:3072 lds
    v_exp_f32 v32, v32
    v_exp_f32 v33, v33
    v_exp_f32 v34, v34
    v_exp_f32 v35, v35
    v_cvt_pk_bf16_f32 v57, v30, v31
    v_cvt_pk_bf16_f32 v58, v32, v33
    v_cvt_pk_bf16_f32 v59, v34, v35
    s_waitcnt vmcnt(28)
    v_mfma_f32_32x32x16_bf16 v[20:35], a[160:163], a[232:235], 0
    v_exp_f32 v36, v36
    v_exp_f32 v37, v37
    v_exp_f32 v38, v38
    v_exp_f32_e64 v39, v39
    v_cvt_pk_bf16_f32 v60, v36, v37
    v_mfma_f32_32x32x16_bf16 v[20:35], a[164:167], a[236:239], v[20:35]
    v_exp_f32 v40, v40
    v_exp_f32 v41, v41
    v_exp_f32 v42, v42
    v_exp_f32 v43, v43
    v_cvt_pk_bf16_f32 v61, v38, v39
    v_cvt_pk_bf16_f32 v62, v40, v41
    v_mfma_f32_32x32x16_bf16 v[116:131], a[152:155], v[52:55], v[116:131]
    v_exp_f32 v44, v44
    v_exp_f32 v45, v45
    v_exp_f32 v46, v46
    v_exp_f32 v47, v47
    v_cvt_pk_bf16_f32 v63, v42, v43
    v_cvt_pk_bf16_f32 v64, v44, v45
    v_mfma_f32_32x32x16_bf16 v[116:131], a[156:159], v[56:59], v[116:131]
    v_exp_f32 v48, v48
    v_exp_f32 v49, v49
    v_exp_f32 v50, v50
    v_exp_f32 v51, v51
    v_cvt_pk_bf16_f32 v65, v46, v47
    v_cvt_pk_bf16_f32 v66, v48, v49
    v_cvt_pk_bf16_f32 v67, v50, v51
    v_mfma_f32_32x32x16_bf16 v[36:51], a[160:163], a[224:227], 0
    buffer_store_dwordx4 v[244:247], v248, s[12:15], s87 offen sc1
    v_exp_f32 v20, v20
    v_exp_f32 v21, v21
    v_exp_f32 v22, v22
    v_exp_f32 v23, v23
    v_cvt_pk_bf16_f32 v52, v20, v21
    v_mfma_f32_32x32x16_bf16 v[36:51], a[164:167], a[228:231], v[36:51]
    v_exp_f32 v24, v24
    v_exp_f32 v25, v25
    v_exp_f32 v26, v26
    v_exp_f32 v27, v27
    v_cvt_pk_bf16_f32 v53, v22, v23
    v_cvt_pk_bf16_f32 v54, v24, v25
    v_mfma_f32_32x32x16_bf16 v[100:115], a[152:155], v[60:63], v[100:115]
    v_exp_f32 v28, v28
    v_exp_f32 v29, v29
    v_exp_f32 v30, v30
    v_exp_f32 v31, v31
    v_cvt_pk_bf16_f32 v55, v26, v27
    v_cvt_pk_bf16_f32 v56, v28, v29
    v_mfma_f32_32x32x16_bf16 v[100:115], a[156:159], v[64:67], v[100:115]
    v_exp_f32 v32, v32
    v_exp_f32 v33, v33
    v_exp_f32 v34, v34
    v_exp_f32 v35, v35
    v_cvt_pk_bf16_f32 v57, v30, v31
    v_cvt_pk_bf16_f32 v58, v32, v33
    v_cvt_pk_bf16_f32 v59, v34, v35
    v_mfma_f32_32x32x16_bf16 v[20:35], a[160:163], a[248:251], 0
    buffer_load_dwordx4 a[144:147], v1, s[12:15], s84 offen sc1
    buffer_load_dwordx4 a[148:151], v1, s[12:15], s84 offen offset:1024 sc1
    buffer_load_dwordx4 a[152:155], v195, s[12:15], s84 offen offset:2048 sc1
    v_exp_f32 v36, v36
    v_exp_f32 v37, v37
    v_exp_f32 v38, v38
    v_exp_f32 v39, v39
    v_cvt_pk_bf16_f32 v60, v36, v37
    v_mfma_f32_32x32x16_bf16 v[20:35], a[164:167], a[252:255], v[20:35]
    buffer_load_dwordx4 a[156:159], v195, s[12:15], s84 offen offset:3072 sc1
    s_addk_i32 s84, 4096
    s_add_u32 m0, s100, 4096
    v_exp_f32 v40, v40
    v_exp_f32 v41, v41
    v_exp_f32 v42, v42
    v_exp_f32_e64 v43, v43
    v_cvt_pk_bf16_f32 v61, v38, v39
    v_cvt_pk_bf16_f32 v62, v40, v41
    v_mfma_f32_32x32x16_bf16 v[84:99], a[168:171], v[52:55], v[84:99]
    s_add_u32 s74, s92, 114688
    buffer_load_dwordx4 v4, s[48:51], s74 offen lds
    buffer_load_dwordx4 v251, s[48:51], s74 offen offset:1024 lds
    v_exp_f32 v44, v44
    v_exp_f32 v45, v45
    v_exp_f32 v46, v46
    v_exp_f32 v47, v47
    v_cvt_pk_bf16_f32 v63, v42, v43
    v_cvt_pk_bf16_f32 v64, v44, v45
    v_mfma_f32_32x32x16_bf16 v[84:99], a[172:175], v[56:59], v[84:99]
    buffer_load_dwordx4 v184, s[48:51], s74 offen offset:2048 lds
    buffer_load_dwordx4 v185, s[48:51], s74 offen offset:3072 lds
    v_exp_f32 v48, v48
    v_exp_f32 v49, v49
    v_exp_f32 v50, v50
    v_exp_f32 v51, v51
    v_cvt_pk_bf16_f32 v65, v46, v47
    v_cvt_pk_bf16_f32 v66, v48, v49
    v_cvt_pk_bf16_f32 v67, v50, v51
    v_mfma_f32_32x32x16_bf16 v[36:51], a[160:163], a[240:243], 0
    v_exp_f32 v20, v20
    v_exp_f32 v21, v21
    v_exp_f32 v22, v22
    v_exp_f32 v23, v23
    v_cvt_pk_bf16_f32 v52, v20, v21
    v_mfma_f32_32x32x16_bf16 v[36:51], a[164:167], a[244:247], v[36:51]
    v_exp_f32 v24, v24
    v_exp_f32 v25, v25
    v_exp_f32 v26, v26
    v_exp_f32 v27, v27
    v_cvt_pk_bf16_f32 v53, v22, v23
    v_cvt_pk_bf16_f32 v54, v24, v25
    v_mfma_f32_32x32x16_bf16 v[68:83], a[168:171], v[60:63], v[68:83]
    v_exp_f32 v28, v28
    v_exp_f32 v29, v29
    v_exp_f32 v30, v30
    v_exp_f32 v31, v31
    v_cvt_pk_bf16_f32 v55, v26, v27
    v_cvt_pk_bf16_f32 v56, v28, v29
    v_mfma_f32_32x32x16_bf16 v[68:83], a[172:175], v[64:67], v[68:83]
    v_exp_f32 v32, v32
    v_exp_f32 v33, v33
    v_exp_f32 v34, v34
    v_exp_f32 v35, v35
    v_cvt_pk_bf16_f32 v57, v30, v31
    v_cvt_pk_bf16_f32 v58, v32, v33
    v_cvt_pk_bf16_f32 v59, v34, v35
    v_mfma_f32_32x32x16_bf16 v[20:35], a[176:179], a[232:235], 0
    buffer_store_dwordx4 v[244:247], v248, s[12:15], s39 offen sc1
    v_exp_f32 v36, v36
    v_exp_f32 v37, v37
    v_exp_f32 v38, v38
    v_exp_f32 v39, v39
    v_cvt_pk_bf16_f32 v60, v36, v37
    v_mfma_f32_32x32x16_bf16 v[20:35], a[180:183], a[236:239], v[20:35]
    v_exp_f32 v40, v40
    v_exp_f32 v41, v41
    v_exp_f32 v42, v42
    v_exp_f32 v43, v43
    v_cvt_pk_bf16_f32 v61, v38, v39
    v_cvt_pk_bf16_f32 v62, v40, v41
    v_mfma_f32_32x32x16_bf16 v[116:131], a[168:171], v[52:55], v[116:131]
    v_exp_f32 v44, v44
    v_exp_f32 v45, v45
    v_exp_f32 v46, v46
    v_exp_f32 v47, v47
    v_cvt_pk_bf16_f32 v63, v42, v43
    v_cvt_pk_bf16_f32 v64, v44, v45
    v_mfma_f32_32x32x16_bf16 v[116:131], a[172:175], v[56:59], v[116:131]
    v_exp_f32 v48, v48
    v_exp_f32 v49, v49
    v_exp_f32 v50, v50
    v_exp_f32 v51, v51
    v_cvt_pk_bf16_f32 v65, v46, v47
    v_cvt_pk_bf16_f32 v66, v48, v49
    v_cvt_pk_bf16_f32 v67, v50, v51
    v_mfma_f32_32x32x16_bf16 v[36:51], a[176:179], a[224:227], 0
    s_add_u32 m0, s100, 8192
    s_add_u32 s74, s92, 229376
    v_exp_f32 v20, v20
    v_exp_f32 v21, v21
    v_exp_f32 v22, v22
    v_exp_f32 v23, v23
    v_cvt_pk_bf16_f32 v52, v20, v21
    v_mfma_f32_32x32x16_bf16 v[36:51], a[180:183], a[228:231], v[36:51]
    buffer_load_dwordx4 v4, s[48:51], s74 offen lds
    v_exp_f32 v24, v24
    v_exp_f32 v25, v25
    v_exp_f32 v26, v26
    v_exp_f32 v27, v27
    v_cvt_pk_bf16_f32 v53, v22, v23
    v_cvt_pk_bf16_f32 v54, v24, v25
    v_mfma_f32_32x32x16_bf16 v[100:115], a[168:171], v[60:63], v[100:115]
    buffer_load_dwordx4 v251, s[48:51], s74 offen offset:1024 lds
    buffer_load_dwordx4 v184, s[48:51], s74 offen offset:2048 lds
    v_exp_f32 v28, v28
    v_exp_f32 v29, v29
    v_exp_f32 v30, v30
    v_exp_f32 v31, v31
    v_cvt_pk_bf16_f32 v55, v26, v27
    v_cvt_pk_bf16_f32 v56, v28, v29
    v_mfma_f32_32x32x16_bf16 v[100:115], a[172:175], v[64:67], v[100:115]
    buffer_load_dwordx4 v185, s[48:51], s74 offen offset:3072 lds
    v_exp_f32 v32, v32
    v_exp_f32 v33, v33
    v_exp_f32 v34, v34
    v_exp_f32 v35, v35
    v_cvt_pk_bf16_f32 v57, v30, v31
    v_cvt_pk_bf16_f32 v58, v32, v33
    v_cvt_pk_bf16_f32 v59, v34, v35
    v_mfma_f32_32x32x16_bf16 v[20:35], a[176:179], a[248:251], 0
    buffer_load_dwordx4 a[160:163], v1, s[12:15], s84 offen sc1
    buffer_load_dwordx4 a[164:167], v1, s[12:15], s84 offen offset:1024 sc1
    buffer_load_dwordx4 a[168:171], v195, s[12:15], s84 offen offset:2048 sc1
    v_exp_f32 v36, v36
    v_exp_f32 v37, v37
    v_exp_f32 v38, v38
    v_exp_f32 v39, v39
    v_cvt_pk_bf16_f32 v60, v36, v37
    v_mfma_f32_32x32x16_bf16 v[20:35], a[180:183], a[252:255], v[20:35]
    buffer_load_dwordx4 a[172:175], v195, s[12:15], s84 offen offset:3072 sc1
    s_addk_i32 s84, 4096
    v_exp_f32 v40, v40
    v_exp_f32 v41, v41
    v_exp_f32 v42, v42
    v_exp_f32_e64 v43, v43
    v_cvt_pk_bf16_f32 v61, v38, v39
    v_cvt_pk_bf16_f32 v62, v40, v41
    v_mfma_f32_32x32x16_bf16 v[84:99], a[184:187], v[52:55], v[84:99]
    s_waitcnt vmcnt(18)
    ds_read_b64_tr_b16 a[0:1], v5 offset:0
    ds_read_b64_tr_b16 a[2:3], v5 offset:1024
    v_exp_f32 v44, v44
    v_exp_f32 v45, v45
    v_exp_f32 v46, v46
    v_exp_f32_e64 v47, v47
    v_cvt_pk_bf16_f32 v63, v42, v43
    v_cvt_pk_bf16_f32 v64, v44, v45
    v_mfma_f32_32x32x16_bf16 v[84:99], a[188:191], v[56:59], v[84:99]
    ds_read_b64_tr_b16 a[4:5], v250 offset:0
    ds_read_b64_tr_b16 a[6:7], v250 offset:1024
    v_exp_f32 v48, v48
    v_exp_f32 v49, v49
    v_exp_f32 v50, v50
    v_exp_f32 v51, v51
    v_cvt_pk_bf16_f32 v65, v46, v47
    v_cvt_pk_bf16_f32 v66, v48, v49
    v_cvt_pk_bf16_f32 v67, v50, v51
    v_mfma_f32_32x32x16_bf16 v[36:51], a[176:179], a[240:243], 0
    ds_read_b64_tr_b16 a[8:9], v5 offset:2048
    v_exp_f32 v20, v20
    v_exp_f32 v21, v21
    v_exp_f32 v22, v22
    v_exp_f32 v23, v23
    v_cvt_pk_bf16_f32 v52, v20, v21
    v_mfma_f32_32x32x16_bf16 v[36:51], a[180:183], a[244:247], v[36:51]
    ds_read_b64_tr_b16 a[10:11], v5 offset:3072
    v_exp_f32 v24, v24
    v_exp_f32 v25, v25
    v_exp_f32 v26, v26
    v_exp_f32 v27, v27
    v_cvt_pk_bf16_f32 v53, v22, v23
    v_cvt_pk_bf16_f32 v54, v24, v25
    v_mfma_f32_32x32x16_bf16 v[68:83], a[184:187], v[60:63], v[68:83]
    ds_read_b64_tr_b16 a[12:13], v250 offset:2048
    v_exp_f32 v28, v28
    v_exp_f32 v29, v29
    v_exp_f32 v30, v30
    v_exp_f32 v31, v31
    v_cvt_pk_bf16_f32 v55, v26, v27
    v_cvt_pk_bf16_f32 v56, v28, v29
    v_mfma_f32_32x32x16_bf16 v[68:83], a[188:191], v[64:67], v[68:83]
    ds_read_b64_tr_b16 a[14:15], v250 offset:3072
    v_exp_f32 v32, v32
    v_exp_f32 v33, v33
    v_exp_f32 v34, v34
    v_exp_f32 v35, v35
    v_cvt_pk_bf16_f32 v57, v30, v31
    v_cvt_pk_bf16_f32 v58, v32, v33
    v_cvt_pk_bf16_f32 v59, v34, v35
    v_mfma_f32_32x32x16_bf16 v[20:35], a[112:115], a[232:235], 0
    buffer_store_dwordx4 v[244:247], v248, s[12:15], s89 offen sc1
    s_waitcnt lgkmcnt(0)
    v_exp_f32 v36, v36
    v_exp_f32 v37, v37
    v_exp_f32 v38, v38
    v_exp_f32_e64 v39, v39
    v_cvt_pk_bf16_f32 v60, v36, v37
    v_mfma_f32_32x32x16_bf16 v[20:35], a[116:119], a[236:239], v[20:35]
    s_add_u32 m0, s100, 0
    s_add_u32 s74, s92, 344064
    v_exp_f32 v40, v40
    v_exp_f32 v41, v41
    v_exp_f32 v42, v42
    v_exp_f32_e64 v43, v43
    v_cvt_pk_bf16_f32 v61, v38, v39
    v_cvt_pk_bf16_f32 v62, v40, v41
    v_mfma_f32_32x32x16_bf16 v[116:131], a[184:187], v[52:55], v[116:131]
    buffer_load_dwordx4 v4, s[48:51], s74 offen lds
    buffer_load_dwordx4 v251, s[48:51], s74 offen offset:1024 lds
    v_exp_f32 v44, v44
    v_exp_f32 v45, v45
    v_exp_f32 v46, v46
    v_exp_f32 v47, v47
    v_cvt_pk_bf16_f32 v63, v42, v43
    v_cvt_pk_bf16_f32 v64, v44, v45
    v_mfma_f32_32x32x16_bf16 v[116:131], a[188:191], v[56:59], v[116:131]
    buffer_load_dwordx4 v184, s[48:51], s74 offen offset:2048 lds
    buffer_load_dwordx4 v185, s[48:51], s74 offen offset:3072 lds
    v_exp_f32 v48, v48
    v_exp_f32 v49, v49
    v_exp_f32 v50, v50
    v_exp_f32 v51, v51
    v_cvt_pk_bf16_f32 v65, v46, v47
    v_cvt_pk_bf16_f32 v66, v48, v49
    v_cvt_pk_bf16_f32 v67, v50, v51
    v_mfma_f32_32x32x16_bf16 v[36:51], a[112:115], a[224:227], 0
    s_waitcnt vmcnt(14)
    ds_read_b64_tr_b16 a[16:17], v5 offset:4096
    v_exp_f32 v20, v20
    v_exp_f32 v21, v21
    v_exp_f32 v22, v22
    v_exp_f32_e64 v23, v23
    v_cvt_pk_bf16_f32 v52, v20, v21
    v_mfma_f32_32x32x16_bf16 v[36:51], a[116:119], a[228:231], v[36:51]
    ds_read_b64_tr_b16 a[18:19], v5 offset:5120
    v_exp_f32 v24, v24
    v_exp_f32 v25, v25
    v_exp_f32 v26, v26
    v_exp_f32 v27, v27
    v_cvt_pk_bf16_f32 v53, v22, v23
    v_cvt_pk_bf16_f32 v54, v24, v25
    v_mfma_f32_32x32x16_bf16 v[100:115], a[184:187], v[60:63], v[100:115]
    ds_read_b64_tr_b16 a[20:21], v250 offset:4096
    v_exp_f32 v28, v28
    v_exp_f32 v29, v29
    v_exp_f32 v30, v30
    v_exp_f32 v31, v31
    v_cvt_pk_bf16_f32 v55, v26, v27
    v_cvt_pk_bf16_f32 v56, v28, v29
    v_mfma_f32_32x32x16_bf16 v[100:115], a[188:191], v[64:67], v[100:115]
    ds_read_b64_tr_b16 a[22:23], v250 offset:5120
    v_exp_f32 v32, v32
    v_exp_f32 v33, v33
    v_exp_f32 v34, v34
    v_exp_f32 v35, v35
    v_cvt_pk_bf16_f32 v57, v30, v31
    v_cvt_pk_bf16_f32 v58, v32, v33
    v_cvt_pk_bf16_f32 v59, v34, v35
    v_mfma_f32_32x32x16_bf16 v[20:35], a[112:115], a[248:251], 0
    buffer_load_dwordx4 a[176:179], v1, s[12:15], s84 offen sc1
    buffer_load_dwordx4 a[180:183], v1, s[12:15], s84 offen offset:1024 sc1
    buffer_load_dwordx4 a[184:187], v195, s[12:15], s84 offen offset:2048 sc1
    v_exp_f32 v36, v36
    v_exp_f32 v37, v37
    v_exp_f32 v38, v38
    v_exp_f32 v39, v39
    v_cvt_pk_bf16_f32 v60, v36, v37
    v_mfma_f32_32x32x16_bf16 v[20:35], a[116:119], a[252:255], v[20:35]
    buffer_load_dwordx4 a[188:191], v195, s[12:15], s84 offen offset:3072 sc1
    s_addk_i32 s84, 4096
    v_exp_f32 v40, v40
    v_exp_f32 v41, v41
    v_exp_f32 v42, v42
    v_exp_f32_e64 v43, v43
    v_cvt_pk_bf16_f32 v61, v38, v39
    v_cvt_pk_bf16_f32 v62, v40, v41
    v_mfma_f32_32x32x16_bf16 v[84:99], a[120:123], v[52:55], v[84:99]
    ds_read_b64_tr_b16 a[24:25], v5 offset:6144
    ds_read_b64_tr_b16 a[26:27], v5 offset:7168
    v_exp_f32 v44, v44
    v_exp_f32 v45, v45
    v_exp_f32 v46, v46
    v_exp_f32 v47, v47
    v_cvt_pk_bf16_f32 v63, v42, v43
    v_cvt_pk_bf16_f32 v64, v44, v45
    v_mfma_f32_32x32x16_bf16 v[84:99], a[124:127], v[56:59], v[84:99]
    ds_read_b64_tr_b16 a[28:29], v250 offset:6144
    ds_read_b64_tr_b16 a[30:31], v250 offset:7168
    v_exp_f32 v48, v48
    v_exp_f32 v49, v49
    v_exp_f32 v50, v50
    v_exp_f32 v51, v51
    v_cvt_pk_bf16_f32 v65, v46, v47
    v_cvt_pk_bf16_f32 v66, v48, v49
    v_cvt_pk_bf16_f32 v67, v50, v51
    v_mfma_f32_32x32x16_bf16 v[36:51], a[112:115], a[240:243], 0
    buffer_store_dwordx4 v[244:247], v248, s[12:15], s89 offen offset:1024 sc1
    s_waitcnt lgkmcnt(0)
    v_exp_f32 v20, v20
    v_exp_f32 v21, v21
    v_exp_f32 v22, v22
    v_exp_f32_e64 v23, v23
    v_cvt_pk_bf16_f32 v52, v20, v21
    v_mfma_f32_32x32x16_bf16 v[36:51], a[116:119], a[244:247], v[36:51]
    s_add_u32 m0, s100, 4096
    s_add_u32 s74, s92, 458752
    v_exp_f32 v24, v24
    v_exp_f32 v25, v25
    v_exp_f32 v26, v26
    v_exp_f32 v27, v27
    v_cvt_pk_bf16_f32 v53, v22, v23
    v_cvt_pk_bf16_f32 v54, v24, v25
    v_mfma_f32_32x32x16_bf16 v[68:83], a[120:123], v[60:63], v[68:83]
    buffer_load_dwordx4 v4, s[48:51], s74 offen lds
    buffer_load_dwordx4 v251, s[48:51], s74 offen offset:1024 lds
    v_exp_f32 v28, v28
    v_exp_f32 v29, v29
    v_exp_f32 v30, v30
    v_exp_f32 v31, v31
    v_cvt_pk_bf16_f32 v55, v26, v27
    v_cvt_pk_bf16_f32 v56, v28, v29
    v_mfma_f32_32x32x16_bf16 v[68:83], a[124:127], v[64:67], v[68:83]
    buffer_load_dwordx4 v184, s[48:51], s74 offen offset:2048 lds
    buffer_load_dwordx4 v185, s[48:51], s74 offen offset:3072 lds
    v_exp_f32 v32, v32
    v_exp_f32 v33, v33
    v_exp_f32 v34, v34
    v_exp_f32 v35, v35
    v_cvt_pk_bf16_f32 v57, v30, v31
    v_cvt_pk_bf16_f32 v58, v32, v33
    v_cvt_pk_bf16_f32 v59, v34, v35
    v_mfma_f32_32x32x16_bf16 v[20:35], a[128:131], a[232:235], 0
    s_waitcnt vmcnt(18)
    ds_read_b64_tr_b16 a[32:33], v5 offset:8192
    v_exp_f32 v36, v36
    v_exp_f32 v37, v37
    v_exp_f32 v38, v38
    v_exp_f32_e64 v39, v39
    v_cvt_pk_bf16_f32 v60, v36, v37
    v_mfma_f32_32x32x16_bf16 v[20:35], a[132:135], a[236:239], v[20:35]
    ds_read_b64_tr_b16 a[34:35], v5 offset:9216
    v_exp_f32 v40, v40
    v_exp_f32 v41, v41
    v_exp_f32 v42, v42
    v_exp_f32 v43, v43
    v_cvt_pk_bf16_f32 v61, v38, v39
    v_cvt_pk_bf16_f32 v62, v40, v41
    v_mfma_f32_32x32x16_bf16 v[116:131], a[120:123], v[52:55], v[116:131]
    ds_read_b64_tr_b16 a[36:37], v250 offset:8192
    v_exp_f32 v44, v44
    v_exp_f32 v45, v45
    v_exp_f32 v46, v46
    v_exp_f32 v47, v47
    v_cvt_pk_bf16_f32 v63, v42, v43
    v_cvt_pk_bf16_f32 v64, v44, v45
    v_mfma_f32_32x32x16_bf16 v[116:131], a[124:127], v[56:59], v[116:131]
    ds_read_b64_tr_b16 a[38:39], v250 offset:9216
    v_exp_f32 v48, v48
    v_exp_f32 v49, v49
    v_exp_f32 v50, v50
    v_exp_f32 v51, v51
    v_cvt_pk_bf16_f32 v65, v46, v47
    v_cvt_pk_bf16_f32 v66, v48, v49
    v_cvt_pk_bf16_f32 v67, v50, v51
    v_mfma_f32_32x32x16_bf16 v[36:51], a[128:131], a[224:227], 0
    ds_read_b64_tr_b16 a[40:41], v5 offset:10240
    v_exp_f32 v20, v20
    v_exp_f32 v21, v21
    v_exp_f32 v22, v22
    v_exp_f32 v23, v23
    v_cvt_pk_bf16_f32 v52, v20, v21
    v_mfma_f32_32x32x16_bf16 v[36:51], a[132:135], a[228:231], v[36:51]
    ds_read_b64_tr_b16 a[42:43], v5 offset:11264
    v_exp_f32 v24, v24
    v_exp_f32 v25, v25
    v_exp_f32 v26, v26
    v_exp_f32 v27, v27
    v_cvt_pk_bf16_f32 v53, v22, v23
    v_cvt_pk_bf16_f32 v54, v24, v25
    v_mfma_f32_32x32x16_bf16 v[100:115], a[120:123], v[60:63], v[100:115]
    ds_read_b64_tr_b16 a[44:45], v250 offset:10240
    v_exp_f32 v28, v28
    v_exp_f32 v29, v29
    v_exp_f32 v30, v30
    v_exp_f32 v31, v31
    v_cvt_pk_bf16_f32 v55, v26, v27
    v_cvt_pk_bf16_f32 v56, v28, v29
    v_mfma_f32_32x32x16_bf16 v[100:115], a[124:127], v[64:67], v[100:115]
    ds_read_b64_tr_b16 a[46:47], v250 offset:11264
    v_exp_f32 v32, v32
    v_exp_f32 v33, v33
    v_exp_f32 v34, v34
    v_exp_f32 v35, v35
    v_cvt_pk_bf16_f32 v57, v30, v31
    v_cvt_pk_bf16_f32 v58, v32, v33
    v_cvt_pk_bf16_f32 v59, v34, v35
    v_mfma_f32_32x32x16_bf16 v[20:35], a[128:131], a[248:251], 0
    buffer_load_dwordx4 a[112:115], v1, s[12:15], s84 offen sc1
    buffer_load_dwordx4 a[116:119], v1, s[12:15], s84 offen offset:1024 sc1
    buffer_load_dwordx4 a[120:123], v195, s[12:15], s84 offen offset:2048 sc1
    v_exp_f32 v36, v36
    v_exp_f32 v37, v37
    v_exp_f32 v38, v38
    v_exp_f32 v39, v39
    v_cvt_pk_bf16_f32 v60, v36, v37
    v_mfma_f32_32x32x16_bf16 v[20:35], a[132:135], a[252:255], v[20:35]
    buffer_load_dwordx4 a[124:127], v195, s[12:15], s84 offen offset:3072 sc1
    s_addk_i32 s84, 4096
    s_waitcnt lgkmcnt(0)
    v_exp_f32 v40, v40
    v_exp_f32 v41, v41
    v_exp_f32 v42, v42
    v_exp_f32 v43, v43
    v_cvt_pk_bf16_f32 v61, v38, v39
    v_cvt_pk_bf16_f32 v62, v40, v41
    v_mfma_f32_32x32x16_bf16 v[84:99], a[136:139], v[52:55], v[84:99]
    s_add_u32 m0, s100, 8192
    s_add_u32 s74, s92, 573440
    buffer_load_dwordx4 v4, s[48:51], s74 offen lds
    v_exp_f32 v44, v44
    v_exp_f32 v45, v45
    v_exp_f32 v46, v46
    v_exp_f32 v47, v47
    v_cvt_pk_bf16_f32 v63, v42, v43
    v_cvt_pk_bf16_f32 v64, v44, v45
    v_mfma_f32_32x32x16_bf16 v[84:99], a[140:143], v[56:59], v[84:99]
    buffer_load_dwordx4 v251, s[48:51], s74 offen offset:1024 lds
    buffer_load_dwordx4 v184, s[48:51], s74 offen offset:2048 lds
    buffer_load_dwordx4 v185, s[48:51], s74 offen offset:3072 lds
    v_exp_f32 v48, v48
    v_exp_f32 v49, v49
    v_exp_f32 v50, v50
    v_exp_f32 v51, v51
    v_cvt_pk_bf16_f32 v65, v46, v47
    v_cvt_pk_bf16_f32 v66, v48, v49
    v_cvt_pk_bf16_f32 v67, v50, v51
    v_mfma_f32_32x32x16_bf16 v[36:51], a[128:131], a[240:243], 0
    buffer_store_dwordx4 v[244:247], v248, s[12:15], s89 offen offset:2048 sc1
    s_waitcnt vmcnt(18)
    v_exp_f32 v20, v20
    v_exp_f32 v21, v21
    v_exp_f32 v22, v22
    v_exp_f32_e64 v23, v23
    v_cvt_pk_bf16_f32 v52, v20, v21
    v_mfma_f32_32x32x16_bf16 v[36:51], a[132:135], a[244:247], v[36:51]
    ds_read_b64_tr_b16 a[48:49], v5 offset:0
    v_exp_f32 v24, v24
    v_exp_f32 v25, v25
    v_exp_f32 v26, v26
    v_exp_f32 v27, v27
    v_cvt_pk_bf16_f32 v53, v22, v23
    v_cvt_pk_bf16_f32 v54, v24, v25
    v_mfma_f32_32x32x16_bf16 v[68:83], a[136:139], v[60:63], v[68:83]
    ds_read_b64_tr_b16 a[50:51], v5 offset:1024
    ds_read_b64_tr_b16 a[52:53], v250 offset:0
    v_exp_f32 v28, v28
    v_exp_f32 v29, v29
    v_exp_f32 v30, v30
    v_exp_f32 v31, v31
    v_cvt_pk_bf16_f32 v55, v26, v27
    v_cvt_pk_bf16_f32 v56, v28, v29
    v_mfma_f32_32x32x16_bf16 v[68:83], a[140:143], v[64:67], v[68:83]
    ds_read_b64_tr_b16 a[54:55], v250 offset:1024
    v_exp_f32 v32, v32
    v_exp_f32 v33, v33
    v_exp_f32 v34, v34
    v_exp_f32 v35, v35
    v_cvt_pk_bf16_f32 v57, v30, v31
    v_cvt_pk_bf16_f32 v58, v32, v33
    v_cvt_pk_bf16_f32 v59, v34, v35
    v_mfma_f32_32x32x16_bf16 v[20:35], a[144:147], a[232:235], 0
    ds_read_b64_tr_b16 a[56:57], v5 offset:2048
    v_exp_f32 v36, v36
    v_exp_f32 v37, v37
    v_exp_f32 v38, v38
    v_exp_f32 v39, v39
    v_cvt_pk_bf16_f32 v60, v36, v37
    v_mfma_f32_32x32x16_bf16 v[20:35], a[148:151], a[236:239], v[20:35]
    ds_read_b64_tr_b16 a[58:59], v5 offset:3072
    v_exp_f32 v40, v40
    v_exp_f32 v41, v41
    v_exp_f32 v42, v42
    v_exp_f32 v43, v43
    v_cvt_pk_bf16_f32 v61, v38, v39
    v_cvt_pk_bf16_f32 v62, v40, v41
    v_mfma_f32_32x32x16_bf16 v[116:131], a[136:139], v[52:55], v[116:131]
    ds_read_b64_tr_b16 a[60:61], v250 offset:2048
    v_exp_f32 v44, v44
    v_exp_f32 v45, v45
    v_exp_f32 v46, v46
    v_exp_f32 v47, v47
    v_cvt_pk_bf16_f32 v63, v42, v43
    v_cvt_pk_bf16_f32 v64, v44, v45
    v_mfma_f32_32x32x16_bf16 v[116:131], a[140:143], v[56:59], v[116:131]
    ds_read_b64_tr_b16 a[62:63], v250 offset:3072
    v_exp_f32 v48, v48
    v_exp_f32 v49, v49
    v_exp_f32 v50, v50
    v_exp_f32 v51, v51
    v_cvt_pk_bf16_f32 v65, v46, v47
    v_cvt_pk_bf16_f32 v66, v48, v49
    v_cvt_pk_bf16_f32 v67, v50, v51
    v_mfma_f32_32x32x16_bf16 v[36:51], a[144:147], a[224:227], 0
    s_waitcnt lgkmcnt(0)
    s_add_u32 m0, s100, 0
    v_exp_f32 v20, v20
    v_exp_f32 v21, v21
    v_exp_f32 v22, v22
    v_exp_f32 v23, v23
    v_cvt_pk_bf16_f32 v52, v20, v21
    v_mfma_f32_32x32x16_bf16 v[36:51], a[148:151], a[228:231], v[36:51]
    s_add_u32 s74, s92, 688128
    buffer_load_dwordx4 v4, s[48:51], s74 offen lds
    v_exp_f32 v24, v24
    v_exp_f32 v25, v25
    v_exp_f32 v26, v26
    v_exp_f32 v27, v27
    v_cvt_pk_bf16_f32 v53, v22, v23
    v_cvt_pk_bf16_f32 v54, v24, v25
    v_mfma_f32_32x32x16_bf16 v[100:115], a[136:139], v[60:63], v[100:115]
    buffer_load_dwordx4 v251, s[48:51], s74 offen offset:1024 lds
    buffer_load_dwordx4 v184, s[48:51], s74 offen offset:2048 lds
    v_exp_f32 v28, v28
    v_exp_f32 v29, v29
    v_exp_f32 v30, v30
    v_exp_f32 v31, v31
    v_cvt_pk_bf16_f32 v55, v26, v27
    v_cvt_pk_bf16_f32 v56, v28, v29
    v_mfma_f32_32x32x16_bf16 v[100:115], a[140:143], v[64:67], v[100:115]
    buffer_load_dwordx4 v185, s[48:51], s74 offen offset:3072 lds
    v_exp_f32 v32, v32
    v_exp_f32 v33, v33
    v_exp_f32 v34, v34
    v_exp_f32 v35, v35
    v_cvt_pk_bf16_f32 v57, v30, v31
    v_cvt_pk_bf16_f32 v58, v32, v33
    v_cvt_pk_bf16_f32 v59, v34, v35
    v_mfma_f32_32x32x16_bf16 v[20:35], a[144:147], a[248:251], 0
    buffer_load_dwordx4 a[128:131], v1, s[12:15], s84 offen sc1
    buffer_load_dwordx4 a[132:135], v1, s[12:15], s84 offen offset:1024 sc1
    buffer_load_dwordx4 a[136:139], v195, s[12:15], s84 offen offset:2048 sc1
    v_exp_f32 v36, v36
    v_exp_f32 v37, v37
    v_exp_f32 v38, v38
    v_exp_f32 v39, v39
    v_cvt_pk_bf16_f32 v60, v36, v37
    v_mfma_f32_32x32x16_bf16 v[20:35], a[148:151], a[252:255], v[20:35]
    buffer_load_dwordx4 a[140:143], v195, s[12:15], s84 offen offset:3072 sc1
    s_addk_i32 s84, 4096
    buffer_store_dwordx4 v[244:247], v248, s[12:15], s89 offen offset:3072 sc1
    v_exp_f32 v40, v40
    v_exp_f32 v41, v41
    v_exp_f32 v42, v42
    v_exp_f32_e64 v43, v43
    v_cvt_pk_bf16_f32 v61, v38, v39
    v_cvt_pk_bf16_f32 v62, v40, v41
    v_mfma_f32_32x32x16_bf16 v[84:99], a[152:155], v[52:55], v[84:99]
    s_waitcnt vmcnt(18)
    ds_read_b64_tr_b16 a[64:65], v5 offset:4096
    ds_read_b64_tr_b16 a[66:67], v5 offset:5120
    v_exp_f32 v44, v44
    v_exp_f32 v45, v45
    v_exp_f32 v46, v46
    v_exp_f32_e64 v47, v47
    v_cvt_pk_bf16_f32 v63, v42, v43
    v_cvt_pk_bf16_f32 v64, v44, v45
    v_mfma_f32_32x32x16_bf16 v[84:99], a[156:159], v[56:59], v[84:99]
    ds_read_b64_tr_b16 a[68:69], v250 offset:4096
    ds_read_b64_tr_b16 a[70:71], v250 offset:5120
    v_exp_f32 v48, v48
    v_exp_f32 v49, v49
    v_exp_f32 v50, v50
    v_exp_f32 v51, v51
    v_cvt_pk_bf16_f32 v65, v46, v47
    v_cvt_pk_bf16_f32 v66, v48, v49
    v_cvt_pk_bf16_f32 v67, v50, v51
    v_mfma_f32_32x32x16_bf16 v[36:51], a[144:147], a[240:243], 0
    ds_read_b64_tr_b16 a[72:73], v5 offset:6144
    v_exp_f32 v20, v20
    v_exp_f32 v21, v21
    v_exp_f32 v22, v22
    v_exp_f32 v23, v23
    v_cvt_pk_bf16_f32 v52, v20, v21
    v_mfma_f32_32x32x16_bf16 v[36:51], a[148:151], a[244:247], v[36:51]
    ds_read_b64_tr_b16 a[74:75], v5 offset:7168
    v_exp_f32 v24, v24
    v_exp_f32 v25, v25
    v_exp_f32 v26, v26
    v_exp_f32 v27, v27
    v_cvt_pk_bf16_f32 v53, v22, v23
    v_cvt_pk_bf16_f32 v54, v24, v25
    v_mfma_f32_32x32x16_bf16 v[68:83], a[152:155], v[60:63], v[68:83]
    ds_read_b64_tr_b16 a[76:77], v250 offset:6144
    v_exp_f32 v28, v28
    v_exp_f32 v29, v29
    v_exp_f32 v30, v30
    v_exp_f32 v31, v31
    v_cvt_pk_bf16_f32 v55, v26, v27
    v_cvt_pk_bf16_f32 v56, v28, v29
    v_mfma_f32_32x32x16_bf16 v[68:83], a[156:159], v[64:67], v[68:83]
    ds_read_b64_tr_b16 a[78:79], v250 offset:7168
    v_exp_f32 v32, v32
    v_exp_f32 v33, v33
    v_exp_f32 v34, v34
    v_exp_f32 v35, v35
    v_cvt_pk_bf16_f32 v57, v30, v31
    v_cvt_pk_bf16_f32 v58, v32, v33
    v_cvt_pk_bf16_f32 v59, v34, v35
    v_mfma_f32_32x32x16_bf16 v[20:35], a[160:163], a[232:235], 0
    s_waitcnt lgkmcnt(0)
    s_add_u32 m0, s100, 4096
    v_exp_f32 v36, v36
    v_exp_f32 v37, v37
    v_exp_f32 v38, v38
    v_exp_f32_e64 v39, v39
    v_cvt_pk_bf16_f32 v60, v36, v37
    v_mfma_f32_32x32x16_bf16 v[20:35], a[164:167], a[236:239], v[20:35]
    s_add_u32 s74, s92, 1089536
    v_exp_f32 v40, v40
    v_exp_f32 v41, v41
    v_exp_f32 v42, v42
    v_exp_f32 v43, v43
    v_cvt_pk_bf16_f32 v61, v38, v39
    v_cvt_pk_bf16_f32 v62, v40, v41
    v_mfma_f32_32x32x16_bf16 v[116:131], a[152:155], v[52:55], v[116:131]
    buffer_load_dwordx4 v4, s[48:51], s74 offen lds
    v_exp_f32 v44, v44
    v_exp_f32 v45, v45
    v_exp_f32 v46, v46
    v_exp_f32 v47, v47
    v_cvt_pk_bf16_f32 v63, v42, v43
    v_cvt_pk_bf16_f32 v64, v44, v45
    v_mfma_f32_32x32x16_bf16 v[116:131], a[156:159], v[56:59], v[116:131]
    buffer_load_dwordx4 v251, s[48:51], s74 offen offset:1024 lds
    v_exp_f32 v48, v48
    v_exp_f32 v49, v49
    v_exp_f32 v50, v50
    v_exp_f32 v51, v51
    v_cvt_pk_bf16_f32 v65, v46, v47
    v_cvt_pk_bf16_f32 v66, v48, v49
    v_cvt_pk_bf16_f32 v67, v50, v51
    v_mfma_f32_32x32x16_bf16 v[36:51], a[160:163], a[224:227], 0
    s_waitcnt vmcnt(12)
    ds_read_b64_tr_b16 a[80:81], v5 offset:8192
    v_exp_f32 v20, v20
    v_exp_f32 v21, v21
    v_exp_f32 v22, v22
    v_exp_f32_e64 v23, v23
    v_cvt_pk_bf16_f32 v52, v20, v21
    v_mfma_f32_32x32x16_bf16 v[36:51], a[164:167], a[228:231], v[36:51]
    ds_read_b64_tr_b16 a[82:83], v5 offset:9216
    v_exp_f32 v24, v24
    v_exp_f32 v25, v25
    v_exp_f32 v26, v26
    v_exp_f32 v27, v27
    v_cvt_pk_bf16_f32 v53, v22, v23
    v_cvt_pk_bf16_f32 v54, v24, v25
    v_mfma_f32_32x32x16_bf16 v[100:115], a[152:155], v[60:63], v[100:115]
    ds_read_b64_tr_b16 a[84:85], v250 offset:8192
    v_exp_f32 v28, v28
    v_exp_f32 v29, v29
    v_exp_f32 v30, v30
    v_exp_f32 v31, v31
    v_cvt_pk_bf16_f32 v55, v26, v27
    v_cvt_pk_bf16_f32 v56, v28, v29
    v_mfma_f32_32x32x16_bf16 v[100:115], a[156:159], v[64:67], v[100:115]
    ds_read_b64_tr_b16 a[86:87], v250 offset:9216
    v_exp_f32 v32, v32
    v_exp_f32 v33, v33
    v_exp_f32 v34, v34
    v_exp_f32 v35, v35
    v_cvt_pk_bf16_f32 v57, v30, v31
    v_cvt_pk_bf16_f32 v58, v32, v33
    v_cvt_pk_bf16_f32 v59, v34, v35
    v_mfma_f32_32x32x16_bf16 v[20:35], a[160:163], a[248:251], 0
    buffer_load_dwordx4 a[144:147], v1, s[12:15], s84 offen sc1
    buffer_load_dwordx4 a[148:151], v1, s[12:15], s84 offen offset:1024 sc1
    buffer_load_dwordx4 a[152:155], v195, s[12:15], s84 offen offset:2048 sc1
    v_exp_f32 v36, v36
    v_exp_f32 v37, v37
    v_exp_f32 v38, v38
    v_exp_f32 v39, v39
    v_cvt_pk_bf16_f32 v60, v36, v37
    v_mfma_f32_32x32x16_bf16 v[20:35], a[164:167], a[252:255], v[20:35]
    buffer_load_dwordx4 a[156:159], v195, s[12:15], s84 offen offset:3072 sc1
    s_addk_i32 s84, 4096
    v_exp_f32 v40, v40
    v_exp_f32 v41, v41
    v_exp_f32 v42, v42
    v_exp_f32_e64 v43, v43
    v_cvt_pk_bf16_f32 v61, v38, v39
    v_cvt_pk_bf16_f32 v62, v40, v41
    v_mfma_f32_32x32x16_bf16 v[84:99], a[168:171], v[52:55], v[84:99]
    buffer_store_dwordx4 v[244:247], v248, s[12:15], s33 offen sc1
    ds_read_b64_tr_b16 a[88:89], v5 offset:10240
    ds_read_b64_tr_b16 a[90:91], v5 offset:11264
    v_exp_f32 v44, v44
    v_exp_f32 v45, v45
    v_exp_f32 v46, v46
    v_exp_f32 v47, v47
    v_cvt_pk_bf16_f32 v63, v42, v43
    v_cvt_pk_bf16_f32 v64, v44, v45
    v_mfma_f32_32x32x16_bf16 v[84:99], a[172:175], v[56:59], v[84:99]
    ds_read_b64_tr_b16 a[92:93], v250 offset:10240
    ds_read_b64_tr_b16 a[94:95], v250 offset:11264
    v_exp_f32 v48, v48
    v_exp_f32 v49, v49
    v_exp_f32 v50, v50
    v_exp_f32 v51, v51
    v_cvt_pk_bf16_f32 v65, v46, v47
    v_cvt_pk_bf16_f32 v66, v48, v49
    v_cvt_pk_bf16_f32 v67, v50, v51
    v_mfma_f32_32x32x16_bf16 v[36:51], a[160:163], a[240:243], 0
    s_waitcnt lgkmcnt(0)
    s_add_u32 m0, s100, 8192
    v_exp_f32 v20, v20
    v_exp_f32 v21, v21
    v_exp_f32 v22, v22
    v_exp_f32_e64 v23, v23
    v_cvt_pk_bf16_f32 v52, v20, v21
    v_mfma_f32_32x32x16_bf16 v[36:51], a[164:167], a[244:247], v[36:51]
    s_add_u32 s74, s92, 1146880
    buffer_load_dwordx4 v4, s[48:51], s74 offen lds
    v_exp_f32 v24, v24
    v_exp_f32 v25, v25
    v_exp_f32 v26, v26
    v_exp_f32 v27, v27
    v_cvt_pk_bf16_f32 v53, v22, v23
    v_cvt_pk_bf16_f32 v54, v24, v25
    v_mfma_f32_32x32x16_bf16 v[68:83], a[168:171], v[60:63], v[68:83]
    buffer_load_dwordx4 v251, s[48:51], s74 offen offset:1024 lds
    buffer_load_dwordx4 v184, s[48:51], s74 offen offset:2048 lds
    v_exp_f32 v28, v28
    v_exp_f32 v29, v29
    v_exp_f32 v30, v30
    v_exp_f32 v31, v31
    v_cvt_pk_bf16_f32 v55, v26, v27
    v_cvt_pk_bf16_f32 v56, v28, v29
    v_mfma_f32_32x32x16_bf16 v[68:83], a[172:175], v[64:67], v[68:83]
    buffer_load_dwordx4 v185, s[48:51], s74 offen offset:3072 lds
    v_exp_f32 v32, v32
    v_exp_f32 v33, v33
    v_exp_f32 v34, v34
    v_exp_f32 v35, v35
    v_cvt_pk_bf16_f32 v57, v30, v31
    v_cvt_pk_bf16_f32 v58, v32, v33
    v_cvt_pk_bf16_f32 v59, v34, v35
    v_mfma_f32_32x32x16_bf16 v[20:35], a[176:179], a[232:235], 0
    s_waitcnt vmcnt(16)
    ds_read_b64_tr_b16 a[96:97], v5 offset:0
    v_exp_f32 v36, v36
    v_exp_f32 v37, v37
    v_exp_f32 v38, v38
    v_exp_f32_e64 v39, v39
    v_cvt_pk_bf16_f32 v60, v36, v37
    v_mfma_f32_32x32x16_bf16 v[20:35], a[180:183], a[236:239], v[20:35]
    ds_read_b64_tr_b16 a[98:99], v5 offset:1024
    v_exp_f32 v40, v40
    v_exp_f32 v41, v41
    v_exp_f32 v42, v42
    v_exp_f32 v43, v43
    v_cvt_pk_bf16_f32 v61, v38, v39
    v_cvt_pk_bf16_f32 v62, v40, v41
    v_mfma_f32_32x32x16_bf16 v[116:131], a[168:171], v[52:55], v[116:131]
    ds_read_b64_tr_b16 a[100:101], v250 offset:0
    v_exp_f32 v44, v44
    v_exp_f32 v45, v45
    v_exp_f32 v46, v46
    v_exp_f32 v47, v47
    v_cvt_pk_bf16_f32 v63, v42, v43
    v_cvt_pk_bf16_f32 v64, v44, v45
    v_mfma_f32_32x32x16_bf16 v[116:131], a[172:175], v[56:59], v[116:131]
    ds_read_b64_tr_b16 a[102:103], v250 offset:1024
    v_exp_f32 v48, v48
    v_exp_f32 v49, v49
    v_exp_f32 v50, v50
    v_exp_f32 v51, v51
    v_cvt_pk_bf16_f32 v65, v46, v47
    v_cvt_pk_bf16_f32 v66, v48, v49
    v_cvt_pk_bf16_f32 v67, v50, v51
    v_mfma_f32_32x32x16_bf16 v[36:51], a[176:179], a[224:227], 0
    buffer_store_dwordx4 v[244:247], v248, s[12:15], s33 offen offset:1024 sc1
    ds_read_b64_tr_b16 a[104:105], v5 offset:2048
    v_exp_f32 v20, v20
    v_exp_f32 v21, v21
    v_exp_f32 v22, v22
    v_exp_f32 v23, v23
    v_cvt_pk_bf16_f32 v52, v20, v21
    v_mfma_f32_32x32x16_bf16 v[36:51], a[180:183], a[228:231], v[36:51]
    ds_read_b64_tr_b16 a[106:107], v5 offset:3072
    v_exp_f32 v24, v24
    v_exp_f32 v25, v25
    v_exp_f32 v26, v26
    v_exp_f32 v27, v27
    v_cvt_pk_bf16_f32 v53, v22, v23
    v_cvt_pk_bf16_f32 v54, v24, v25
    v_mfma_f32_32x32x16_bf16 v[100:115], a[168:171], v[60:63], v[100:115]
    ds_read_b64_tr_b16 a[108:109], v250 offset:2048
    v_exp_f32 v28, v28
    v_exp_f32 v29, v29
    v_exp_f32 v30, v30
    v_exp_f32 v31, v31
    v_cvt_pk_bf16_f32 v55, v26, v27
    v_cvt_pk_bf16_f32 v56, v28, v29
    v_mfma_f32_32x32x16_bf16 v[100:115], a[172:175], v[64:67], v[100:115]
    ds_read_b64_tr_b16 a[110:111], v250 offset:3072
    v_exp_f32 v32, v32
    v_exp_f32 v33, v33
    v_exp_f32 v34, v34
    v_exp_f32 v35, v35
    v_cvt_pk_bf16_f32 v57, v30, v31
    v_cvt_pk_bf16_f32 v58, v32, v33
    v_cvt_pk_bf16_f32 v59, v34, v35
    v_mfma_f32_32x32x16_bf16 v[20:35], a[176:179], a[248:251], 0
    buffer_load_dwordx4 a[160:163], v1, s[12:15], s84 offen sc1
    buffer_load_dwordx4 a[164:167], v1, s[12:15], s84 offen offset:1024 sc1
    buffer_load_dwordx4 a[168:171], v195, s[12:15], s84 offen offset:2048 sc1
    v_exp_f32 v36, v36
    v_exp_f32 v37, v37
    v_exp_f32 v38, v38
    v_exp_f32 v39, v39
    v_cvt_pk_bf16_f32 v60, v36, v37
    v_mfma_f32_32x32x16_bf16 v[20:35], a[180:183], a[252:255], v[20:35]
    buffer_load_dwordx4 a[172:175], v195, s[12:15], s84 offen offset:3072 sc1
    s_addk_i32 s84, 4096
    s_waitcnt lgkmcnt(0)
    v_exp_f32 v40, v40
    v_exp_f32 v41, v41
    v_exp_f32 v42, v42
    v_exp_f32 v43, v43
    v_cvt_pk_bf16_f32 v61, v38, v39
    v_cvt_pk_bf16_f32 v62, v40, v41
    v_mfma_f32_32x32x16_bf16 v[84:99], a[184:187], v[52:55], v[84:99]
    s_add_u32 m0, s100, 0
    s_add_u32 s74, s92, 1261568
    buffer_load_dwordx4 v4, s[48:51], s74 offen lds
    v_exp_f32 v44, v44
    v_exp_f32 v45, v45
    v_exp_f32 v46, v46
    v_exp_f32_e64 v47, v47
    v_cvt_pk_bf16_f32 v63, v42, v43
    v_cvt_pk_bf16_f32 v64, v44, v45
    v_mfma_f32_32x32x16_bf16 v[84:99], a[188:191], v[56:59], v[84:99]
    buffer_load_dwordx4 v251, s[48:51], s74 offen offset:1024 lds
    buffer_load_dwordx4 v184, s[48:51], s74 offen offset:2048 lds
    buffer_load_dwordx4 v185, s[48:51], s74 offen offset:3072 lds
    v_exp_f32 v48, v48
    v_exp_f32 v49, v49
    v_exp_f32 v50, v50
    v_exp_f32 v51, v51
    v_cvt_pk_bf16_f32 v65, v46, v47
    v_cvt_pk_bf16_f32 v66, v48, v49
    v_cvt_pk_bf16_f32 v67, v50, v51
    v_mfma_f32_32x32x16_bf16 v[36:51], a[176:179], a[240:243], 0
    s_waitcnt vmcnt(18)
    ds_read_b64_tr_b16 a[200:201], v5 offset:4096
    v_exp_f32 v20, v20
    v_exp_f32 v21, v21
    v_exp_f32 v22, v22
    v_exp_f32_e64 v23, v23
    v_cvt_pk_bf16_f32 v52, v20, v21
    v_mfma_f32_32x32x16_bf16 v[36:51], a[180:183], a[244:247], v[36:51]
    ds_read_b64_tr_b16 a[202:203], v5 offset:5120
    v_exp_f32 v24, v24
    v_exp_f32 v25, v25
    v_exp_f32 v26, v26
    v_exp_f32 v27, v27
    v_cvt_pk_bf16_f32 v53, v22, v23
    v_cvt_pk_bf16_f32 v54, v24, v25
    v_mfma_f32_32x32x16_bf16 v[68:83], a[184:187], v[60:63], v[68:83]
    ds_read_b64_tr_b16 a[204:205], v250 offset:4096
    v_exp_f32 v28, v28
    v_exp_f32 v29, v29
    v_exp_f32 v30, v30
    v_exp_f32 v31, v31
    v_cvt_pk_bf16_f32 v55, v26, v27
    v_cvt_pk_bf16_f32 v56, v28, v29
    v_mfma_f32_32x32x16_bf16 v[68:83], a[188:191], v[64:67], v[68:83]
    ds_read_b64_tr_b16 a[206:207], v250 offset:5120
    v_exp_f32 v32, v32
    v_exp_f32 v33, v33
    v_exp_f32 v34, v34
    v_exp_f32 v35, v35
    v_cvt_pk_bf16_f32 v57, v30, v31
    v_cvt_pk_bf16_f32 v58, v32, v33
    v_cvt_pk_bf16_f32 v59, v34, v35
    v_mfma_f32_32x32x16_bf16 v[20:35], a[112:115], a[232:235], 0
    v_exp_f32 v36, v36
    v_exp_f32 v37, v37
    v_exp_f32 v38, v38
    v_exp_f32 v39, v39
    v_cvt_pk_bf16_f32 v60, v36, v37
    v_mfma_f32_32x32x16_bf16 v[20:35], a[116:119], a[236:239], v[20:35]
    v_exp_f32 v40, v40
    v_exp_f32 v41, v41
    v_exp_f32 v42, v42
    v_exp_f32 v43, v43
    v_cvt_pk_bf16_f32 v61, v38, v39
    v_cvt_pk_bf16_f32 v62, v40, v41
    v_mfma_f32_32x32x16_bf16 v[116:131], a[184:187], v[52:55], v[116:131]
    v_exp_f32 v44, v44
    v_exp_f32 v45, v45
    v_exp_f32 v46, v46
    v_exp_f32 v47, v47
    v_cvt_pk_bf16_f32 v63, v42, v43
    v_cvt_pk_bf16_f32 v64, v44, v45
    v_mfma_f32_32x32x16_bf16 v[116:131], a[188:191], v[56:59], v[116:131]
    v_exp_f32 v48, v48
    v_exp_f32 v49, v49
    v_exp_f32 v50, v50
    v_exp_f32 v51, v51
    v_cvt_pk_bf16_f32 v65, v46, v47
    v_cvt_pk_bf16_f32 v66, v48, v49
    v_cvt_pk_bf16_f32 v67, v50, v51
    v_mfma_f32_32x32x16_bf16 v[36:51], a[112:115], a[224:227], 0
    buffer_store_dwordx4 v[244:247], v248, s[12:15], s33 offen offset:2048 sc1
    s_waitcnt lgkmcnt(0)
    v_exp_f32 v20, v20
    v_exp_f32 v21, v21
    v_exp_f32 v22, v22
    v_exp_f32_e64 v23, v23
    v_cvt_pk_bf16_f32 v52, v20, v21
    v_mfma_f32_32x32x16_bf16 v[36:51], a[116:119], a[228:231], v[36:51]
    s_add_u32 m0, s100, 4096
    s_add_u32 s74, s92, 1376256
    v_exp_f32 v24, v24
    v_exp_f32 v25, v25
    v_exp_f32 v26, v26
    v_exp_f32 v27, v27
    v_cvt_pk_bf16_f32 v53, v22, v23
    v_cvt_pk_bf16_f32 v54, v24, v25
    v_mfma_f32_32x32x16_bf16 v[100:115], a[184:187], v[60:63], v[100:115]
    buffer_load_dwordx4 v4, s[48:51], s74 offen lds
    buffer_load_dwordx4 v251, s[48:51], s74 offen offset:1024 lds
    v_exp_f32 v28, v28
    v_exp_f32 v29, v29
    v_exp_f32 v30, v30
    v_exp_f32 v31, v31
    v_cvt_pk_bf16_f32 v55, v26, v27
    v_cvt_pk_bf16_f32 v56, v28, v29
    v_mfma_f32_32x32x16_bf16 v[100:115], a[188:191], v[64:67], v[100:115]
    buffer_load_dwordx4 v184, s[48:51], s74 offen offset:2048 lds
    buffer_load_dwordx4 v185, s[48:51], s74 offen offset:3072 lds
    v_exp_f32 v32, v32
    v_exp_f32 v33, v33
    v_exp_f32 v34, v34
    v_exp_f32 v35, v35
    v_cvt_pk_bf16_f32 v57, v30, v31
    v_cvt_pk_bf16_f32 v58, v32, v33
    v_cvt_pk_bf16_f32 v59, v34, v35
    v_mfma_f32_32x32x16_bf16 v[20:35], a[112:115], a[248:251], 0
    buffer_load_dwordx4 a[176:179], v1, s[12:15], s84 offen sc1
    buffer_load_dwordx4 a[180:183], v1, s[12:15], s84 offen offset:1024 sc1
    buffer_load_dwordx4 a[184:187], v195, s[12:15], s84 offen offset:2048 sc1
    v_exp_f32 v36, v36
    v_exp_f32 v37, v37
    v_exp_f32 v38, v38
    v_exp_f32 v39, v39
    v_cvt_pk_bf16_f32 v60, v36, v37
    v_mfma_f32_32x32x16_bf16 v[20:35], a[116:119], a[252:255], v[20:35]
    buffer_load_dwordx4 a[188:191], v195, s[12:15], s84 offen offset:3072 sc1
    s_addk_i32 s84, 4096
    v_exp_f32 v40, v40
    v_exp_f32 v41, v41
    v_exp_f32 v42, v42
    v_exp_f32_e64 v43, v43
    v_cvt_pk_bf16_f32 v61, v38, v39
    v_cvt_pk_bf16_f32 v62, v40, v41
    v_mfma_f32_32x32x16_bf16 v[84:99], a[120:123], v[52:55], v[84:99]
    s_waitcnt vmcnt(18)
    ds_read_b64_tr_b16 a[208:209], v5 offset:8192
    ds_read_b64_tr_b16 a[210:211], v5 offset:9216
    v_exp_f32 v44, v44
    v_exp_f32 v45, v45
    v_exp_f32 v46, v46
    v_exp_f32_e64 v47, v47
    v_cvt_pk_bf16_f32 v63, v42, v43
    v_cvt_pk_bf16_f32 v64, v44, v45
    v_mfma_f32_32x32x16_bf16 v[84:99], a[124:127], v[56:59], v[84:99]
    ds_read_b64_tr_b16 a[212:213], v250 offset:8192
    ds_read_b64_tr_b16 a[214:215], v250 offset:9216
    v_exp_f32 v48, v48
    v_exp_f32 v49, v49
    v_exp_f32 v50, v50
    v_exp_f32 v51, v51
    v_cvt_pk_bf16_f32 v65, v46, v47
    v_cvt_pk_bf16_f32 v66, v48, v49
    v_cvt_pk_bf16_f32 v67, v50, v51
    v_mfma_f32_32x32x16_bf16 v[36:51], a[112:115], a[240:243], 0
    ds_read_b64_tr_b16 a[216:217], v5 offset:10240
    v_exp_f32 v20, v20
    v_exp_f32 v21, v21
    v_exp_f32 v22, v22
    v_exp_f32 v23, v23
    v_cvt_pk_bf16_f32 v52, v20, v21
    v_mfma_f32_32x32x16_bf16 v[36:51], a[116:119], a[244:247], v[36:51]
    ds_read_b64_tr_b16 a[218:219], v5 offset:11264
    v_exp_f32 v24, v24
    v_exp_f32 v25, v25
    v_exp_f32 v26, v26
    v_exp_f32 v27, v27
    v_cvt_pk_bf16_f32 v53, v22, v23
    v_cvt_pk_bf16_f32 v54, v24, v25
    v_mfma_f32_32x32x16_bf16 v[68:83], a[120:123], v[60:63], v[68:83]
    ds_read_b64_tr_b16 a[220:221], v250 offset:10240
    v_exp_f32 v28, v28
    v_exp_f32 v29, v29
    v_exp_f32 v30, v30
    v_exp_f32 v31, v31
    v_cvt_pk_bf16_f32 v55, v26, v27
    v_cvt_pk_bf16_f32 v56, v28, v29
    v_mfma_f32_32x32x16_bf16 v[68:83], a[124:127], v[64:67], v[68:83]
    ds_read_b64_tr_b16 a[222:223], v250 offset:11264
    v_exp_f32 v32, v32
    v_exp_f32 v33, v33
    v_exp_f32 v34, v34
    v_exp_f32 v35, v35
    v_cvt_pk_bf16_f32 v57, v30, v31
    v_cvt_pk_bf16_f32 v58, v32, v33
    v_cvt_pk_bf16_f32 v59, v34, v35
    v_mfma_f32_32x32x16_bf16 v[20:35], a[128:131], a[232:235], 0
    buffer_store_dwordx4 v[244:247], v248, s[12:15], s33 offen offset:3072 sc1
    s_waitcnt lgkmcnt(0)
    v_exp_f32 v36, v36
    v_exp_f32 v37, v37
    v_exp_f32 v38, v38
    v_exp_f32_e64 v39, v39
    v_cvt_pk_bf16_f32 v60, v36, v37
    v_mfma_f32_32x32x16_bf16 v[20:35], a[132:135], a[236:239], v[20:35]
    s_add_u32 m0, s100, 8192
    s_add_u32 s74, s92, 1490944
    v_exp_f32 v40, v40
    v_exp_f32 v41, v41
    v_exp_f32 v42, v42
    v_exp_f32 v43, v43
    v_cvt_pk_bf16_f32 v61, v38, v39
    v_cvt_pk_bf16_f32 v62, v40, v41
    v_mfma_f32_32x32x16_bf16 v[116:131], a[120:123], v[52:55], v[116:131]
    buffer_load_dwordx4 v4, s[48:51], s74 offen lds
    buffer_load_dwordx4 v251, s[48:51], s74 offen offset:1024 lds
    v_exp_f32 v44, v44
    v_exp_f32 v45, v45
    v_exp_f32 v46, v46
    v_exp_f32 v47, v47
    v_cvt_pk_bf16_f32 v63, v42, v43
    v_cvt_pk_bf16_f32 v64, v44, v45
    v_mfma_f32_32x32x16_bf16 v[116:131], a[124:127], v[56:59], v[116:131]
    buffer_load_dwordx4 v184, s[48:51], s74 offen offset:2048 lds
    buffer_load_dwordx4 v185, s[48:51], s74 offen offset:3072 lds
    v_exp_f32 v48, v48
    v_exp_f32 v49, v49
    v_exp_f32 v50, v50
    v_exp_f32 v51, v51
    v_cvt_pk_bf16_f32 v65, v46, v47
    v_cvt_pk_bf16_f32 v66, v48, v49
    v_cvt_pk_bf16_f32 v67, v50, v51
    v_mfma_f32_32x32x16_bf16 v[36:51], a[128:131], a[224:227], 0
    s_waitcnt vmcnt(14)
    ds_read_b64_tr_b16 v[196:197], v5 offset:0
    v_exp_f32 v20, v20
    v_exp_f32 v21, v21
    v_exp_f32 v22, v22
    v_exp_f32_e64 v23, v23
    v_cvt_pk_bf16_f32 v52, v20, v21
    v_mfma_f32_32x32x16_bf16 v[36:51], a[132:135], a[228:231], v[36:51]
    ds_read_b64_tr_b16 v[198:199], v5 offset:1024
    v_exp_f32 v24, v24
    v_exp_f32 v25, v25
    v_exp_f32 v26, v26
    v_exp_f32 v27, v27
    v_cvt_pk_bf16_f32 v53, v22, v23
    v_cvt_pk_bf16_f32 v54, v24, v25
    v_mfma_f32_32x32x16_bf16 v[100:115], a[120:123], v[60:63], v[100:115]
    ds_read_b64_tr_b16 v[200:201], v250 offset:0
    v_exp_f32 v28, v28
    v_exp_f32 v29, v29
    v_exp_f32 v30, v30
    v_exp_f32 v31, v31
    v_cvt_pk_bf16_f32 v55, v26, v27
    v_cvt_pk_bf16_f32 v56, v28, v29
    v_mfma_f32_32x32x16_bf16 v[100:115], a[124:127], v[64:67], v[100:115]
    ds_read_b64_tr_b16 v[202:203], v250 offset:1024
    v_exp_f32 v32, v32
    v_exp_f32 v33, v33
    v_exp_f32 v34, v34
    v_exp_f32 v35, v35
    v_cvt_pk_bf16_f32 v57, v30, v31
    v_cvt_pk_bf16_f32 v58, v32, v33
    v_cvt_pk_bf16_f32 v59, v34, v35
    v_mfma_f32_32x32x16_bf16 v[20:35], a[144:147], a[232:235], 0
    buffer_load_dwordx4 a[112:115], v1, s[12:15], s84 offen sc1
    buffer_load_dwordx4 a[116:119], v1, s[12:15], s84 offen offset:1024 sc1
    buffer_load_dwordx4 a[120:123], v195, s[12:15], s84 offen offset:2048 sc1
    v_exp_f32 v36, v36
    v_exp_f32 v37, v37
    v_exp_f32 v38, v38
    v_exp_f32 v39, v39
    v_cvt_pk_bf16_f32 v60, v36, v37
    v_mfma_f32_32x32x16_bf16 v[20:35], a[148:151], a[236:239], v[20:35]
    buffer_load_dwordx4 a[124:127], v195, s[12:15], s84 offen offset:3072 sc1
    s_addk_i32 s84, 4096
    v_exp_f32 v40, v40
    v_exp_f32 v41, v41
    v_exp_f32 v42, v42
    v_exp_f32_e64 v43, v43
    v_cvt_pk_bf16_f32 v61, v38, v39
    v_cvt_pk_bf16_f32 v62, v40, v41
    v_mfma_f32_32x32x16_bf16 v[84:99], a[136:139], v[52:55], v[84:99]
    ds_read_b64_tr_b16 v[204:205], v5 offset:2048
    ds_read_b64_tr_b16 v[206:207], v5 offset:3072
    v_exp_f32 v44, v44
    v_exp_f32 v45, v45
    v_exp_f32 v46, v46
    v_exp_f32 v47, v47
    v_cvt_pk_bf16_f32 v63, v42, v43
    v_cvt_pk_bf16_f32 v64, v44, v45
    v_mfma_f32_32x32x16_bf16 v[84:99], a[140:143], v[56:59], v[84:99]
    ds_read_b64_tr_b16 v[208:209], v250 offset:2048
    ds_read_b64_tr_b16 v[210:211], v250 offset:3072
    v_exp_f32 v48, v48
    v_exp_f32 v49, v49
    v_exp_f32 v50, v50
    v_exp_f32 v51, v51
    v_cvt_pk_bf16_f32 v65, v46, v47
    v_cvt_pk_bf16_f32 v66, v48, v49
    v_cvt_pk_bf16_f32 v67, v50, v51
    v_mfma_f32_32x32x16_bf16 v[36:51], a[144:147], a[224:227], 0
    s_waitcnt lgkmcnt(0)
    s_add_u32 m0, s100, 26624
    v_exp_f32 v20, v20
    v_exp_f32 v21, v21
    v_exp_f32 v22, v22
    v_exp_f32_e64 v23, v23
    v_cvt_pk_bf16_f32 v52, v20, v21
    v_mfma_f32_32x32x16_bf16 v[36:51], a[148:151], a[228:231], v[36:51]
    s_add_u32 s74, s92, 802816
    v_exp_f32 v24, v24
    v_exp_f32 v25, v25
    v_exp_f32 v26, v26
    v_exp_f32 v27, v27
    v_cvt_pk_bf16_f32 v53, v22, v23
    v_cvt_pk_bf16_f32 v54, v24, v25
    v_mfma_f32_32x32x16_bf16 v[68:83], a[136:139], v[60:63], v[68:83]
    buffer_load_dwordx4 v4, s[48:51], s74 offen lds
    v_exp_f32 v28, v28
    v_exp_f32 v29, v29
    v_exp_f32 v30, v30
    v_exp_f32 v31, v31
    v_cvt_pk_bf16_f32 v55, v26, v27
    v_cvt_pk_bf16_f32 v56, v28, v29
    v_mfma_f32_32x32x16_bf16 v[68:83], a[140:143], v[64:67], v[68:83]
    buffer_load_dwordx4 v251, s[48:51], s74 offen offset:1024 lds
    v_exp_f32 v32, v32
    v_exp_f32 v33, v33
    v_exp_f32 v34, v34
    v_exp_f32 v35, v35
    v_cvt_pk_bf16_f32 v57, v30, v31
    v_cvt_pk_bf16_f32 v58, v32, v33
    v_cvt_pk_bf16_f32 v59, v34, v35
    v_mfma_f32_32x32x16_bf16 v[20:35], a[160:163], a[232:235], 0
    s_waitcnt vmcnt(15)
    ds_read_b64_tr_b16 v[212:213], v5 offset:4096
    ds_read_b64_tr_b16 v[214:215], v5 offset:5120
    v_exp_f32 v36, v36
    v_exp_f32 v37, v37
    v_exp_f32 v38, v38
    v_exp_f32_e64 v39, v39
    v_cvt_pk_bf16_f32 v60, v36, v37
    v_mfma_f32_32x32x16_bf16 v[20:35], a[164:167], a[236:239], v[20:35]
    ds_read_b64_tr_b16 v[216:217], v250 offset:4096
    ds_read_b64_tr_b16 v[218:219], v250 offset:5120
    v_exp_f32 v40, v40
    v_exp_f32 v41, v41
    v_exp_f32 v42, v42
    v_exp_f32 v43, v43
    v_cvt_pk_bf16_f32 v61, v38, v39
    v_cvt_pk_bf16_f32 v62, v40, v41
    v_mfma_f32_32x32x16_bf16 v[84:99], a[152:155], v[52:55], v[84:99]
    s_add_u32 m0, s100, 28672
    s_add_u32 s74, s92, 860160
    v_exp_f32 v44, v44
    v_exp_f32 v45, v45
    v_exp_f32 v46, v46
    v_exp_f32 v47, v47
    v_cvt_pk_bf16_f32 v63, v42, v43
    v_cvt_pk_bf16_f32 v64, v44, v45
    v_mfma_f32_32x32x16_bf16 v[84:99], a[156:159], v[56:59], v[84:99]
    buffer_load_dwordx4 v4, s[48:51], s74 offen lds
    buffer_load_dwordx4 v251, s[48:51], s74 offen offset:1024 lds
    v_exp_f32 v48, v48
    v_exp_f32 v49, v49
    v_exp_f32 v50, v50
    v_exp_f32 v51, v51
    v_cvt_pk_bf16_f32 v65, v46, v47
    v_cvt_pk_bf16_f32 v66, v48, v49
    v_cvt_pk_bf16_f32 v67, v50, v51
    v_mfma_f32_32x32x16_bf16 v[36:51], a[160:163], a[224:227], 0
    ds_read_b64_tr_b16 v[220:221], v5 offset:6144
    ds_read_b64_tr_b16 v[222:223], v5 offset:7168
    v_exp_f32 v20, v20
    v_exp_f32 v21, v21
    v_exp_f32 v22, v22
    v_exp_f32 v23, v23
    v_cvt_pk_bf16_f32 v52, v20, v21
    v_mfma_f32_32x32x16_bf16 v[36:51], a[164:167], a[228:231], v[36:51]
    ds_read_b64_tr_b16 v[224:225], v250 offset:6144
    ds_read_b64_tr_b16 v[226:227], v250 offset:7168
    v_exp_f32 v24, v24
    v_exp_f32 v25, v25
    v_exp_f32 v26, v26
    v_exp_f32 v27, v27
    v_cvt_pk_bf16_f32 v53, v22, v23
    v_cvt_pk_bf16_f32 v54, v24, v25
    v_mfma_f32_32x32x16_bf16 v[68:83], a[152:155], v[60:63], v[68:83]
    s_add_u32 m0, s100, 30720
    s_add_u32 s74, s92, 917504
    v_exp_f32 v28, v28
    v_exp_f32 v29, v29
    v_exp_f32 v30, v30
    v_exp_f32 v31, v31
    v_cvt_pk_bf16_f32 v55, v26, v27
    v_cvt_pk_bf16_f32 v56, v28, v29
    v_mfma_f32_32x32x16_bf16 v[68:83], a[156:159], v[64:67], v[68:83]
    buffer_load_dwordx4 v4, s[48:51], s74 offen lds
    buffer_load_dwordx4 v251, s[48:51], s74 offen offset:1024 lds
    v_exp_f32 v32, v32
    v_exp_f32 v33, v33
    v_exp_f32 v34, v34
    v_exp_f32 v35, v35
    v_cvt_pk_bf16_f32 v57, v30, v31
    v_cvt_pk_bf16_f32 v58, v32, v33
    v_cvt_pk_bf16_f32 v59, v34, v35
    s_waitcnt vmcnt(15)
    v_mfma_f32_32x32x16_bf16 v[20:35], a[176:179], a[232:235], 0
    s_add_u32 m0, s100, 32768
    v_exp_f32 v36, v36
    v_exp_f32 v37, v37
    v_exp_f32 v38, v38
    v_exp_f32_e64 v39, v39
    v_cvt_pk_bf16_f32 v60, v36, v37
    v_mfma_f32_32x32x16_bf16 v[20:35], a[180:183], a[236:239], v[20:35]
    s_add_u32 s74, s92, 974848
    v_exp_f32 v40, v40
    v_exp_f32 v41, v41
    v_exp_f32 v42, v42
    v_exp_f32 v43, v43
    v_cvt_pk_bf16_f32 v61, v38, v39
    v_cvt_pk_bf16_f32 v62, v40, v41
    v_mfma_f32_32x32x16_bf16 v[84:99], a[168:171], v[52:55], v[84:99]
    buffer_load_dwordx4 v4, s[48:51], s74 offen lds
    v_exp_f32 v44, v44
    v_exp_f32 v45, v45
    v_exp_f32 v46, v46
    v_exp_f32 v47, v47
    v_cvt_pk_bf16_f32 v63, v42, v43
    v_cvt_pk_bf16_f32 v64, v44, v45
    v_mfma_f32_32x32x16_bf16 v[84:99], a[172:175], v[56:59], v[84:99]
    buffer_load_dwordx4 v251, s[48:51], s74 offen offset:1024 lds
    v_exp_f32 v48, v48
    v_exp_f32 v49, v49
    v_exp_f32 v50, v50
    v_exp_f32 v51, v51
    v_cvt_pk_bf16_f32 v65, v46, v47
    v_cvt_pk_bf16_f32 v66, v48, v49
    v_cvt_pk_bf16_f32 v67, v50, v51
    v_mfma_f32_32x32x16_bf16 v[36:51], a[176:179], a[224:227], 0
    s_waitcnt vmcnt(12)
    ds_read_b64_tr_b16 v[228:229], v5 offset:8192
    ds_read_b64_tr_b16 v[230:231], v5 offset:9216
    v_exp_f32 v20, v20
    v_exp_f32 v21, v21
    v_exp_f32 v22, v22
    v_exp_f32_e64 v23, v23
    v_cvt_pk_bf16_f32 v52, v20, v21
    v_mfma_f32_32x32x16_bf16 v[36:51], a[180:183], a[228:231], v[36:51]
    ds_read_b64_tr_b16 v[232:233], v250 offset:8192
    ds_read_b64_tr_b16 v[234:235], v250 offset:9216
    v_exp_f32 v24, v24
    v_exp_f32 v25, v25
    v_exp_f32 v26, v26
    v_exp_f32 v27, v27
    v_cvt_pk_bf16_f32 v53, v22, v23
    v_cvt_pk_bf16_f32 v54, v24, v25
    v_mfma_f32_32x32x16_bf16 v[68:83], a[168:171], v[60:63], v[68:83]
    s_add_u32 m0, s100, 34816
    s_add_u32 s74, s92, 1032192
    v_exp_f32 v28, v28
    v_exp_f32 v29, v29
    v_exp_f32 v30, v30
    v_exp_f32 v31, v31
    v_cvt_pk_bf16_f32 v55, v26, v27
    v_cvt_pk_bf16_f32 v56, v28, v29
    v_mfma_f32_32x32x16_bf16 v[68:83], a[172:175], v[64:67], v[68:83]
    buffer_load_dwordx4 v4, s[48:51], s74 offen lds
    buffer_load_dwordx4 v251, s[48:51], s74 offen offset:1024 lds
    s_lshl2_add_u32 s70, s5, s4
    s_lshl2_add_u32 s70, s70, s32
    v_mov_b32 v249, s7
    s_mov_b64 exec, 1
    buffer_store_dword v249, v2, s[12:15], s70 offen sc1
    s_mov_b64 exec, -1
    v_exp_f32 v32, v32
    v_exp_f32 v33, v33
    v_exp_f32 v34, v34
    v_exp_f32_e64 v35, v35
    v_cvt_pk_bf16_f32 v57, v30, v31
    v_cvt_pk_bf16_f32 v58, v32, v33
    v_cvt_pk_bf16_f32 v59, v34, v35
    s_waitcnt vmcnt(11)
    v_mfma_f32_32x32x16_bf16 v[20:35], a[112:115], a[232:235], 0
    ds_read_b64_tr_b16 v[236:237], v5 offset:10240
    ds_read_b64_tr_b16 v[238:239], v5 offset:11264
    ds_read_b64_tr_b16 v[240:241], v250 offset:10240
    ds_read_b64_tr_b16 v[242:243], v250 offset:11264
    v_exp_f32 v36, v36
    v_exp_f32 v37, v37
    v_exp_f32 v38, v38
    v_exp_f32_e64 v39, v39
    v_cvt_pk_bf16_f32 v60, v36, v37
    v_mfma_f32_32x32x16_bf16 v[20:35], a[116:119], a[236:239], v[20:35]
    v_add_u32 v192, s27, v18
    v_add_u32 v193, s27, v19
    ds_read_b64_tr_b16 v[140:141], v192 offset:12288
    v_exp_f32 v40, v40
    v_exp_f32 v41, v41
    v_exp_f32 v42, v42
    v_exp_f32 v43, v43
    v_cvt_pk_bf16_f32 v61, v38, v39
    v_cvt_pk_bf16_f32 v62, v40, v41
    v_mfma_f32_32x32x16_bf16 v[84:99], a[184:187], v[52:55], v[84:99]
    ds_read_b64_tr_b16 v[142:143], v192 offset:13312
    ds_read_b64_tr_b16 v[144:145], v193 offset:12288
    ds_read_b64_tr_b16 v[146:147], v193 offset:13312
    ds_read_b64_tr_b16 v[148:149], v192 offset:14336
    v_exp_f32 v44, v44
    v_exp_f32 v45, v45
    v_exp_f32 v46, v46
    v_exp_f32 v47, v47
    v_cvt_pk_bf16_f32 v63, v42, v43
    v_cvt_pk_bf16_f32 v64, v44, v45
    v_mfma_f32_32x32x16_bf16 v[84:99], a[188:191], v[56:59], v[84:99]
    ds_read_b64_tr_b16 v[150:151], v192 offset:15360
    ds_read_b64_tr_b16 v[152:153], v193 offset:14336
    ds_read_b64_tr_b16 v[154:155], v193 offset:15360
    v_exp_f32 v48, v48
    v_exp_f32 v49, v49
    v_exp_f32 v50, v50
    v_exp_f32 v51, v51
    v_cvt_pk_bf16_f32 v65, v46, v47
    v_cvt_pk_bf16_f32 v66, v48, v49
    v_cvt_pk_bf16_f32 v67, v50, v51
    v_mfma_f32_32x32x16_bf16 v[36:51], a[112:115], a[224:227], 0
    v_exp_f32 v20, v20
    v_exp_f32 v21, v21
    v_exp_f32 v22, v22
    v_exp_f32 v23, v23
    v_cvt_pk_bf16_f32 v52, v20, v21
    v_mfma_f32_32x32x16_bf16 v[36:51], a[116:119], a[228:231], v[36:51]
    v_exp_f32 v24, v24
    v_exp_f32 v25, v25
    v_exp_f32 v26, v26
    v_exp_f32 v27, v27
    v_cvt_pk_bf16_f32 v53, v22, v23
    v_cvt_pk_bf16_f32 v54, v24, v25
    v_mfma_f32_32x32x16_bf16 v[68:83], a[184:187], v[60:63], v[68:83]
    v_exp_f32 v28, v28
    v_exp_f32 v29, v29
    v_exp_f32 v30, v30
    v_exp_f32 v31, v31
    v_cvt_pk_bf16_f32 v55, v26, v27
    v_cvt_pk_bf16_f32 v56, v28, v29
    v_mfma_f32_32x32x16_bf16 v[68:83], a[188:191], v[64:67], v[68:83]
    s_waitcnt lgkmcnt(0)
    s_barrier
    v_exp_f32 v32, v32
    v_exp_f32 v33, v33
    v_exp_f32 v34, v34
    v_exp_f32 v35, v35
    v_cvt_pk_bf16_f32 v57, v30, v31
    v_cvt_pk_bf16_f32 v58, v32, v33
    v_cvt_pk_bf16_f32 v59, v34, v35
    v_mfma_f32_32x32x16_bf16 v[20:35], a[128:131], a[248:251], 0
    v_add_u32 v192, s28, v18
    v_add_u32 v193, s28, v19
    ds_read_b64_tr_b16 v[156:157], v192 offset:12288
    v_exp_f32 v36, v36
    v_exp_f32 v37, v37
    v_exp_f32 v38, v38
    v_exp_f32 v39, v39
    v_cvt_pk_bf16_f32 v60, v36, v37
    v_mfma_f32_32x32x16_bf16 v[20:35], a[132:135], a[252:255], v[20:35]
    ds_read_b64_tr_b16 v[158:159], v192 offset:13312
    ds_read_b64_tr_b16 v[160:161], v193 offset:12288
    v_exp_f32 v40, v40
    v_exp_f32 v41, v41
    v_exp_f32 v42, v42
    v_exp_f32 v43, v43
    v_cvt_pk_bf16_f32 v61, v38, v39
    v_cvt_pk_bf16_f32 v62, v40, v41
    v_mfma_f32_32x32x16_bf16 v[84:99], a[120:123], v[52:55], v[84:99]
    ds_read_b64_tr_b16 v[162:163], v193 offset:13312
    ds_read_b64_tr_b16 v[164:165], v192 offset:14336
    ds_read_b64_tr_b16 v[166:167], v192 offset:15360
    v_exp_f32 v44, v44
    v_exp_f32 v45, v45
    v_exp_f32 v46, v46
    v_exp_f32 v47, v47
    v_cvt_pk_bf16_f32 v63, v42, v43
    v_cvt_pk_bf16_f32 v64, v44, v45
    v_mfma_f32_32x32x16_bf16 v[84:99], a[124:127], v[56:59], v[84:99]
    ds_read_b64_tr_b16 v[168:169], v193 offset:14336
    ds_read_b64_tr_b16 v[170:171], v193 offset:15360
    v_exp_f32 v48, v48
    v_exp_f32 v49, v49
    v_exp_f32 v50, v50
    v_exp_f32 v51, v51
    v_cvt_pk_bf16_f32 v65, v46, v47
    v_cvt_pk_bf16_f32 v66, v48, v49
    v_cvt_pk_bf16_f32 v67, v50, v51
    v_mfma_f32_32x32x16_bf16 v[36:51], a[128:131], a[240:243], 0
    v_exp_f32 v20, v20
    v_exp_f32 v21, v21
    v_exp_f32 v22, v22
    v_exp_f32 v23, v23
    v_cvt_pk_bf16_f32 v52, v20, v21
    v_mfma_f32_32x32x16_bf16 v[36:51], a[132:135], a[244:247], v[36:51]
    ds_write_b128 v188, v[84:87] offset:0
    v_exp_f32 v24, v24
    v_exp_f32 v25, v25
    v_exp_f32 v26, v26
    v_exp_f32 v27, v27
    v_cvt_pk_bf16_f32 v53, v22, v23
    v_cvt_pk_bf16_f32 v54, v24, v25
    v_mfma_f32_32x32x16_bf16 v[68:83], a[120:123], v[60:63], v[68:83]
    ds_write_b128 v188, v[88:91] offset:1024
    v_exp_f32 v28, v28
    v_exp_f32 v29, v29
    v_exp_f32 v30, v30
    v_exp_f32 v31, v31
    v_cvt_pk_bf16_f32 v55, v26, v27
    v_cvt_pk_bf16_f32 v56, v28, v29
    v_mfma_f32_32x32x16_bf16 v[68:83], a[124:127], v[64:67], v[68:83]
    ds_write_b128 v190, v[92:95] offset:0
    v_exp_f32 v32, v32
    v_exp_f32 v33, v33
    v_exp_f32 v34, v34
    v_exp_f32 v35, v35
    v_cvt_pk_bf16_f32 v57, v30, v31
    v_cvt_pk_bf16_f32 v58, v32, v33
    v_cvt_pk_bf16_f32 v59, v34, v35
    v_mfma_f32_32x32x16_bf16 v[20:35], a[144:147], a[248:251], 0
    ds_write_b128 v190, v[96:99] offset:1024
    s_nop 1
    ds_write_b128 v189, v[76:79] offset:0
    v_exp_f32 v36, v36
    v_exp_f32 v37, v37
    v_exp_f32 v38, v38
    v_exp_f32_e64 v39, v39
    v_cvt_pk_bf16_f32 v60, v36, v37
    v_mfma_f32_32x32x16_bf16 v[20:35], a[148:151], a[252:255], v[20:35]
    ds_write_b128 v189, v[80:83] offset:1024
    v_cndmask_b32 v132, v80, v72, s[34:35]
    v_exp_f32 v40, v40
    v_exp_f32 v41, v41
    v_exp_f32 v42, v42
    v_exp_f32 v43, v43
    v_cvt_pk_bf16_f32 v61, v38, v39
    v_cvt_pk_bf16_f32 v62, v40, v41
    v_mfma_f32_32x32x16_bf16 v[116:131], a[136:139], v[52:55], v[116:131]
    v_cndmask_b32 v133, v96, v88, s[34:35]
    v_xor_b32 v8, 0x400, v191
    v_exp_f32 v44, v44
    v_exp_f32 v45, v45
    v_exp_f32 v46, v46
    v_exp_f32 v47, v47
    v_cvt_pk_bf16_f32 v63, v42, v43
    v_cvt_pk_bf16_f32 v64, v44, v45
    v_mfma_f32_32x32x16_bf16 v[116:131], a[140:143], v[56:59], v[116:131]
    ds_write_b32 v191, v132 offset:4096
    ds_write_b32 v8, v133 offset:4096
    s_waitcnt lgkmcnt(0)
    s_barrier
    v_exp_f32 v48, v48
    v_exp_f32 v49, v49
    v_exp_f32 v50, v50
    v_exp_f32 v51, v51
    v_cvt_pk_bf16_f32 v65, v46, v47
    v_cvt_pk_bf16_f32 v66, v48, v49
    v_cvt_pk_bf16_f32 v67, v50, v51
    v_mfma_f32_32x32x16_bf16 v[36:51], a[144:147], a[240:243], 0
    v_and_b32 v8, 31, v0
    s_lshl_b32 s70, s69, 10
    s_add_u32 s70, s70, 4224
    v_lshl_add_u32 v8, v8, 2, s70
    v_exp_f32 v20, v20
    v_exp_f32 v21, v21
    v_exp_f32 v22, v22
    v_exp_f32 v23, v23
    v_cvt_pk_bf16_f32 v52, v20, v21
    v_mfma_f32_32x32x16_bf16 v[36:51], a[148:151], a[244:247], v[36:51]
    ds_read2st64_b32 v[132:133], v8 offset0:0 offset1:1
    ds_read2st64_b32 v[134:135], v8 offset0:2 offset1:3
    v_add_u32 v7, s100, v1
    v_exp_f32 v24, v24
    v_exp_f32 v25, v25
    v_exp_f32 v26, v26
    v_exp_f32_e64 v27, v27
    v_cvt_pk_bf16_f32 v53, v22, v23
    v_cvt_pk_bf16_f32 v54, v24, v25
    v_mfma_f32_32x32x16_bf16 v[100:115], a[136:139], v[60:63], v[100:115]
    ds_read_b128 v[84:87], v7 offset:0
    ds_read_b128 v[88:91], v7 offset:1024
    ds_read_b128 v[76:79], v7 offset:2048
    v_exp_f32 v28, v28
    v_exp_f32 v29, v29
    v_exp_f32 v30, v30
    v_exp_f32 v31, v31
    v_cvt_pk_bf16_f32 v55, v26, v27
    v_cvt_pk_bf16_f32 v56, v28, v29
    v_mfma_f32_32x32x16_bf16 v[100:115], a[140:143], v[64:67], v[100:115]
    ds_read_b128 v[80:83], v7 offset:3072
    ds_read_b128 v[92:95], v7 offset:4096
    ds_read_b128 v[96:99], v7 offset:5120
    v_exp_f32 v32, v32
    v_exp_f32 v33, v33
    v_exp_f32 v34, v34
    v_exp_f32 v35, v35
    v_cvt_pk_bf16_f32 v57, v30, v31
    v_cvt_pk_bf16_f32 v58, v32, v33
    v_cvt_pk_bf16_f32 v59, v34, v35
    v_mfma_f32_32x32x16_bf16 v[20:35], a[160:163], a[248:251], 0
    s_waitcnt lgkmcnt(7)
    v_add_f32 v132, v132, v133
    s_waitcnt lgkmcnt(6)
    v_add_f32 v134, v134, v135
    v_add_f32 v132, v132, v134
    v_rcp_f32 v132, v132
    s_waitcnt lgkmcnt(5)
    v_add_f32 v68, v68, v84
    v_add_f32 v69, v69, v85
    v_exp_f32 v36, v36
    v_exp_f32 v37, v37
    v_exp_f32 v38, v38
    v_exp_f32_e64 v39, v39
    v_cvt_pk_bf16_f32 v60, v36, v37
    v_mfma_f32_32x32x16_bf16 v[20:35], a[164:167], a[252:255], v[20:35]
    v_add_f32 v70, v70, v86
    v_add_f32 v71, v71, v87
    s_waitcnt lgkmcnt(4)
    v_add_f32 v72, v72, v88
    v_add_f32 v73, v73, v89
    v_add_f32 v74, v74, v90
    v_exp_f32 v40, v40
    v_exp_f32 v41, v41
    v_exp_f32 v42, v42
    v_exp_f32 v43, v43
    v_cvt_pk_bf16_f32 v61, v38, v39
    v_cvt_pk_bf16_f32 v62, v40, v41
    v_mfma_f32_32x32x16_bf16 v[116:131], a[152:155], v[52:55], v[116:131]
    v_add_f32 v75, v75, v91
    s_waitcnt lgkmcnt(3)
    v_add_f32 v68, v68, v76
    v_add_f32 v69, v69, v77
    v_add_f32 v70, v70, v78
    v_add_f32 v71, v71, v79
    v_exp_f32 v44, v44
    v_exp_f32 v45, v45
    v_exp_f32 v46, v46
    v_exp_f32 v47, v47
    v_cvt_pk_bf16_f32 v63, v42, v43
    v_cvt_pk_bf16_f32 v64, v44, v45
    v_mfma_f32_32x32x16_bf16 v[116:131], a[156:159], v[56:59], v[116:131]
    s_waitcnt lgkmcnt(2)
    v_add_f32 v72, v72, v80
    v_add_f32 v73, v73, v81
    v_add_f32 v74, v74, v82
    v_add_f32 v75, v75, v83
    s_waitcnt lgkmcnt(1)
    v_add_f32 v68, v68, v92
    v_exp_f32 v48, v48
    v_exp_f32 v49, v49
    v_exp_f32 v50, v50
    v_exp_f32_e64 v51, v51
    v_cvt_pk_bf16_f32 v65, v46, v47
    v_cvt_pk_bf16_f32 v66, v48, v49
    v_cvt_pk_bf16_f32 v67, v50, v51
    v_mfma_f32_32x32x16_bf16 v[36:51], a[160:163], a[240:243], 0
    v_add_f32 v69, v69, v93
    v_add_f32 v70, v70, v94
    v_add_f32 v71, v71, v95
    s_waitcnt lgkmcnt(0)
    v_add_f32 v72, v72, v96
    v_add_f32 v73, v73, v97
    v_add_f32 v74, v74, v98
    v_exp_f32 v20, v20
    v_exp_f32 v21, v21
    v_exp_f32 v22, v22
    v_exp_f32_e64 v23, v23
    v_cvt_pk_bf16_f32 v52, v20, v21
    v_mfma_f32_32x32x16_bf16 v[36:51], a[164:167], a[244:247], v[36:51]
    v_add_f32 v75, v75, v99
    v_mul_f32 v68, v132, v68
    v_mul_f32 v69, v132, v69
    v_mul_f32 v70, v132, v70
    v_mul_f32 v71, v132, v71
    v_exp_f32 v24, v24
    v_exp_f32 v25, v25
    v_exp_f32 v26, v26
    v_exp_f32_e64 v27, v27
    v_cvt_pk_bf16_f32 v53, v22, v23
    v_cvt_pk_bf16_f32 v54, v24, v25
    v_mfma_f32_32x32x16_bf16 v[100:115], a[152:155], v[60:63], v[100:115]
    v_mul_f32 v72, v132, v72
    v_mul_f32 v73, v132, v73
    v_mul_f32 v74, v132, v74
    v_mul_f32 v75, v132, v75
    v_cvt_pk_bf16_f32 v136, v68, v69
    v_cvt_pk_bf16_f32 v137, v70, v71
    v_exp_f32 v28, v28
    v_exp_f32 v29, v29
    v_exp_f32 v30, v30
    v_exp_f32 v31, v31
    v_cvt_pk_bf16_f32 v55, v26, v27
    v_cvt_pk_bf16_f32 v56, v28, v29
    v_mfma_f32_32x32x16_bf16 v[100:115], a[156:159], v[64:67], v[100:115]
    v_cvt_pk_bf16_f32 v138, v72, v73
    v_cvt_pk_bf16_f32 v139, v74, v75
    v_cndmask_b32 v138, v138, v2, s[36:37]
    v_cndmask_b32 v139, v139, v2, s[36:37]
    buffer_store_dwordx4 v[136:139], v1, s[12:15], s85 offen sc1
    v_and_b32 v253, 31, v0
    v_lshlrev_b32 v253, 2, v253
    buffer_load_dword v254, v253, s[12:15], s32 offen sc1
    v_exp_f32 v32, v32
    v_exp_f32 v33, v33
    v_exp_f32 v34, v34
    v_exp_f32 v35, v35
    v_cvt_pk_bf16_f32 v57, v30, v31
    v_cvt_pk_bf16_f32 v58, v32, v33
    v_cvt_pk_bf16_f32 v59, v34, v35
    v_mfma_f32_32x32x16_bf16 v[20:35], a[176:179], a[248:251], 0
    v_exp_f32 v36, v36
    v_exp_f32 v37, v37
    v_exp_f32 v38, v38
    v_exp_f32 v39, v39
    v_cvt_pk_bf16_f32 v60, v36, v37
    v_mfma_f32_32x32x16_bf16 v[20:35], a[180:183], a[252:255], v[20:35]
    v_exp_f32 v40, v40
    v_exp_f32 v41, v41
    v_exp_f32 v42, v42
    v_exp_f32 v43, v43
    v_cvt_pk_bf16_f32 v61, v38, v39
    v_cvt_pk_bf16_f32 v62, v40, v41
    v_mfma_f32_32x32x16_bf16 v[116:131], a[168:171], v[52:55], v[116:131]
    v_exp_f32 v44, v44
    v_exp_f32 v45, v45
    v_exp_f32 v46, v46
    v_exp_f32 v47, v47
    v_cvt_pk_bf16_f32 v63, v42, v43
    v_cvt_pk_bf16_f32 v64, v44, v45
    v_mfma_f32_32x32x16_bf16 v[116:131], a[172:175], v[56:59], v[116:131]
    v_exp_f32 v48, v48
    v_exp_f32 v49, v49
    v_exp_f32 v50, v50
    v_exp_f32 v51, v51
    v_cvt_pk_bf16_f32 v65, v46, v47
    v_cvt_pk_bf16_f32 v66, v48, v49
    v_cvt_pk_bf16_f32 v67, v50, v51
    v_mfma_f32_32x32x16_bf16 v[36:51], a[176:179], a[240:243], 0
    v_add_u32 v192, s29, v18
    v_add_u32 v193, s29, v19
    ds_read_b64_tr_b16 v[172:173], v192 offset:12288
    v_exp_f32 v20, v20
    v_exp_f32 v21, v21
    v_exp_f32 v22, v22
    v_exp_f32 v23, v23
    v_cvt_pk_bf16_f32 v52, v20, v21
    v_mfma_f32_32x32x16_bf16 v[36:51], a[180:183], a[244:247], v[36:51]
    ds_read_b64_tr_b16 v[174:175], v192 offset:13312
    ds_read_b64_tr_b16 v[176:177], v193 offset:12288
    v_exp_f32 v24, v24
    v_exp_f32 v25, v25
    v_exp_f32 v26, v26
    v_exp_f32 v27, v27
    v_cvt_pk_bf16_f32 v53, v22, v23
    v_cvt_pk_bf16_f32 v54, v24, v25
    v_mfma_f32_32x32x16_bf16 v[100:115], a[168:171], v[60:63], v[100:115]
    ds_read_b64_tr_b16 v[178:179], v193 offset:13312
    ds_read_b64_tr_b16 v[180:181], v192 offset:14336
    ds_read_b64_tr_b16 v[182:183], v192 offset:15360
    v_exp_f32 v28, v28
    v_exp_f32 v29, v29
    v_exp_f32 v30, v30
    v_exp_f32 v31, v31
    v_cvt_pk_bf16_f32 v55, v26, v27
    v_cvt_pk_bf16_f32 v56, v28, v29
    v_mfma_f32_32x32x16_bf16 v[100:115], a[172:175], v[64:67], v[100:115]
    ds_read_b64_tr_b16 v[184:185], v193 offset:14336
    ds_read_b64_tr_b16 v[186:187], v193 offset:15360
    v_exp_f32 v32, v32
    v_exp_f32 v33, v33
    v_exp_f32 v34, v34
    v_exp_f32 v35, v35
    v_cvt_pk_bf16_f32 v57, v30, v31
    v_cvt_pk_bf16_f32 v58, v32, v33
    v_cvt_pk_bf16_f32 v59, v34, v35
    v_mfma_f32_32x32x16_bf16 v[20:35], a[112:115], a[248:251], 0
    v_exp_f32 v36, v36
    v_exp_f32 v37, v37
    v_exp_f32 v38, v38
    v_exp_f32 v39, v39
    v_cvt_pk_bf16_f32 v60, v36, v37
    v_mfma_f32_32x32x16_bf16 v[20:35], a[116:119], a[252:255], v[20:35]
    v_exp_f32 v40, v40
    v_exp_f32 v41, v41
    v_exp_f32 v42, v42
    v_exp_f32 v43, v43
    v_cvt_pk_bf16_f32 v61, v38, v39
    v_cvt_pk_bf16_f32 v62, v40, v41
    v_mfma_f32_32x32x16_bf16 v[116:131], a[184:187], v[52:55], v[116:131]
    v_exp_f32 v44, v44
    v_exp_f32 v45, v45
    v_exp_f32 v46, v46
    v_exp_f32 v47, v47
    v_cvt_pk_bf16_f32 v63, v42, v43
    v_cvt_pk_bf16_f32 v64, v44, v45
    v_mfma_f32_32x32x16_bf16 v[116:131], a[188:191], v[56:59], v[116:131]
    v_exp_f32 v48, v48
    v_exp_f32 v49, v49
    v_exp_f32 v50, v50
    v_exp_f32 v51, v51
    v_cvt_pk_bf16_f32 v65, v46, v47
    v_cvt_pk_bf16_f32 v66, v48, v49
    v_cvt_pk_bf16_f32 v67, v50, v51
    v_mfma_f32_32x32x16_bf16 v[36:51], a[112:115], a[240:243], 0
    v_add_u32 v192, s30, v18
    v_add_u32 v193, s30, v19
    ds_read_b64_tr_b16 a[224:225], v192 offset:12288
    v_exp_f32 v20, v20
    v_exp_f32 v21, v21
    v_exp_f32 v22, v22
    v_exp_f32 v23, v23
    v_cvt_pk_bf16_f32 v52, v20, v21
    v_mfma_f32_32x32x16_bf16 v[36:51], a[116:119], a[244:247], v[36:51]
    ds_read_b64_tr_b16 a[226:227], v192 offset:13312
    ds_read_b64_tr_b16 a[228:229], v193 offset:12288
    v_exp_f32 v24, v24
    v_exp_f32 v25, v25
    v_exp_f32 v26, v26
    v_exp_f32 v27, v27
    v_cvt_pk_bf16_f32 v53, v22, v23
    v_cvt_pk_bf16_f32 v54, v24, v25
    v_mfma_f32_32x32x16_bf16 v[100:115], a[184:187], v[60:63], v[100:115]
    ds_read_b64_tr_b16 a[230:231], v193 offset:13312
    ds_read_b64_tr_b16 a[232:233], v192 offset:14336
    ds_read_b64_tr_b16 a[234:235], v192 offset:15360
    v_exp_f32 v28, v28
    v_exp_f32 v29, v29
    v_exp_f32 v30, v30
    v_exp_f32 v31, v31
    v_cvt_pk_bf16_f32 v55, v26, v27
    v_cvt_pk_bf16_f32 v56, v28, v29
    v_mfma_f32_32x32x16_bf16 v[100:115], a[188:191], v[64:67], v[100:115]
    ds_read_b64_tr_b16 a[236:237], v193 offset:14336
    ds_read_b64_tr_b16 a[238:239], v193 offset:15360
    s_mov_b32 s94, 0
L_p3c_a:
    s_waitcnt vmcnt(0)
    v_cmp_ne_u32 vcc, s7, v254
    s_nop 0
    s_cbranch_vccz L_p3k_a
    s_add_u32 s94, s94, 1
    s_cmp_gt_u32 s94, 131072
    s_cbranch_scc1 L_p3k_a
    s_sleep 4
    v_and_b32 v253, 31, v0
    v_lshlrev_b32 v253, 2, v253
    buffer_load_dword v254, v253, s[12:15], s32 offen sc1
    s_waitcnt vmcnt(0)
    s_branch L_p3c_a
L_p3k_a:
    v_exp_f32 v32, v32
    v_exp_f32 v33, v33
    v_exp_f32 v34, v34
    v_exp_f32 v35, v35
    v_cvt_pk_bf16_f32 v57, v30, v31
    v_cvt_pk_bf16_f32 v58, v32, v33
    v_cvt_pk_bf16_f32 v59, v34, v35
    v_exp_f32 v36, v36
    v_exp_f32 v37, v37
    v_exp_f32 v38, v38
    v_exp_f32 v39, v39
    v_cvt_pk_bf16_f32 v60, v36, v37
    v_exp_f32 v40, v40
    v_exp_f32 v41, v41
    v_exp_f32 v42, v42
    v_exp_f32 v43, v43
    v_cvt_pk_bf16_f32 v61, v38, v39
    v_cvt_pk_bf16_f32 v62, v40, v41
    v_mfma_f32_32x32x16_bf16 v[116:131], a[120:123], v[52:55], v[116:131]
    v_exp_f32 v44, v44
    v_exp_f32 v45, v45
    v_exp_f32 v46, v46
    v_exp_f32 v47, v47
    v_cvt_pk_bf16_f32 v63, v42, v43
    v_cvt_pk_bf16_f32 v64, v44, v45
    v_mfma_f32_32x32x16_bf16 v[116:131], a[124:127], v[56:59], v[116:131]
    v_exp_f32 v48, v48
    v_exp_f32 v49, v49
    v_exp_f32 v50, v50
    v_exp_f32 v51, v51
    v_cvt_pk_bf16_f32 v65, v46, v47
    v_cvt_pk_bf16_f32 v66, v48, v49
    v_cvt_pk_bf16_f32 v67, v50, v51
    v_mfma_f32_32x32x16_bf16 v[100:115], a[120:123], v[60:63], v[100:115]
    s_nop 0
    v_mfma_f32_32x32x16_bf16 v[100:115], a[124:127], v[64:67], v[100:115]
L_comb2:
    v_lshrrev_b32 v194, 5, v0
    v_lshlrev_b32 v194, 7, v194
    s_lshl_b32 s78, s4, 11
    s_add_u32 s78, s78, 32768
    s_lshr_b32 s80, s23, 2
    s_add_u32 s80, s80, s78
    buffer_load_dwordx4 a[112:115], v194, s[12:15], s80 offen sc1
    buffer_load_dwordx4 a[116:119], v194, s[12:15], s80 offen offset:256 sc1
    ds_write_b128 v188, v[116:119] offset:6144
    s_lshr_b32 s80, s24, 2
    s_add_u32 s80, s80, s78
    buffer_load_dwordx4 a[120:123], v194, s[12:15], s80 offen sc1
    buffer_load_dwordx4 a[124:127], v194, s[12:15], s80 offen offset:256 sc1
    ds_write_b128 v188, v[120:123] offset:7168
    s_lshr_b32 s80, s25, 2
    s_add_u32 s80, s80, s78
    buffer_load_dwordx4 a[128:131], v194, s[12:15], s80 offen sc1
    buffer_load_dwordx4 a[132:135], v194, s[12:15], s80 offen offset:256 sc1
    ds_write_b128 v190, v[124:127] offset:6144
    s_lshr_b32 s80, s26, 2
    s_add_u32 s80, s80, s78
    buffer_load_dwordx4 a[136:139], v194, s[12:15], s80 offen sc1
    buffer_load_dwordx4 a[140:143], v194, s[12:15], s80 offen offset:256 sc1
    ds_write_b128 v190, v[128:131] offset:7168
    s_add_u32 s79, s86, s23
    buffer_load_dwordx4 v[68:71], v1, s[12:15], s79 offen sc1
    ds_write_b128 v189, v[108:111] offset:6144
    buffer_load_dwordx4 v[72:75], v1, s[12:15], s79 offen offset:1024 sc1
    ds_write_b128 v189, v[112:115] offset:7168
    v_cndmask_b32 v132, v112, v104, s[34:35]
    v_cndmask_b32 v133, v128, v120, s[34:35]
    v_xor_b32 v8, 0x400, v191
    ds_write_b32 v191, v132 offset:6144
    ds_write_b32 v8, v133 offset:6144
    v_add_u32 v254, 0x8000, v1
    s_add_u32 s79, s86, s24
    buffer_load_dwordx4 v[76:79], v1, s[12:15], s79 offen sc1
    s_waitcnt lgkmcnt(0)
    s_barrier
    v_and_b32 v8, 31, v0
    s_lshl_b32 s70, s69, 10
    s_add_u32 s70, s70, 6272
    v_lshl_add_u32 v8, v8, 2, s70
    ds_read2st64_b32 v[132:133], v8 offset0:0 offset1:1
    ds_read2st64_b32 v[134:135], v8 offset0:2 offset1:3
    v_add_u32 v7, s100, v1
    ds_read_b128 v[116:119], v7 offset:6144
    ds_read_b128 v[120:123], v7 offset:7168
    ds_read_b128 v[108:111], v7 offset:8192
    ds_read_b128 v[112:115], v7 offset:9216
    ds_read_b128 v[124:127], v7 offset:10240
    ds_read_b128 v[128:131], v7 offset:11264
    buffer_load_dwordx4 v[80:83], v1, s[12:15], s79 offen offset:1024 sc1
    s_add_u32 s79, s86, s25
    buffer_load_dwordx4 v[84:87], v1, s[12:15], s79 offen sc1
    buffer_load_dwordx4 v[88:91], v1, s[12:15], s79 offen offset:1024 sc1
    s_add_u32 s79, s86, s26
    buffer_load_dwordx4 v[92:95], v1, s[12:15], s79 offen sc1
    buffer_load_dwordx4 v[96:99], v1, s[12:15], s79 offen offset:1024 sc1
    s_waitcnt lgkmcnt(7)
    v_add_f32 v132, v132, v133
    s_waitcnt lgkmcnt(6)
    v_add_f32 v134, v134, v135
    v_add_f32 v132, v132, v134
    v_rcp_f32 v132, v132
    s_waitcnt lgkmcnt(5)
    v_pk_add_f32 v[100:101], v[100:101], v[116:117]
    v_pk_add_f32 v[102:103], v[102:103], v[118:119]
    s_waitcnt lgkmcnt(4)
    v_pk_add_f32 v[104:105], v[104:105], v[120:121]
    v_pk_add_f32 v[106:107], v[106:107], v[122:123]
    s_waitcnt lgkmcnt(3)
    v_pk_add_f32 v[100:101], v[100:101], v[108:109]
    v_pk_add_f32 v[102:103], v[102:103], v[110:111]
    s_waitcnt lgkmcnt(2)
    v_pk_add_f32 v[104:105], v[104:105], v[112:113]
    v_pk_add_f32 v[106:107], v[106:107], v[114:115]
    s_waitcnt lgkmcnt(1)
    v_pk_add_f32 v[100:101], v[100:101], v[124:125]
    v_pk_add_f32 v[102:103], v[102:103], v[126:127]
    s_waitcnt lgkmcnt(0)
    v_pk_add_f32 v[104:105], v[104:105], v[128:129]
    v_pk_add_f32 v[106:107], v[106:107], v[130:131]
    v_pk_mul_f32 v[100:101], v[100:101], v[132:133] op_sel_hi:[1,0]
    v_pk_mul_f32 v[102:103], v[102:103], v[132:133] op_sel_hi:[1,0]
    v_pk_mul_f32 v[104:105], v[104:105], v[132:133] op_sel_hi:[1,0]
    v_pk_mul_f32 v[106:107], v[106:107], v[132:133] op_sel_hi:[1,0]
    v_cvt_pk_bf16_f32 v136, v100, v101
    v_cvt_pk_bf16_f32 v137, v102, v103
    v_cvt_pk_bf16_f32 v138, v104, v105
    v_cvt_pk_bf16_f32 v139, v106, v107
    v_cndmask_b32 v138, v138, v2, s[36:37]
    v_cndmask_b32 v139, v139, v2, s[36:37]
    buffer_store_dwordx4 v[136:139], v1, s[12:15], s38 offen sc1
    s_cmp_eq_u32 s5, 7
    s_cbranch_scc1 L_fin7
    s_mov_b32 s94, 0
L_p30_body:
    s_waitcnt vmcnt(8)
    v_mfma_f32_32x32x16_bf16 v[36:51], v[140:143], v[68:71], 0
    v_mfma_f32_32x32x16_bf16 v[52:67], v[144:147], v[68:71], 0
    v_mfma_f32_32x32x16_bf16 a[144:159], a[112:115], v[68:71], 0
    s_add_u32 m0, s100, 12288
    s_mul_i32 s77, s17, 14
    s_add_u32 s77, s77, s93
    s_add_u32 s74, s77, 0
    buffer_load_dwordx4 v3, s[52:55], s74 offen lds
    s_waitcnt vmcnt(8)
    v_mfma_f32_32x32x16_bf16 v[36:51], v[148:151], v[72:75], v[36:51]
    v_mfma_f32_32x32x16_bf16 v[52:67], v[152:155], v[72:75], v[52:67]
    v_mfma_f32_32x32x16_bf16 a[144:159], a[116:119], v[72:75], a[144:159]
    buffer_load_dwordx4 v6, s[52:55], s74 offen offset:1024 lds
    ds_read_b64_tr_b16 a[160:161], v5 offset:26624
    ds_read_b64_tr_b16 a[162:163], v5 offset:27648
    ds_read_b64_tr_b16 a[164:165], v250 offset:26624
    ds_read_b64_tr_b16 a[166:167], v250 offset:27648
    s_waitcnt vmcnt(8)
    v_mfma_f32_32x32x16_bf16 v[36:51], v[156:159], v[76:79], v[36:51]
    v_mfma_f32_32x32x16_bf16 v[52:67], v[160:163], v[76:79], v[52:67]
    v_mfma_f32_32x32x16_bf16 a[144:159], a[120:123], v[76:79], a[144:159]
    s_add_u32 m0, s100, 14336
    s_add_u32 s74, s77, 14336
    buffer_load_dwordx4 v3, s[52:55], s74 offen lds
    ds_read_b64_tr_b16 a[168:169], v5 offset:28672
    ds_read_b64_tr_b16 a[170:171], v5 offset:29696
    ds_read_b64_tr_b16 a[172:173], v250 offset:28672
    ds_read_b64_tr_b16 a[174:175], v250 offset:29696
    s_waitcnt vmcnt(8)
    v_mfma_f32_32x32x16_bf16 v[36:51], v[164:167], v[80:83], v[36:51]
    v_mfma_f32_32x32x16_bf16 v[52:67], v[168:171], v[80:83], v[52:67]
    v_mfma_f32_32x32x16_bf16 a[144:159], a[124:127], v[80:83], a[144:159]
    buffer_load_dwordx4 v6, s[52:55], s74 offen offset:1024 lds
    ds_read_b64_tr_b16 a[176:177], v5 offset:30720
    ds_read_b64_tr_b16 a[178:179], v5 offset:31744
    ds_read_b64_tr_b16 a[180:181], v250 offset:30720
    ds_read_b64_tr_b16 a[182:183], v250 offset:31744
    s_waitcnt vmcnt(8)
    v_mfma_f32_32x32x16_bf16 v[36:51], v[172:175], v[84:87], v[36:51]
    v_mfma_f32_32x32x16_bf16 v[52:67], v[176:179], v[84:87], v[52:67]
    v_mfma_f32_32x32x16_bf16 a[144:159], a[128:131], v[84:87], a[144:159]
    s_add_u32 m0, s100, 16384
    s_add_u32 s74, s77, 28672
    buffer_load_dwordx4 v3, s[52:55], s74 offen lds
    ds_read_b64_tr_b16 a[184:185], v5 offset:32768
    ds_read_b64_tr_b16 a[186:187], v5 offset:33792
    ds_read_b64_tr_b16 a[188:189], v250 offset:32768
    ds_read_b64_tr_b16 a[190:191], v250 offset:33792
    s_waitcnt vmcnt(8)
    v_mfma_f32_32x32x16_bf16 v[36:51], v[180:183], v[88:91], v[36:51]
    v_mfma_f32_32x32x16_bf16 v[52:67], v[184:187], v[88:91], v[52:67]
    v_mfma_f32_32x32x16_bf16 a[144:159], a[132:135], v[88:91], a[144:159]
    buffer_load_dwordx4 v6, s[52:55], s74 offen offset:1024 lds
    ds_read_b64_tr_b16 a[192:193], v5 offset:34816
    ds_read_b64_tr_b16 a[194:195], v5 offset:35840
    ds_read_b64_tr_b16 a[196:197], v250 offset:34816
    ds_read_b64_tr_b16 a[198:199], v250 offset:35840
    s_waitcnt vmcnt(8)
    v_mfma_f32_32x32x16_bf16 v[36:51], a[224:227], v[92:95], v[36:51]
    v_mfma_f32_32x32x16_bf16 v[52:67], a[228:231], v[92:95], v[52:67]
    v_mfma_f32_32x32x16_bf16 a[144:159], a[136:139], v[92:95], a[144:159]
    s_add_u32 m0, s100, 19456
    s_add_u32 s74, s77, 43008
    buffer_load_dwordx4 v3, s[52:55], s74 offen lds
    s_waitcnt vmcnt(8)
    v_mfma_f32_32x32x16_bf16 v[36:51], a[232:235], v[96:99], v[36:51]
    v_mfma_f32_32x32x16_bf16 v[52:67], a[236:239], v[96:99], v[52:67]
    v_mfma_f32_32x32x16_bf16 a[144:159], a[140:143], v[96:99], a[144:159]
    buffer_load_dwordx4 v6, s[52:55], s74 offen offset:1024 lds
    v_lshlrev_b32 v20, 16, v10
    v_and_b32 v21, 0xffff0000, v10
    v_lshlrev_b32 v22, 16, v11
    v_and_b32 v23, 0xffff0000, v11
    v_lshlrev_b32 v24, 16, v12
    v_and_b32 v25, 0xffff0000, v12
    v_lshlrev_b32 v26, 16, v13
    v_and_b32 v27, 0xffff0000, v13
    s_nop 0
    v_cmp_u_f32 vcc, v36, v36
    s_nop 0
    s_cbranch_vccz L_p30_ok
    s_add_u32 s94, s94, 1
    s_cmp_gt_u32 s94, 131072
    s_cbranch_scc1 L_p30_ok
    s_waitcnt vmcnt(0)
    s_sleep 2
    s_add_u32 s79, s86, s23
    buffer_load_dwordx4 v[68:71], v1, s[12:15], s79 offen sc1
    buffer_load_dwordx4 v[72:75], v1, s[12:15], s79 offen offset:1024 sc1
    s_add_u32 s79, s86, s24
    buffer_load_dwordx4 v[76:79], v1, s[12:15], s79 offen sc1
    buffer_load_dwordx4 v[80:83], v1, s[12:15], s79 offen offset:1024 sc1
    s_add_u32 s79, s86, s25
    buffer_load_dwordx4 v[84:87], v1, s[12:15], s79 offen sc1
    buffer_load_dwordx4 v[88:91], v1, s[12:15], s79 offen offset:1024 sc1
    s_add_u32 s79, s86, s26
    buffer_load_dwordx4 v[92:95], v1, s[12:15], s79 offen sc1
    buffer_load_dwordx4 v[96:99], v1, s[12:15], s79 offen offset:1024 sc1
    s_waitcnt vmcnt(0)
    s_branch L_p30_body
L_p30_ok:
    ds_write_b128 v188, v[52:55] offset:0
    ds_write_b128 v188, v[56:59] offset:1024
    ds_write_b128 v189, v[44:47] offset:0
    ds_write_b128 v189, v[48:51] offset:1024
    ds_write_b128 v190, v[60:63] offset:0
    ds_write_b128 v190, v[64:67] offset:1024
    s_add_u32 s79, s86, s23
    buffer_load_dwordx4 v[100:103], v254, s[12:15], s79 offen sc1
    v_and_b32 v8, 0x3ff, v191
    ds_write_b32 v8, a144 offset:2048
    v_pk_add_f32 v[36:37], v[36:37], v[20:21]
    v_pk_add_f32 v[38:39], v[38:39], v[22:23]
    v_pk_add_f32 v[40:41], v[40:41], v[24:25]
    v_pk_add_f32 v[42:43], v[42:43], v[26:27]
    s_waitcnt lgkmcnt(0)
    s_barrier
    v_and_b32 v33, 31, v0
    v_lshlrev_b32 v32, 3, v33
    v_lshlrev_b32 v33, 2, v33
    ds_read_b32 v32, v32 offset:256
    ds_read2st64_b32 v[28:29], v33 offset0:8 offset1:9
    ds_read2st64_b32 v[30:31], v33 offset0:10 offset1:11
    v_add_u32 v7, s100, v1
    ds_read_b128 v[52:55], v7 offset:0
    ds_read_b128 v[56:59], v7 offset:1024
    ds_read_b128 v[44:47], v7 offset:2048
    ds_read_b128 v[48:51], v7 offset:3072
    ds_read_b128 v[60:63], v7 offset:4096
    ds_read_b128 v[64:67], v7 offset:5120
    buffer_load_dwordx4 v[104:107], v254, s[12:15], s79 offen offset:1024 sc1
    s_add_u32 s79, s86, s24
    buffer_load_dwordx4 v[108:111], v254, s[12:15], s79 offen sc1
    s_waitcnt lgkmcnt(7)
    v_add_f32 v32, v32, v28
    v_add_f32 v32, v32, v29
    s_waitcnt lgkmcnt(6)
    v_add_f32 v32, v32, v30
    v_add_f32 v32, v32, v31
    s_waitcnt lgkmcnt(5)
    v_pk_add_f32 v[36:37], v[36:37], v[52:53]
    v_pk_add_f32 v[38:39], v[38:39], v[54:55]
    s_waitcnt lgkmcnt(4)
    v_pk_add_f32 v[40:41], v[40:41], v[56:57]
    v_pk_add_f32 v[42:43], v[42:43], v[58:59]
    s_waitcnt lgkmcnt(3)
    v_pk_add_f32 v[36:37], v[36:37], v[44:45]
    v_pk_add_f32 v[38:39], v[38:39], v[46:47]
    s_waitcnt lgkmcnt(2)
    v_pk_add_f32 v[40:41], v[40:41], v[48:49]
    v_pk_add_f32 v[42:43], v[42:43], v[50:51]
    s_waitcnt lgkmcnt(1)
    v_pk_add_f32 v[36:37], v[36:37], v[60:61]
    v_pk_add_f32 v[38:39], v[38:39], v[62:63]
    s_waitcnt lgkmcnt(0)
    v_pk_add_f32 v[40:41], v[40:41], v[64:65]
    v_pk_add_f32 v[42:43], v[42:43], v[66:67]
    v_cvt_pk_bf16_f32 v10, v36, v37
    v_cvt_pk_bf16_f32 v11, v38, v39
    v_cvt_pk_bf16_f32 v12, v40, v41
    v_cvt_pk_bf16_f32 v13, v42, v43
    v_lshlrev_b32 v20, 16, v10
    v_and_b32 v21, 0xffff0000, v10
    v_lshlrev_b32 v22, 16, v11
    v_and_b32 v23, 0xffff0000, v11
    v_lshlrev_b32 v24, 16, v12
    v_and_b32 v25, 0xffff0000, v12
    v_lshlrev_b32 v26, 16, v13
    v_and_b32 v27, 0xffff0000, v13
    v_pk_add_f32 v[20:21], v[20:21], v[32:33] op_sel_hi:[1,0] neg_lo:[0,1] neg_hi:[0,1]
    v_pk_add_f32 v[22:23], v[22:23], v[32:33] op_sel_hi:[1,0] neg_lo:[0,1] neg_hi:[0,1]
    v_pk_add_f32 v[24:25], v[24:25], v[32:33] op_sel_hi:[1,0] neg_lo:[0,1] neg_hi:[0,1]
    v_pk_add_f32 v[26:27], v[26:27], v[32:33] op_sel_hi:[1,0] neg_lo:[0,1] neg_hi:[0,1]
    v_cvt_pk_bf16_f32 v28, v20, v21
    v_cvt_pk_bf16_f32 v29, v22, v23
    v_cvt_pk_bf16_f32 v30, v24, v25
    v_cvt_pk_bf16_f32 v31, v26, v27
    buffer_store_dwordx4 v[28:31], v1, s[12:15], s87 offen sc1
    buffer_load_dwordx4 v[112:115], v254, s[12:15], s79 offen offset:1024 sc1
    s_add_u32 s79, s86, s25
    buffer_load_dwordx4 v[116:119], v254, s[12:15], s79 offen sc1
    buffer_load_dwordx4 v[120:123], v254, s[12:15], s79 offen offset:1024 sc1
    s_add_u32 s79, s86, s26
    buffer_load_dwordx4 v[124:127], v254, s[12:15], s79 offen sc1
    buffer_load_dwordx4 v[128:131], v254, s[12:15], s79 offen offset:1024 sc1
    s_mov_b32 s94, 0
L_p31_body:
    s_waitcnt vmcnt(8)
    v_mfma_f32_32x32x16_bf16 v[36:51], v[140:143], v[100:103], 0
    v_mfma_f32_32x32x16_bf16 v[52:67], v[144:147], v[100:103], 0
    v_mfma_f32_32x32x16_bf16 a[144:159], a[112:115], v[100:103], 0
    s_add_u32 m0, s100, 21504
    s_mul_i32 s77, s18, 14
    s_add_u32 s77, s77, s93
    s_add_u32 s74, s77, 0
    buffer_load_dwordx4 v3, s[52:55], s74 offen lds
    s_waitcnt vmcnt(8)
    v_mfma_f32_32x32x16_bf16 v[36:51], v[148:151], v[104:107], v[36:51]
    v_mfma_f32_32x32x16_bf16 v[52:67], v[152:155], v[104:107], v[52:67]
    v_mfma_f32_32x32x16_bf16 a[144:159], a[116:119], v[104:107], a[144:159]
    buffer_load_dwordx4 v6, s[52:55], s74 offen offset:1024 lds
    s_waitcnt vmcnt(8)
    v_mfma_f32_32x32x16_bf16 v[36:51], v[156:159], v[108:111], v[36:51]
    v_mfma_f32_32x32x16_bf16 v[52:67], v[160:163], v[108:111], v[52:67]
    v_mfma_f32_32x32x16_bf16 a[144:159], a[120:123], v[108:111], a[144:159]
    s_add_u32 m0, s100, 23552
    s_add_u32 s74, s77, 14336
    buffer_load_dwordx4 v3, s[52:55], s74 offen lds
    s_waitcnt vmcnt(7)
    v_mfma_f32_32x32x16_bf16 v[36:51], v[164:167], v[112:115], v[36:51]
    v_mfma_f32_32x32x16_bf16 v[52:67], v[168:171], v[112:115], v[52:67]
    v_mfma_f32_32x32x16_bf16 a[144:159], a[124:127], v[112:115], a[144:159]
    buffer_load_dwordx4 v6, s[52:55], s74 offen offset:1024 lds
    s_waitcnt vmcnt(7)
    v_mfma_f32_32x32x16_bf16 v[36:51], v[172:175], v[116:119], v[36:51]
    v_mfma_f32_32x32x16_bf16 v[52:67], v[176:179], v[116:119], v[52:67]
    v_mfma_f32_32x32x16_bf16 a[144:159], a[128:131], v[116:119], a[144:159]
    s_add_u32 m0, s100, 26624
    s_mul_i32 s77, s16, 14
    s_add_u32 s77, s77, s93
    s_add_u32 s74, s77, 0
    buffer_load_dwordx4 v3, s[52:55], s74 offen lds
    s_waitcnt vmcnt(7)
    v_mfma_f32_32x32x16_bf16 v[36:51], v[180:183], v[120:123], v[36:51]
    v_mfma_f32_32x32x16_bf16 v[52:67], v[184:187], v[120:123], v[52:67]
    v_mfma_f32_32x32x16_bf16 a[144:159], a[132:135], v[120:123], a[144:159]
    buffer_load_dwordx4 v6, s[52:55], s74 offen offset:1024 lds
    s_waitcnt vmcnt(7)
    v_mfma_f32_32x32x16_bf16 v[36:51], a[224:227], v[124:127], v[36:51]
    v_mfma_f32_32x32x16_bf16 v[52:67], a[228:231], v[124:127], v[52:67]
    v_mfma_f32_32x32x16_bf16 a[144:159], a[136:139], v[124:127], a[144:159]
    s_waitcnt vmcnt(6)
    v_mfma_f32_32x32x16_bf16 v[36:51], a[232:235], v[128:131], v[36:51]
    v_mfma_f32_32x32x16_bf16 v[52:67], a[236:239], v[128:131], v[52:67]
    v_mfma_f32_32x32x16_bf16 a[144:159], a[140:143], v[128:131], a[144:159]
    v_lshlrev_b32 v20, 16, v14
    v_and_b32 v21, 0xffff0000, v14
    v_lshlrev_b32 v22, 16, v15
    v_and_b32 v23, 0xffff0000, v15
    v_lshlrev_b32 v24, 16, v16
    v_and_b32 v25, 0xffff0000, v16
    v_lshlrev_b32 v26, 16, v17
    v_and_b32 v27, 0xffff0000, v17
    s_nop 1
    v_cmp_u_f32 vcc, v36, v36
    s_nop 0
    s_cbranch_vccz L_p31_ok
    s_add_u32 s94, s94, 1
    s_cmp_gt_u32 s94, 131072
    s_cbranch_scc1 L_p31_ok
    s_waitcnt vmcnt(0)
    s_sleep 2
    s_add_u32 s79, s86, s23
    buffer_load_dwordx4 v[100:103], v254, s[12:15], s79 offen sc1
    buffer_load_dwordx4 v[104:107], v254, s[12:15], s79 offen offset:1024 sc1
    s_add_u32 s79, s86, s24
    buffer_load_dwordx4 v[108:111], v254, s[12:15], s79 offen sc1
    buffer_load_dwordx4 v[112:115], v254, s[12:15], s79 offen offset:1024 sc1
    s_add_u32 s79, s86, s25
    buffer_load_dwordx4 v[116:119], v254, s[12:15], s79 offen sc1
    buffer_load_dwordx4 v[120:123], v254, s[12:15], s79 offen offset:1024 sc1
    s_add_u32 s79, s86, s26
    buffer_load_dwordx4 v[124:127], v254, s[12:15], s79 offen sc1
    buffer_load_dwordx4 v[128:131], v254, s[12:15], s79 offen offset:1024 sc1
    s_waitcnt vmcnt(0)
    s_branch L_p31_body
L_p31_ok:
    ds_write_b128 v188, v[52:55] offset:6144
    s_add_u32 s71, s88, 0
    buffer_load_dwordx4 v[68:71], v1, s[12:15], s71 offen sc1
    ds_write_b128 v188, v[56:59] offset:7168
    buffer_load_dwordx4 v[72:75], v1, s[12:15], s71 offen offset:1024 sc1
    ds_write_b128 v189, v[44:47] offset:6144
    buffer_load_dwordx4 v[76:79], v1, s[12:15], s71 offen offset:2048 sc1
    ds_write_b128 v189, v[48:51] offset:7168
    buffer_load_dwordx4 v[80:83], v1, s[12:15], s71 offen offset:3072 sc1
    ds_write_b128 v190, v[60:63] offset:6144
    s_add_u32 s71, s88, 4096
    buffer_load_dwordx4 v[84:87], v1, s[12:15], s71 offen sc1
    ds_write_b128 v190, v[64:67] offset:7168
    buffer_load_dwordx4 v[88:91], v1, s[12:15], s71 offen offset:1024 sc1
    v_and_b32 v8, 0x3ff, v191
    ds_write_b32 v8, a144 offset:3072
    v_pk_add_f32 v[36:37], v[36:37], v[20:21]
    v_pk_add_f32 v[38:39], v[38:39], v[22:23]
    v_pk_add_f32 v[40:41], v[40:41], v[24:25]
    v_pk_add_f32 v[42:43], v[42:43], v[26:27]
    buffer_load_dwordx4 v[92:95], v1, s[12:15], s71 offen offset:2048 sc1
    ds_read_b64_tr_b16 a[144:145], v18 offset:12288
    ds_read_b64_tr_b16 a[146:147], v18 offset:13312
    ds_read_b64_tr_b16 a[148:149], v19 offset:12288
    ds_read_b64_tr_b16 a[150:151], v19 offset:13312
    ds_read_b64_tr_b16 a[152:153], v18 offset:14336
    ds_read_b64_tr_b16 a[154:155], v18 offset:15360
    ds_read_b64_tr_b16 a[156:157], v19 offset:14336
    ds_read_b64_tr_b16 a[158:159], v19 offset:15360
    ds_read_b64_tr_b16 a[224:225], v18 offset:16384
    ds_read_b64_tr_b16 a[226:227], v18 offset:17408
    ds_read_b64_tr_b16 a[228:229], v19 offset:16384
    ds_read_b64_tr_b16 a[230:231], v19 offset:17408
    ds_read_b64_tr_b16 a[232:233], v18 offset:19456
    ds_read_b64_tr_b16 a[234:235], v18 offset:20480
    ds_read_b64_tr_b16 a[236:237], v19 offset:19456
    ds_read_b64_tr_b16 a[238:239], v19 offset:20480
    s_waitcnt vmcnt(11)
    ds_read_b64_tr_b16 a[240:241], v18 offset:21504
    ds_read_b64_tr_b16 a[242:243], v18 offset:22528
    ds_read_b64_tr_b16 a[244:245], v19 offset:21504
    ds_read_b64_tr_b16 a[246:247], v19 offset:22528
    s_waitcnt vmcnt(9)
    ds_read_b64_tr_b16 a[248:249], v18 offset:23552
    ds_read_b64_tr_b16 a[250:251], v18 offset:24576
    ds_read_b64_tr_b16 a[252:253], v19 offset:23552
    ds_read_b64_tr_b16 a[254:255], v19 offset:24576
    s_waitcnt lgkmcnt(0)
    v_add_u32 v9, s100, v1
    s_mov_b32 s94, 0
L_p40_body:
    s_waitcnt vmcnt(6)
    ds_write_b128 v9, v[68:71] offset:12288
    v_dot2_f32_bf16 v96, v68, v68, 0
    v_dot2_f32_bf16 v96, v69, v69, v96
    v_dot2_f32_bf16 v96, v70, v70, v96
    v_dot2_f32_bf16 v96, v71, v71, v96
    s_waitcnt vmcnt(5)
    ds_write_b128 v9, v[72:75] offset:13312
    v_dot2_f32_bf16 v96, v72, v72, v96
    v_dot2_f32_bf16 v96, v73, v73, v96
    v_dot2_f32_bf16 v96, v74, v74, v96
    v_dot2_f32_bf16 v96, v75, v75, v96
    s_waitcnt vmcnt(4)
    ds_write_b128 v9, v[76:79] offset:14336
    v_dot2_f32_bf16 v96, v76, v76, v96
    v_dot2_f32_bf16 v96, v77, v77, v96
    v_dot2_f32_bf16 v96, v78, v78, v96
    v_dot2_f32_bf16 v96, v79, v79, v96
    s_waitcnt vmcnt(3)
    ds_write_b128 v9, v[80:83] offset:15360
    v_dot2_f32_bf16 v96, v80, v80, v96
    v_dot2_f32_bf16 v96, v81, v81, v96
    v_dot2_f32_bf16 v96, v82, v82, v96
    v_dot2_f32_bf16 v96, v83, v83, v96
    s_waitcnt vmcnt(2)
    ds_write_b128 v9, v[84:87] offset:16384
    v_dot2_f32_bf16 v96, v84, v84, v96
    v_dot2_f32_bf16 v96, v85, v85, v96
    v_dot2_f32_bf16 v96, v86, v86, v96
    v_dot2_f32_bf16 v96, v87, v87, v96
    s_waitcnt vmcnt(1)
    ds_write_b128 v9, v[88:91] offset:17408
    v_dot2_f32_bf16 v96, v88, v88, v96
    v_dot2_f32_bf16 v96, v89, v89, v96
    v_dot2_f32_bf16 v96, v90, v90, v96
    v_dot2_f32_bf16 v96, v91, v91, v96
    s_waitcnt vmcnt(0)
    ds_write_b128 v9, v[92:95] offset:18432
    v_dot2_f32_bf16 v96, v92, v92, v96
    v_dot2_f32_bf16 v96, v93, v93, v96
    v_dot2_f32_bf16 v96, v94, v94, v96
    v_dot2_f32_bf16 v96, v95, v95, v96
    s_lshl_b32 s70, s4, 8
    v_lshl_add_u32 v9, v0, 2, s70
    s_nop 0
    v_cmp_u_f32 vcc, v96, v96
    s_nop 0
    s_cbranch_vccz L_p40_ok
    s_add_u32 s94, s94, 1
    s_cmp_gt_u32 s94, 131072
    s_cbranch_scc1 L_p40_ok
    s_waitcnt vmcnt(0)
    s_sleep 2
    v_add_u32 v9, s100, v1
    s_add_u32 s71, s88, 0
    buffer_load_dwordx4 v[68:71], v1, s[12:15], s71 offen sc1
    buffer_load_dwordx4 v[72:75], v1, s[12:15], s71 offen offset:1024 sc1
    buffer_load_dwordx4 v[76:79], v1, s[12:15], s71 offen offset:2048 sc1
    buffer_load_dwordx4 v[80:83], v1, s[12:15], s71 offen offset:3072 sc1
    s_add_u32 s71, s88, 4096
    buffer_load_dwordx4 v[84:87], v1, s[12:15], s71 offen sc1
    buffer_load_dwordx4 v[88:91], v1, s[12:15], s71 offen offset:1024 sc1
    buffer_load_dwordx4 v[92:95], v1, s[12:15], s71 offen offset:2048 sc1
    s_waitcnt vmcnt(0)
    s_branch L_p40_body
L_p40_ok:
    ds_write_b32 v9, v96 offset:4096
    v_add_u32 v7, 28672, v1
    v_add_u32 v8, 65536, v1
    v_add_u32 v253, 102400, v1
    v_add_u32 v254, 139264, v1
    s_waitcnt lgkmcnt(0)
    s_barrier
    ds_read_b128 v[108:111], v7 offset:0
    ds_read_b128 v[112:115], v7 offset:1024
    ds_read_b128 v[116:119], v7 offset:2048
    ds_read_b128 v[120:123], v7 offset:3072
    ds_read_b128 v[124:127], v7 offset:4096
    ds_read_b128 v[128:131], v7 offset:5120
.p2align 3
    s_waitcnt lgkmcnt(4)
    v_mfma_f32_32x32x16_bf16 v[20:35], a[0:3], v[108:111], 0
    ds_read_b128 v[132:135], v7 offset:6144
    v_and_b32 v97, 31, v0
    v_lshlrev_b32 v96, 3, v97
    v_lshlrev_b32 v97, 2, v97
    ds_read_b32 v96, v96 offset:512
    ds_read2st64_b32 v[92:93], v97 offset0:12 offset1:13
    ds_read2st64_b32 v[94:95], v97 offset0:14 offset1:15
    v_add_u32_e64 v252, s100, v1
    v_mfma_f32_32x32x16_bf16 v[20:35], a[8:11], v[112:115], v[20:35]
    ds_read_b128 v[136:139], v8 offset:0
    ds_read_b128 v[52:55], v252 offset:6144
    ds_read_b128 v[56:59], v252 offset:7168
    ds_read_b128 v[44:47], v252 offset:8192
    ds_read_b128 v[48:51], v252 offset:9216
    ds_read_b128 v[60:63], v252 offset:10240
    ds_read_b128 v[64:67], v252 offset:11264
    s_waitcnt lgkmcnt(8)
    v_add_f32 v96, v96, v92
    v_mfma_f32_32x32x16_bf16 v[20:35], a[16:19], v[116:119], v[20:35]
    ds_read_b128 v[140:143], v8 offset:1024
    v_add_f32 v96, v96, v93
    s_waitcnt lgkmcnt(8)
    v_add_f32 v96, v96, v94
    v_add_f32 v96, v96, v95
    s_waitcnt lgkmcnt(6)
    v_add_f32 v36, v36, v52
    v_add_f32 v37, v37, v53
    v_add_f32 v38, v38, v54
    v_add_f32 v39, v39, v55
    s_waitcnt lgkmcnt(5)
    v_add_f32_e64 v40, v40, v56
    v_mfma_f32_32x32x16_bf16 v[20:35], a[24:27], v[120:123], v[20:35]
    ds_read_b128 v[144:147], v8 offset:2048
    v_add_f32 v41, v41, v57
    v_add_f32 v42, v42, v58
    v_add_f32 v43, v43, v59
    s_waitcnt lgkmcnt(5)
    v_add_f32 v36, v36, v44
    v_add_f32 v37, v37, v45
    v_add_f32 v38, v38, v46
    v_add_f32 v39, v39, v47
    v_mfma_f32_32x32x16_bf16 v[20:35], a[32:35], v[124:127], v[20:35]
    ds_read_b128 v[148:151], v8 offset:3072
    s_waitcnt lgkmcnt(5)
    v_add_f32 v40, v40, v48
    v_add_f32 v41, v41, v49
    v_add_f32 v42, v42, v50
    v_add_f32 v43, v43, v51
    s_waitcnt lgkmcnt(4)
    v_add_f32 v36, v36, v60
    v_add_f32 v37, v37, v61
    v_add_f32_e64 v38, v38, v62
    v_mfma_f32_32x32x16_bf16 v[20:35], a[40:43], v[128:131], v[20:35]
    ds_read_b128 v[152:155], v8 offset:4096
    v_add_f32 v39, v39, v63
    s_waitcnt lgkmcnt(4)
    v_add_f32 v40, v40, v64
    v_add_f32 v41, v41, v65
    v_add_f32 v42, v42, v66
    v_add_f32 v43, v43, v67
    v_cvt_pk_bf16_f32 v14, v36, v37
    v_cvt_pk_bf16_f32 v15, v38, v39
    v_cvt_pk_bf16_f32 v16, v40, v41
    v_mfma_f32_32x32x16_bf16 v[20:35], a[48:51], v[132:135], v[20:35]
    ds_read_b128 v[156:159], v8 offset:5120
    v_cvt_pk_bf16_f32 v17, v42, v43
    v_lshlrev_b32_e64 v84, 16, v14
    v_and_b32 v85, 0xffff0000, v14
    v_lshlrev_b32_e64 v86, 16, v15
    v_and_b32 v87, 0xffff0000, v15
    v_lshlrev_b32_e64 v88, 16, v16
    v_and_b32 v89, 0xffff0000, v16
    v_mfma_f32_32x32x16_bf16 v[20:35], a[56:59], v[136:139], v[20:35]
    ds_read_b128 v[160:163], v8 offset:6144
    v_lshlrev_b32_e64 v90, 16, v17
    v_and_b32 v91, 0xffff0000, v17
    v_sub_f32 v84, v84, v96
    v_sub_f32 v85, v85, v96
    v_sub_f32 v86, v86, v96
    v_sub_f32 v87, v87, v96
    v_sub_f32 v88, v88, v96
    s_waitcnt lgkmcnt(4)
    v_mfma_f32_32x32x16_bf16 v[20:35], a[64:67], v[140:143], v[20:35]
    ds_read_b128 v[164:167], v253 offset:0
    v_sub_f32 v89, v89, v96
    v_sub_f32 v90, v90, v96
    v_sub_f32_e64 v91, v91, v96
    v_cvt_pk_bf16_f32 v92, v84, v85
    v_cvt_pk_bf16_f32 v93, v86, v87
    v_cvt_pk_bf16_f32 v94, v88, v89
    v_cvt_pk_bf16_f32 v95, v90, v91
    buffer_store_dwordx4 v[92:95], v1, s[12:15], s39 offen sc1
    v_mfma_f32_32x32x16_bf16 v[20:35], a[72:75], v[144:147], v[20:35]
    ds_read_b128 v[36:39], v253 offset:1024
    s_waitcnt lgkmcnt(4)
    v_mfma_f32_32x32x16_bf16 v[20:35], a[80:83], v[148:151], v[20:35]
    ds_read_b128 v[40:43], v253 offset:2048
    s_add_u32 m0, s100, 28672
    s_mul_i32 s77, s16, 14
    s_add_u32 s77, s77, s93
    s_add_u32 s74, s77, 14336
    buffer_load_dwordx4 v3, s[52:55], s74 offen lds
    buffer_load_dwordx4 v6, s[52:55], s74 offen offset:1024 lds
    ds_read_b64_tr_b16 a[112:113], v18 offset:26624
    ds_read_b64_tr_b16 a[114:115], v18 offset:27648
    ds_read_b64_tr_b16 a[116:117], v19 offset:26624
    ds_read_b64_tr_b16 a[118:119], v19 offset:27648
    v_and_b32 v9, 31, v0
    v_mfma_f32_32x32x16_bf16 v[20:35], a[88:91], v[152:155], v[20:35]
    ds_read_b128 v[44:47], v253 offset:3072
    v_lshlrev_b32_e64 v9, 2, v9
    v_add_u32 v9, 4096, v9
    s_waitcnt lgkmcnt(8)
    v_mfma_f32_32x32x16_bf16 v[20:35], a[96:99], v[156:159], v[20:35]
    ds_read_b128 v[48:51], v253 offset:4096
    ds_read2_b32 v[68:69], v9 offset0:0 offset1:32
    ds_read2_b32 v[70:71], v9 offset0:64 offset1:96
    v_mfma_f32_32x32x16_bf16 v[20:35], a[104:107], v[160:163], v[20:35]
    ds_read_b128 v[52:55], v253 offset:5120
    s_add_u32 m0, s100, 30720
    s_add_u32 s74, s77, 28672
    buffer_load_dwordx4 v3, s[52:55], s74 offen lds
    buffer_load_dwordx4 v6, s[52:55], s74 offen offset:1024 lds
    ds_read2_b32 v[72:73], v9 offset0:128 offset1:160
    s_waitcnt lgkmcnt(11)
    v_mfma_f32_32x32x16_bf16 v[20:35], a[160:163], v[164:167], v[20:35]
    ds_read_b128 v[56:59], v253 offset:6144
    ds_read2_b32 v[74:75], v9 offset0:192 offset1:224
    v_mov_b32 v106, 0x3eeff558
    v_mfma_f32_32x32x16_bf16 v[20:35], a[168:171], v[36:39], v[20:35]
    ds_read_b128 v[60:63], v254 offset:0
    v_lshrrev_b32 v107, 5, v0
    v_lshlrev_b32_e64 v107, 4, v107
    s_waitcnt lgkmcnt(8)
    v_mfma_f32_32x32x16_bf16 v[20:35], a[176:179], v[40:43], v[20:35]
    ds_read_b128 v[64:67], v254 offset:1024
    s_add_u32 m0, s100, 32768
    s_add_u32 s74, s77, 43008
    buffer_load_dwordx4 v3, s[52:55], s74 offen lds
    buffer_load_dwordx4 v6, s[52:55], s74 offen offset:1024 lds
    s_lshl_b32 s76, s4, 8
    v_mfma_f32_32x32x16_bf16 v[20:35], a[184:187], v[44:47], v[20:35]
    ds_read_b128 v[36:39], v254 offset:2048
    v_add_u32 v107, s76, v107
    s_waitcnt lgkmcnt(8)
    v_add_f32_e64 v68, v68, v69
    s_waitcnt lgkmcnt(6)
    v_mfma_f32_32x32x16_bf16 v[20:35], a[192:195], v[48:51], v[20:35]
    ds_read_b128 v[40:43], v254 offset:3072
    v_add_f32 v70, v70, v71
    s_waitcnt lgkmcnt(6)
    v_add_f32_e64 v72, v72, v73
    v_mfma_f32_32x32x16_bf16 v[20:35], a[200:203], v[52:55], v[20:35]
    ds_read_b128 v[44:47], v254 offset:4096
    s_add_u32 m0, s100, 34816
    s_mul_i32 s77, s18, 14
    s_add_u32 s77, s77, s93
    s_add_u32 s74, s77, 28672
    buffer_load_dwordx4 v3, s[52:55], s74 offen lds
    buffer_load_dwordx4 v6, s[52:55], s74 offen offset:1024 lds
    s_waitcnt lgkmcnt(5)
    v_add_f32_e64 v74, v74, v75
    s_waitcnt lgkmcnt(4)
    v_mfma_f32_32x32x16_bf16 v[20:35], a[208:211], v[56:59], v[20:35]
    ds_read_b128 v[48:51], v254 offset:5120
    v_add_f32 v68, v68, v70
    v_add_f32 v72, v72, v74
    v_mfma_f32_32x32x16_bf16 v[20:35], a[216:219], v[60:63], v[20:35]
    ds_read_b128 v[52:55], v254 offset:6144
    v_add_f32_e64 v68, v68, v72
    v_mul_f32 v68, 0x3b124925, v68
    s_waitcnt lgkmcnt(4)
    v_mfma_f32_32x32x16_bf16 v[20:35], v[196:199], v[64:67], v[20:35]
    s_add_u32 m0, s100, 0
    s_add_u32 s74, s77, 43008
    buffer_load_dwordx4 v3, s[52:55], s74 offen lds
    buffer_load_dwordx4 v6, s[52:55], s74 offen offset:1024 lds
    v_cvt_pk_bf16_f32 v68, v2, v68
    v_mfma_f32_32x32x16_bf16 v[20:35], v[204:207], v[36:39], v[20:35]
    v_add_f32 v68, 0x3727c5ac, v68
    v_cvt_pk_bf16_f32 v68, v2, v68
    s_waitcnt lgkmcnt(2)
    v_mfma_f32_32x32x16_bf16 v[20:35], v[212:215], v[40:43], v[20:35]
    v_sqrt_f32_e64 v68, v68
    s_nop 0
    v_cvt_pk_bf16_f32 v68, v2, v68
    v_mfma_f32_32x32x16_bf16 v[20:35], v[220:223], v[44:47], v[20:35]
    s_add_u32 m0, s100, 2048
    s_mul_i32 s77, s19, 14
    s_add_u32 s77, s77, s93
    s_add_u32 s74, s77, 0
    buffer_load_dwordx4 v3, s[52:55], s74 offen lds
    buffer_load_dwordx4 v6, s[52:55], s74 offen offset:1024 lds
    v_rcp_f32_e64 v68, v68
    s_nop 0
    v_mul_f32 v104, 0x3eeff558, v68
    s_waitcnt lgkmcnt(0)
    v_mfma_f32_32x32x16_bf16 v[20:35], v[228:231], v[48:51], v[20:35]
    s_waitcnt vmcnt(10)
    ds_read_b64_tr_b16 a[120:121], v18 offset:28672
    ds_read_b64_tr_b16 a[122:123], v18 offset:29696
    ds_read_b64_tr_b16 a[124:125], v19 offset:28672
    ds_read_b64_tr_b16 a[126:127], v19 offset:29696
    v_mfma_f32_32x32x16_bf16 v[20:35], v[236:239], v[52:55], v[20:35]
    v_mfma_f32_32x32x16_bf16 v[36:51], a[4:7], v[108:111], 0
    v_mfma_f32_32x32x16_bf16 v[36:51], a[12:15], v[112:115], v[36:51]
    s_waitcnt vmcnt(8)
    ds_read_b64_tr_b16 a[128:129], v18 offset:30720
    ds_read_b64_tr_b16 a[130:131], v18 offset:31744
    ds_read_b64_tr_b16 a[132:133], v19 offset:30720
    ds_read_b64_tr_b16 a[134:135], v19 offset:31744
    v_mfma_f32_32x32x16_bf16 v[36:51], a[20:23], v[116:119], v[36:51]
    ds_read_b128 v[68:71], v107 offset:768
    ds_read_b128 v[72:75], v107 offset:800
    ds_read_b128 v[76:79], v107 offset:832
    ds_read_b128 v[80:83], v107 offset:864
    v_mfma_f32_32x32x16_bf16 v[36:51], a[28:31], v[120:123], v[36:51]
    s_waitcnt lgkmcnt(3)
    v_fma_f32 v20, v20, v104, v68
    v_fma_f32 v21, v21, v104, v69
    v_fma_f32 v22, v22, v104, v70
    v_fma_f32 v23, v23, v104, v71
    v_fmaak_f32 v84, v20, v20, 0x409d30fc
    v_mfma_f32_32x32x16_bf16 v[36:51], a[36:39], v[124:127], v[36:51]
    s_add_u32 s71, s88, 28672
    buffer_load_dwordx4 v[168:171], v1, s[12:15], s71 offen sc1
    buffer_load_dwordx4 v[172:175], v1, s[12:15], s71 offen offset:1024 sc1
    s_waitcnt vmcnt(8)
    ds_read_b64_tr_b16 a[136:137], v18 offset:32768
    ds_read_b64_tr_b16 a[138:139], v18 offset:33792
    ds_read_b64_tr_b16 a[140:141], v19 offset:32768
    ds_read_b64_tr_b16 a[142:143], v19 offset:33792
    v_fmaak_f32 v85, v21, v21, 0x409d30fc
    v_fmaak_f32 v86, v22, v22, 0x409d30fc
    v_fmaak_f32 v87, v23, v23, 0x409d30fc
    v_mul_f32 v84, v84, v20
    v_mul_f32_e64 v85, v85, v21
    v_mfma_f32_32x32x16_bf16 v[36:51], a[44:47], v[128:131], v[36:51]
    v_mul_f32 v86, v86, v22
    v_mul_f32 v87, v87, v23
    v_exp_f32 v84, -v84
    v_exp_f32 v85, -v85
    v_exp_f32 v86, -v86
    v_mfma_f32_32x32x16_bf16 v[36:51], a[52:55], v[132:135], v[36:51]
    buffer_load_dwordx4 v[176:179], v1, s[12:15], s71 offen offset:2048 sc1
    buffer_load_dwordx4 v[180:183], v1, s[12:15], s71 offen offset:3072 sc1
    v_exp_f32 v87, -v87
    v_fma_f32 v84, v84, v106, v106
    v_fma_f32 v85, v85, v106, v106
    v_fma_f32 v86, v86, v106, v106
    v_fma_f32 v87, v87, v106, v106
    v_mfma_f32_32x32x16_bf16 v[36:51], a[60:63], v[136:139], v[36:51]
    v_rcp_f32 v84, v84
    v_rcp_f32 v85, v85
    v_rcp_f32 v86, v86
    v_rcp_f32 v87, v87
    v_mul_f32_e64 v20, v20, v84
    v_mfma_f32_32x32x16_bf16 v[36:51], a[68:71], v[140:143], v[36:51]
    s_add_u32 s71, s88, 32768
    buffer_load_dwordx4 v[184:187], v1, s[12:15], s71 offen sc1
    buffer_load_dwordx4 v[188:191], v1, s[12:15], s71 offen offset:1024 sc1
    v_mul_f32 v21, v21, v85
    v_mul_f32 v22, v22, v86
    v_mul_f32_e64 v23, v23, v87
    v_cvt_pk_bf16_f32 v92, v20, v21
    v_mfma_f32_32x32x16_bf16 v[36:51], a[76:79], v[144:147], v[36:51]
    ds_read_b128 v[108:111], v253 offset:1024
    v_cvt_pk_bf16_f32 v93, v22, v23
    s_waitcnt lgkmcnt(7)
    v_fma_f32 v24, v24, v104, v72
    v_fma_f32 v25, v25, v104, v73
    v_fma_f32 v26, v26, v104, v74
    v_fma_f32 v27, v27, v104, v75
    v_mfma_f32_32x32x16_bf16 v[36:51], a[84:87], v[148:151], v[36:51]
    ds_read_b128 v[112:115], v253 offset:2048
    buffer_load_dwordx4 v[192:195], v1, s[12:15], s71 offen offset:2048 sc1
    v_fmaak_f32 v88, v24, v24, 0x409d30fc
    v_fmaak_f32 v89, v25, v25, 0x409d30fc
    v_fmaak_f32 v90, v26, v26, 0x409d30fc
    v_fmaak_f32 v91, v27, v27, 0x409d30fc
    v_mul_f32 v88, v88, v24
    v_mfma_f32_32x32x16_bf16 v[36:51], a[92:95], v[152:155], v[36:51]
    ds_read_b128 v[116:119], v253 offset:3072
    s_waitcnt vmcnt(11)
    ds_read_b64_tr_b16 v[140:141], v18 offset:34816
    ds_read_b64_tr_b16 v[142:143], v18 offset:35840
    ds_read_b64_tr_b16 v[144:145], v19 offset:34816
    ds_read_b64_tr_b16 v[146:147], v19 offset:35840
    v_mul_f32 v89, v89, v25
    v_mul_f32 v90, v90, v26
    v_mul_f32 v91, v91, v27
    v_exp_f32 v88, -v88
    v_exp_f32 v89, -v89
    v_mfma_f32_32x32x16_bf16 v[36:51], a[100:103], v[156:159], v[36:51]
    ds_read_b128 v[120:123], v253 offset:4096
    v_exp_f32 v90, -v90
    v_exp_f32 v91, -v91
    v_fma_f32 v88, v88, v106, v106
    v_fma_f32 v89, v89, v106, v106
    v_fma_f32 v90, v90, v106, v106
    v_mfma_f32_32x32x16_bf16 v[36:51], a[108:111], v[160:163], v[36:51]
    ds_read_b128 v[124:127], v253 offset:5120
    s_waitcnt vmcnt(9)
    ds_read_b64_tr_b16 v[148:149], v18 offset:0
    ds_read_b64_tr_b16 v[150:151], v18 offset:1024
    ds_read_b64_tr_b16 v[152:153], v19 offset:0
    ds_read_b64_tr_b16 v[154:155], v19 offset:1024
    v_fma_f32 v91, v91, v106, v106
    v_rcp_f32 v88, v88
    v_rcp_f32 v89, v89
    v_rcp_f32 v90, v90
    v_rcp_f32 v91, v91
    s_waitcnt lgkmcnt(12)
    v_mfma_f32_32x32x16_bf16 v[36:51], a[164:167], v[164:167], v[36:51]
    ds_read_b128 v[128:131], v253 offset:6144
    v_mul_f32 v24, v24, v88
    v_mul_f32 v25, v25, v89
    v_mul_f32 v26, v26, v90
    v_mul_f32 v27, v27, v91
    v_cvt_pk_bf16_f32 v94, v24, v25
    v_mfma_f32_32x32x16_bf16 v[36:51], a[172:175], v[108:111], v[36:51]
    ds_read_b128 v[132:135], v254 offset:0
    s_waitcnt vmcnt(7)
    ds_read_b64_tr_b16 v[156:157], v18 offset:2048
    ds_read_b64_tr_b16 v[158:159], v18 offset:3072
    ds_read_b64_tr_b16 v[160:161], v19 offset:2048
    ds_read_b64_tr_b16 v[162:163], v19 offset:3072
    v_cvt_pk_bf16_f32 v95, v26, v27
    buffer_store_dwordx4 v[92:95], v1, s[12:15], s89 offen sc1
    v_fma_f32 v28, v28, v104, v76
    v_fma_f32 v29, v29, v104, v77
    s_waitcnt lgkmcnt(15)
    v_mfma_f32_32x32x16_bf16 v[36:51], a[180:183], v[112:115], v[36:51]
    ds_read_b128 v[136:139], v254 offset:1024
    v_fma_f32 v30, v30, v104, v78
    v_fma_f32 v31, v31, v104, v79
    v_fmaak_f32 v84, v28, v28, 0x409d30fc
    v_fmaak_f32 v85, v29, v29, 0x409d30fc
    v_fmaak_f32 v86, v30, v30, 0x409d30fc
    v_mfma_f32_32x32x16_bf16 v[36:51], a[188:191], v[116:119], v[36:51]
    ds_read_b128 v[108:111], v254 offset:2048
    v_fmaak_f32 v87, v31, v31, 0x409d30fc
    v_mul_f32 v84, v84, v28
    v_mul_f32 v85, v85, v29
    v_mul_f32 v86, v86, v30
    v_mul_f32_e64 v87, v87, v31
    s_waitcnt lgkmcnt(12)
    v_mfma_f32_32x32x16_bf16 v[36:51], a[196:199], v[120:123], v[36:51]
    ds_read_b128 v[112:115], v254 offset:3072
    v_exp_f32 v84, -v84
    v_exp_f32 v85, -v85
    v_exp_f32 v86, -v86
    v_exp_f32 v87, -v87
    v_fma_f32 v84, v84, v106, v106
    v_mfma_f32_32x32x16_bf16 v[36:51], a[204:207], v[124:127], v[36:51]
    ds_read_b128 v[116:119], v254 offset:4096
    v_fma_f32 v85, v85, v106, v106
    v_fma_f32 v86, v86, v106, v106
    v_fma_f32 v87, v87, v106, v106
    v_rcp_f32 v84, v84
    v_rcp_f32_e64 v85, v85
    s_waitcnt lgkmcnt(8)
    v_mfma_f32_32x32x16_bf16 v[36:51], a[212:215], v[128:131], v[36:51]
    ds_read_b128 v[120:123], v254 offset:5120
    v_rcp_f32 v86, v86
    v_rcp_f32 v87, v87
    v_mul_f32 v28, v28, v84
    v_mul_f32 v29, v29, v85
    v_mul_f32_e64 v30, v30, v86
    v_mfma_f32_32x32x16_bf16 v[36:51], a[220:223], v[132:135], v[36:51]
    ds_read_b128 v[124:127], v254 offset:6144
    v_mul_f32_e64 v31, v31, v87
    v_cvt_pk_bf16_f32 v96, v28, v29
    v_cvt_pk_bf16_f32 v97, v30, v31
    v_fma_f32 v32, v32, v104, v80
    s_waitcnt lgkmcnt(4)
    v_mfma_f32_32x32x16_bf16 v[36:51], v[200:203], v[136:139], v[36:51]
    v_fma_f32 v33, v33, v104, v81
    v_fma_f32 v34, v34, v104, v82
    v_fma_f32 v35, v35, v104, v83
    v_fmaak_f32 v88, v32, v32, 0x409d30fc
    v_fmaak_f32 v89, v33, v33, 0x409d30fc
    v_mfma_f32_32x32x16_bf16 v[36:51], v[208:211], v[108:111], v[36:51]
    v_fmaak_f32 v90, v34, v34, 0x409d30fc
    v_fmaak_f32 v91, v35, v35, 0x409d30fc
    v_mul_f32 v88, v88, v32
    v_mul_f32 v89, v89, v33
    v_mul_f32_e64 v90, v90, v34
    s_waitcnt lgkmcnt(2)
    v_mfma_f32_32x32x16_bf16 v[36:51], v[216:219], v[112:115], v[36:51]
    v_mul_f32_e64 v91, v91, v35
    v_exp_f32 v88, -v88
    v_exp_f32 v89, -v89
    v_exp_f32 v90, -v90
    v_exp_f32 v91, -v91
    v_mfma_f32_32x32x16_bf16 v[36:51], v[224:227], v[116:119], v[36:51]
    v_fma_f32 v88, v88, v106, v106
    v_fma_f32 v89, v89, v106, v106
    v_fma_f32 v90, v90, v106, v106
    v_fma_f32 v91, v91, v106, v106
    v_rcp_f32 v88, v88
    s_waitcnt lgkmcnt(0)
    v_mfma_f32_32x32x16_bf16 v[36:51], v[232:235], v[120:123], v[36:51]
    v_rcp_f32 v89, v89
    v_rcp_f32 v90, v90
    v_rcp_f32 v91, v91
    v_mul_f32 v32, v32, v88
    v_mul_f32_e64 v33, v33, v89
    v_mfma_f32_32x32x16_bf16 v[36:51], v[240:243], v[124:127], v[36:51]
    v_mul_f32 v34, v34, v90
    v_mul_f32 v35, v35, v91
    v_cvt_pk_bf16_f32 v98, v32, v33
    v_cvt_pk_bf16_f32 v99, v34, v35
    buffer_store_dwordx4 v[96:99], v1, s[12:15], s89 offen offset:1024 sc1
    v_mov_b32 v100, 0x409d30fc
    v_add_u32_e64 v252, s100, v1
    ds_read_b128 v[68:71], v107 offset:896
    ds_read_b128 v[72:75], v107 offset:928
    ds_read_b128 v[76:79], v107 offset:960
    ds_read_b128 v[80:83], v107 offset:992
    s_waitcnt lgkmcnt(3)
    v_pk_fma_f32 v[36:37], v[36:37], v[104:105], v[68:69] op_sel:[0,0,0] op_sel_hi:[1,0,1]
    v_pk_fma_f32 v[38:39], v[38:39], v[104:105], v[70:71] op_sel:[0,0,0] op_sel_hi:[1,0,1]
    v_pk_fma_f32 v[84:85], v[36:37], v[36:37], v[100:101] op_sel_hi:[1,1,0]
    v_pk_fma_f32 v[86:87], v[38:39], v[38:39], v[100:101] op_sel_hi:[1,1,0]
    v_pk_mul_f32 v[84:85], v[84:85], v[36:37] neg_lo:[1,0] neg_hi:[1,0]
    v_pk_mul_f32 v[86:87], v[86:87], v[38:39] neg_lo:[1,0] neg_hi:[1,0]
    v_exp_f32_e64 v84, v84
    s_waitcnt vmcnt(2)
    ds_write_b128 v252, v[168:171] offset:19456
    s_add_u32 m0, s100, 8192
    s_add_u32 s74, s77, 43008
    buffer_load_dwordx4 v3, s[52:55], s74 offen lds
    buffer_load_dwordx4 v6, s[52:55], s74 offen offset:1024 lds
    v_exp_f32 v85, v85
    v_exp_f32 v86, v86
    v_exp_f32_e64 v87, v87
    v_pk_fma_f32 v[84:85], v[84:85], v[106:107], v[106:107] op_sel_hi:[1,0,0]
    v_pk_fma_f32 v[86:87], v[86:87], v[106:107], v[106:107] op_sel_hi:[1,0,0]
    v_rcp_f32 v84, v84
    v_rcp_f32 v85, v85
    v_rcp_f32_e64 v86, v86
    ds_write_b128 v252, v[172:175] offset:20480
    v_rcp_f32_e64 v87, v87
    v_pk_mul_f32 v[36:37], v[36:37], v[84:85]
    v_pk_mul_f32 v[38:39], v[38:39], v[86:87]
    v_cvt_pk_bf16_f32 v92, v36, v37
    v_cvt_pk_bf16_f32 v93, v38, v39
    s_waitcnt lgkmcnt(4)
    v_pk_fma_f32 v[40:41], v[40:41], v[104:105], v[72:73] op_sel:[0,0,0] op_sel_hi:[1,0,1]
    v_pk_fma_f32 v[42:43], v[42:43], v[104:105], v[74:75] op_sel:[0,0,0] op_sel_hi:[1,0,1]
    v_pk_fma_f32 v[88:89], v[40:41], v[40:41], v[100:101] op_sel_hi:[1,1,0]
    ds_write_b128 v252, v[176:179] offset:21504
    s_add_u32 m0, s100, 10240
    s_mul_i32 s77, s20, 14
    s_add_u32 s77, s77, s93
    s_add_u32 s74, s77, 0
    buffer_load_dwordx4 v3, s[52:55], s74 offen lds
    buffer_load_dwordx4 v6, s[52:55], s74 offen offset:1024 lds
    v_pk_fma_f32 v[90:91], v[42:43], v[42:43], v[100:101] op_sel_hi:[1,1,0]
    v_pk_mul_f32 v[88:89], v[88:89], v[40:41] neg_lo:[1,0] neg_hi:[1,0]
    v_pk_mul_f32 v[90:91], v[90:91], v[42:43] neg_lo:[1,0] neg_hi:[1,0]
    v_exp_f32 v88, v88
    v_exp_f32 v89, v89
    v_exp_f32 v90, v90
    v_exp_f32 v91, v91
    v_pk_fma_f32 v[88:89], v[88:89], v[106:107], v[106:107] op_sel_hi:[1,0,0]
    ds_write_b128 v252, v[180:183] offset:22528
    v_pk_fma_f32 v[90:91], v[90:91], v[106:107], v[106:107] op_sel_hi:[1,0,0]
    v_rcp_f32 v88, v88
    v_rcp_f32 v89, v89
    v_rcp_f32 v90, v90
    v_rcp_f32 v91, v91
    v_pk_mul_f32 v[40:41], v[40:41], v[88:89]
    v_pk_mul_f32 v[42:43], v[42:43], v[90:91]
    v_cvt_pk_bf16_f32 v94, v40, v41
    ds_write_b128 v252, v[184:187] offset:23552
    s_add_u32 m0, s100, 4096
    s_mul_i32 s77, s19, 14
    s_add_u32 s77, s77, s93
    s_add_u32 s74, s77, 14336
    buffer_load_dwordx4 v3, s[52:55], s74 offen lds
    buffer_load_dwordx4 v6, s[52:55], s74 offen offset:1024 lds
    v_cvt_pk_bf16_f32 v95, v42, v43
    buffer_store_dwordx4 v[92:95], v1, s[12:15], s89 offen offset:2048 sc1
    s_add_u32 m0, s100, 6144
    s_add_u32 s74, s77, 28672
    buffer_load_dwordx4 v3, s[52:55], s74 offen lds
    buffer_load_dwordx4 v6, s[52:55], s74 offen offset:1024 lds
    ds_write_b128 v252, v[188:191] offset:24576
    ds_write_b128 v252, v[192:195] offset:25600
    v_dot2_f32_bf16 v102, v168, v168, 0
    v_dot2_f32_bf16 v102, v169, v169, v102
    v_dot2_f32_bf16 v102, v170, v170, v102
    v_dot2_f32_bf16 v102, v171, v171, v102
    v_dot2_f32_bf16 v102, v172, v172, v102
    v_dot2_f32_bf16 v102, v173, v173, v102
    v_dot2_f32_bf16 v102, v174, v174, v102
    v_dot2_f32_bf16 v102, v175, v175, v102
    v_dot2_f32_bf16 v102, v176, v176, v102
    v_dot2_f32_bf16 v102, v177, v177, v102
    v_dot2_f32_bf16 v102, v178, v178, v102
    v_dot2_f32_bf16 v102, v179, v179, v102
    v_dot2_f32_bf16 v102, v180, v180, v102
    v_dot2_f32_bf16 v102, v181, v181, v102
    v_dot2_f32_bf16 v102, v182, v182, v102
    v_dot2_f32_bf16 v102, v183, v183, v102
    v_dot2_f32_bf16 v102, v184, v184, v102
    v_dot2_f32_bf16 v102, v185, v185, v102
    v_dot2_f32_bf16 v102, v186, v186, v102
    v_dot2_f32_bf16 v102, v187, v187, v102
    v_dot2_f32_bf16 v102, v188, v188, v102
    v_dot2_f32_bf16 v102, v189, v189, v102
    v_dot2_f32_bf16 v102, v190, v190, v102
    v_dot2_f32_bf16 v102, v191, v191, v102
    v_dot2_f32_bf16 v102, v192, v192, v102
    v_dot2_f32_bf16 v102, v193, v193, v102
    v_dot2_f32_bf16 v102, v194, v194, v102
    v_dot2_f32_bf16 v102, v195, v195, v102
    s_mov_b32 s94, 0
    s_lshl_b32 s70, s4, 8
    v_lshl_add_u32 v9, v0, 2, s70
    v_cmp_u_f32_e64 vcc, v102, v102
    s_nop 0
    s_cbranch_vccnz L_p41_redo
L_p41_ok:
    ds_write_b32 v9, v102 offset:5120
    s_waitcnt lgkmcnt(0)
    s_barrier
    ds_read_b128 v[52:55], v7 offset:7168
    ds_read_b128 v[56:59], v7 offset:8192
    ds_read_b128 v[60:63], v7 offset:9216
    ds_read_b128 v[64:67], v7 offset:10240
    ds_read_b128 v[20:23], v7 offset:11264
    ds_read_b128 v[24:27], v7 offset:12288
    s_waitcnt lgkmcnt(4)
    v_mfma_f32_32x32x16_bf16 v[108:123], a[0:3], v[52:55], 0
    ds_read_b128 v[28:31], v7 offset:13312
    s_waitcnt lgkmcnt(0)
    s_add_u32 m0, s100, 26624
    s_mul_i32 s77, s20, 14
    s_add_u32 s77, s77, s93
    s_add_u32 s74, s77, 14336
    buffer_load_dwordx4 v3, s[52:55], s74 offen lds
    buffer_load_dwordx4 v6, s[52:55], s74 offen offset:1024 lds
    v_mfma_f32_32x32x16_bf16 v[124:139], a[4:7], v[52:55], 0
    v_and_b32 v9, 31, v0
    v_lshlrev_b32 v9, 2, v9
    v_add_u32 v9, 5120, v9
    v_mfma_f32_32x32x16_bf16 v[108:123], a[8:11], v[56:59], v[108:123]
    ds_read_b128 v[32:35], v8 offset:7168
    v_fma_f32 v44, v44, v104, v76
    v_mfma_f32_32x32x16_bf16 v[124:139], a[12:15], v[56:59], v[124:139]
    ds_read2_b32 v[168:169], v9 offset0:0 offset1:32
    ds_read2_b32 v[170:171], v9 offset0:64 offset1:96
    ds_read2_b32 v[172:173], v9 offset0:128 offset1:160
    ds_read2_b32 v[174:175], v9 offset0:192 offset1:224
    v_fma_f32 v45, v45, v104, v77
    v_fma_f32 v46, v46, v104, v78
    v_mfma_f32_32x32x16_bf16 v[108:123], a[16:19], v[60:63], v[108:123]
    ds_read_b128 v[52:55], v8 offset:8192
    s_waitcnt lgkmcnt(0)
    s_add_u32 m0, s100, 28672
    s_add_u32 s74, s77, 28672
    buffer_load_dwordx4 v3, s[52:55], s74 offen lds
    buffer_load_dwordx4 v6, s[52:55], s74 offen offset:1024 lds
    s_waitcnt vmcnt(11)
    ds_read_b64_tr_b16 v[180:181], v18 offset:8192
    ds_read_b64_tr_b16 v[182:183], v18 offset:9216
    ds_read_b64_tr_b16 v[184:185], v19 offset:8192
    ds_read_b64_tr_b16 v[186:187], v19 offset:9216
    v_fma_f32 v47, v47, v104, v79
    v_mfma_f32_32x32x16_bf16 v[124:139], a[20:23], v[60:63], v[124:139]
    v_add_f32 v168, v168, v169
    v_add_f32 v170, v170, v171
    v_add_f32 v172, v172, v173
    v_add_f32 v174, v174, v175
    v_fmaak_f32 v84, v44, v44, 0x409d30fc
    v_fmaak_f32 v85, v45, v45, 0x409d30fc
    v_mfma_f32_32x32x16_bf16 v[108:123], a[24:27], v[64:67], v[108:123]
    ds_read_b128 v[56:59], v8 offset:9216
    s_waitcnt vmcnt(9)
    ds_read_b64_tr_b16 v[188:189], v18 offset:10240
    ds_read_b64_tr_b16 v[190:191], v18 offset:11264
    ds_read_b64_tr_b16 v[192:193], v19 offset:10240
    ds_read_b64_tr_b16 v[194:195], v19 offset:11264
    v_fmaak_f32 v86, v46, v46, 0x409d30fc
    v_fmaak_f32 v87, v47, v47, 0x409d30fc
    v_mfma_f32_32x32x16_bf16 v[124:139], a[28:31], v[64:67], v[124:139]
    v_add_f32 v168, v168, v170
    v_add_f32 v172, v172, v174
    v_add_f32 v168, v168, v172
    v_mul_f32_e64 v84, v84, v44
    v_mfma_f32_32x32x16_bf16 v[108:123], a[32:35], v[20:23], v[108:123]
    ds_read_b128 v[60:63], v8 offset:10240
    v_mul_f32 v85, v85, v45
    v_mul_f32 v86, v86, v46
    v_mfma_f32_32x32x16_bf16 v[124:139], a[36:39], v[20:23], v[124:139]
    v_mul_f32 v168, 0x3b124925, v168
    v_cvt_pk_bf16_f32 v168, v2, v168
    v_add_f32 v168, 0x3727c5ac, v168
    v_cvt_pk_bf16_f32 v168, v2, v168
    s_waitcnt lgkmcnt(0)
    s_add_u32 m0, s100, 30720
    s_add_u32 s74, s77, 43008
    buffer_load_dwordx4 v3, s[52:55], s74 offen lds
    buffer_load_dwordx4 v6, s[52:55], s74 offen offset:1024 lds
    v_mul_f32 v87, v87, v47
    v_mfma_f32_32x32x16_bf16 v[108:123], a[40:43], v[24:27], v[108:123]
    ds_read_b128 v[64:67], v8 offset:11264
    v_exp_f32 v84, -v84
    v_exp_f32 v85, -v85
    v_mfma_f32_32x32x16_bf16 v[124:139], a[44:47], v[24:27], v[124:139]
    v_sqrt_f32 v168, v168
    s_nop 0
    v_cvt_pk_bf16_f32 v168, v2, v168
    v_rcp_f32 v168, v168
    s_nop 0
    v_mul_f32 v105, 0x3eeff558, v168
    v_exp_f32 v86, -v86
    v_exp_f32 v87, -v87
    v_mfma_f32_32x32x16_bf16 v[108:123], a[48:51], v[28:31], v[108:123]
    ds_read_b128 v[20:23], v8 offset:12288
    v_fma_f32 v84, v84, v106, v106
    v_mfma_f32_32x32x16_bf16 v[124:139], a[52:55], v[28:31], v[124:139]
    s_waitcnt lgkmcnt(0)
    s_add_u32 m0, s100, 32768
    s_mul_i32 s77, s21, 14
    s_add_u32 s77, s77, s93
    s_add_u32 s74, s77, 0
    buffer_load_dwordx4 v3, s[52:55], s74 offen lds
    buffer_load_dwordx4 v6, s[52:55], s74 offen offset:1024 lds
    v_fma_f32 v85, v85, v106, v106
    v_fma_f32 v86, v86, v106, v106
    v_mfma_f32_32x32x16_bf16 v[108:123], a[56:59], v[32:35], v[108:123]
    ds_read_b128 v[24:27], v8 offset:13312
    s_waitcnt vmcnt(11)
    ds_read_b64_tr_b16 v[164:165], v18 offset:4096
    ds_read_b64_tr_b16 v[166:167], v18 offset:5120
    ds_read_b64_tr_b16 v[168:169], v19 offset:4096
    ds_read_b64_tr_b16 v[170:171], v19 offset:5120
    v_fma_f32 v87, v87, v106, v106
    v_mfma_f32_32x32x16_bf16 v[124:139], a[60:63], v[32:35], v[124:139]
    v_rcp_f32 v84, v84
    v_rcp_f32_e64 v85, v85
    v_mfma_f32_32x32x16_bf16 v[108:123], a[64:67], v[52:55], v[108:123]
    ds_read_b128 v[28:31], v253 offset:7168
    s_waitcnt vmcnt(8)
    ds_read_b64_tr_b16 v[172:173], v18 offset:6144
    ds_read_b64_tr_b16 v[174:175], v18 offset:7168
    ds_read_b64_tr_b16 v[176:177], v19 offset:6144
    ds_read_b64_tr_b16 v[178:179], v19 offset:7168
    v_rcp_f32 v86, v86
    v_rcp_f32_e64 v87, v87
    v_mfma_f32_32x32x16_bf16 v[124:139], a[68:71], v[52:55], v[124:139]
    v_mul_f32_e64 v44, v44, v84
    v_mfma_f32_32x32x16_bf16 v[108:123], a[72:75], v[56:59], v[108:123]
    ds_read_b128 v[32:35], v253 offset:8192
    s_waitcnt lgkmcnt(0)
    s_add_u32 m0, s100, 34816
    s_add_u32 s74, s77, 14336
    buffer_load_dwordx4 v3, s[52:55], s74 offen lds
    buffer_load_dwordx4 v6, s[52:55], s74 offen offset:1024 lds
    v_mul_f32 v45, v45, v85
    v_mul_f32_e64 v46, v46, v86
    v_mfma_f32_32x32x16_bf16 v[124:139], a[76:79], v[56:59], v[124:139]
    v_mul_f32_e64 v47, v47, v87
    v_mfma_f32_32x32x16_bf16 v[108:123], a[80:83], v[60:63], v[108:123]
    ds_read_b128 v[52:55], v253 offset:9216
    v_cvt_pk_bf16_f32 v96, v44, v45
    v_cvt_pk_bf16_f32 v97, v46, v47
    v_mfma_f32_32x32x16_bf16 v[124:139], a[84:87], v[60:63], v[124:139]
    v_fma_f32 v48, v48, v104, v80
    v_fma_f32 v49, v49, v104, v81
    v_mfma_f32_32x32x16_bf16 v[108:123], a[88:91], v[64:67], v[108:123]
    ds_read_b128 v[56:59], v253 offset:10240
    s_waitcnt lgkmcnt(0)
    s_add_u32 m0, s100, 0
    s_add_u32 s74, s77, 28672
    buffer_load_dwordx4 v3, s[52:55], s74 offen lds
    buffer_load_dwordx4 v6, s[52:55], s74 offen offset:1024 lds
    v_fma_f32 v50, v50, v104, v82
    v_mfma_f32_32x32x16_bf16 v[124:139], a[92:95], v[64:67], v[124:139]
    v_fma_f32 v51, v51, v104, v83
    v_fmaak_f32 v88, v48, v48, 0x409d30fc
    v_mfma_f32_32x32x16_bf16 v[108:123], a[96:99], v[20:23], v[108:123]
    ds_read_b128 v[60:63], v253 offset:11264
    v_fmaak_f32 v89, v49, v49, 0x409d30fc
    v_mfma_f32_32x32x16_bf16 v[124:139], a[100:103], v[20:23], v[124:139]
    v_fmaak_f32 v90, v50, v50, 0x409d30fc
    v_fmaak_f32 v91, v51, v51, 0x409d30fc
    v_mfma_f32_32x32x16_bf16 v[108:123], a[104:107], v[24:27], v[108:123]
    ds_read_b128 v[64:67], v253 offset:12288
    v_mul_f32 v88, v88, v48
    v_mul_f32 v89, v89, v49
    v_mfma_f32_32x32x16_bf16 v[124:139], a[108:111], v[24:27], v[124:139]
    s_waitcnt lgkmcnt(0)
    s_add_u32 m0, s100, 2048
    s_add_u32 s74, s77, 43008
    buffer_load_dwordx4 v3, s[52:55], s74 offen lds
    buffer_load_dwordx4 v6, s[52:55], s74 offen offset:1024 lds
    v_mul_f32 v90, v90, v50
    v_mfma_f32_32x32x16_bf16 v[108:123], a[160:163], v[28:31], v[108:123]
    ds_read_b128 v[20:23], v253 offset:13312
    v_mul_f32_e64 v91, v91, v51
    v_exp_f32 v88, -v88
    v_mfma_f32_32x32x16_bf16 v[124:139], a[164:167], v[28:31], v[124:139]
    v_exp_f32 v89, -v89
    v_mfma_f32_32x32x16_bf16 v[108:123], a[168:171], v[32:35], v[108:123]
    ds_read_b128 v[24:27], v254 offset:7168
    v_exp_f32 v90, -v90
    v_exp_f32 v91, -v91
    v_mfma_f32_32x32x16_bf16 v[124:139], a[172:175], v[32:35], v[124:139]
    v_fma_f32 v88, v88, v106, v106
    v_fma_f32 v89, v89, v106, v106
    v_mfma_f32_32x32x16_bf16 v[108:123], a[176:179], v[52:55], v[108:123]
    ds_read_b128 v[28:31], v254 offset:8192
    s_waitcnt lgkmcnt(0)
    s_add_u32 m0, s100, 8192
    s_mul_i32 s77, s22, 14
    s_add_u32 s77, s77, s93
    s_add_u32 s74, s77, 28672
    buffer_load_dwordx4 v3, s[52:55], s74 offen lds
    buffer_load_dwordx4 v6, s[52:55], s74 offen offset:1024 lds
    v_fma_f32 v90, v90, v106, v106
    v_mfma_f32_32x32x16_bf16 v[124:139], a[180:183], v[52:55], v[124:139]
    v_fma_f32 v91, v91, v106, v106
    v_rcp_f32 v88, v88
    v_mfma_f32_32x32x16_bf16 v[108:123], a[184:187], v[56:59], v[108:123]
    ds_read_b128 v[32:35], v254 offset:9216
    v_rcp_f32_e64 v89, v89
    v_mfma_f32_32x32x16_bf16 v[124:139], a[188:191], v[56:59], v[124:139]
    v_rcp_f32 v90, v90
    v_rcp_f32 v91, v91
    v_mfma_f32_32x32x16_bf16 v[108:123], a[192:195], v[60:63], v[108:123]
    ds_read_b128 v[52:55], v254 offset:10240
    s_waitcnt lgkmcnt(0)
    s_add_u32 m0, s100, 10240
    s_add_u32 s74, s77, 43008
    buffer_load_dwordx4 v3, s[52:55], s74 offen lds
    buffer_load_dwordx4 v6, s[52:55], s74 offen offset:1024 lds
    v_mul_f32 v48, v48, v88
    v_mul_f32_e64 v49, v49, v89
    v_mfma_f32_32x32x16_bf16 v[124:139], a[196:199], v[60:63], v[124:139]
    v_mul_f32_e64 v50, v50, v90
    v_mfma_f32_32x32x16_bf16 v[108:123], a[200:203], v[64:67], v[108:123]
    ds_read_b128 v[56:59], v254 offset:11264
    v_mul_f32_e64 v51, v51, v91
    v_cvt_pk_bf16_f32 v98, v48, v49
    v_mfma_f32_32x32x16_bf16 v[124:139], a[204:207], v[64:67], v[124:139]
    v_cvt_pk_bf16_f32 v99, v50, v51
    buffer_store_dwordx4 v[96:99], v1, s[12:15], s89 offen offset:3072 sc1
    v_mfma_f32_32x32x16_bf16 v[108:123], a[208:211], v[20:23], v[108:123]
    ds_read_b128 v[60:63], v254 offset:12288
    v_mfma_f32_32x32x16_bf16 v[124:139], a[212:215], v[20:23], v[124:139]
    s_waitcnt lgkmcnt(0)
    s_add_u32 m0, s100, 4096
    s_add_u32 s74, s77, 0
    buffer_load_dwordx4 v3, s[52:55], s74 offen lds
    buffer_load_dwordx4 v6, s[52:55], s74 offen offset:1024 lds
    v_mfma_f32_32x32x16_bf16 v[108:123], a[216:219], v[24:27], v[108:123]
    ds_read_b128 v[64:67], v254 offset:13312
    s_waitcnt vmcnt(19)
    ds_read_b64_tr_b16 a[0:1], v18 offset:26624
    ds_read_b64_tr_b16 a[2:3], v18 offset:27648
    ds_read_b64_tr_b16 a[4:5], v19 offset:26624
    ds_read_b64_tr_b16 a[6:7], v19 offset:27648
    v_mfma_f32_32x32x16_bf16 v[124:139], a[220:223], v[24:27], v[124:139]
    v_mfma_f32_32x32x16_bf16 v[108:123], v[196:199], v[28:31], v[108:123]
    s_waitcnt vmcnt(13)
    ds_read_b64_tr_b16 a[24:25], v18 offset:32768
    ds_read_b64_tr_b16 a[26:27], v18 offset:33792
    ds_read_b64_tr_b16 a[28:29], v19 offset:32768
    ds_read_b64_tr_b16 a[30:31], v19 offset:33792
    v_mfma_f32_32x32x16_bf16 v[124:139], v[200:203], v[28:31], v[124:139]
    s_waitcnt lgkmcnt(0)
    s_add_u32 m0, s100, 6144
    s_add_u32 s74, s77, 14336
    buffer_load_dwordx4 v3, s[52:55], s74 offen lds
    buffer_load_dwordx4 v6, s[52:55], s74 offen offset:1024 lds
    v_mfma_f32_32x32x16_bf16 v[108:123], v[204:207], v[32:35], v[108:123]
    s_waitcnt vmcnt(13)
    ds_read_b64_tr_b16 a[32:33], v18 offset:34816
    ds_read_b64_tr_b16 a[34:35], v18 offset:35840
    ds_read_b64_tr_b16 a[36:37], v19 offset:34816
    ds_read_b64_tr_b16 a[38:39], v19 offset:35840
    v_mfma_f32_32x32x16_bf16 v[124:139], v[208:211], v[32:35], v[124:139]
    v_mfma_f32_32x32x16_bf16 v[108:123], v[212:215], v[52:55], v[108:123]
    ds_read_b64_tr_b16 a[8:9], v18 offset:28672
    ds_read_b64_tr_b16 a[10:11], v18 offset:29696
    ds_read_b64_tr_b16 a[12:13], v19 offset:28672
    ds_read_b64_tr_b16 a[14:15], v19 offset:29696
    v_mfma_f32_32x32x16_bf16 v[124:139], v[216:219], v[52:55], v[124:139]
    v_mfma_f32_32x32x16_bf16 v[108:123], v[220:223], v[56:59], v[108:123]
    ds_read_b64_tr_b16 a[16:17], v18 offset:30720
    ds_read_b64_tr_b16 a[18:19], v18 offset:31744
    ds_read_b64_tr_b16 a[20:21], v19 offset:30720
    ds_read_b64_tr_b16 a[22:23], v19 offset:31744
    v_mfma_f32_32x32x16_bf16 v[124:139], v[224:227], v[56:59], v[124:139]
    v_mfma_f32_32x32x16_bf16 v[108:123], v[228:231], v[60:63], v[108:123]
    v_mfma_f32_32x32x16_bf16 v[124:139], v[232:235], v[60:63], v[124:139]
    v_mfma_f32_32x32x16_bf16 v[108:123], v[236:239], v[64:67], v[108:123]
    v_mfma_f32_32x32x16_bf16 v[124:139], v[240:243], v[64:67], v[124:139]
    s_barrier
    v_add_u32 v254, 114688, v1
    ds_read_b128 v[68:71], v107 offset:768
    ds_read_b128 v[72:75], v107 offset:800
    ds_read_b128 v[76:79], v107 offset:832
    ds_read_b128 v[80:83], v107 offset:864
    s_waitcnt lgkmcnt(3)
    s_nop 3
    v_pk_fma_f32 v[108:109], v[108:109], v[104:105], v[68:69] op_sel:[0,1,0] op_sel_hi:[1,1,1]
    v_pk_fma_f32 v[110:111], v[110:111], v[104:105], v[70:71] op_sel:[0,1,0] op_sel_hi:[1,1,1]
    v_pk_fma_f32 v[84:85], v[108:109], v[108:109], v[100:101] op_sel_hi:[1,1,0]
    v_pk_fma_f32 v[86:87], v[110:111], v[110:111], v[100:101] op_sel_hi:[1,1,0]
    v_pk_mul_f32 v[84:85], v[84:85], v[108:109] neg_lo:[1,0] neg_hi:[1,0]
    s_add_u32 s75, s90, s16
    buffer_load_dwordx4 v[20:23], v1, s[12:15], s75 offen sc1
    buffer_load_dwordx4 v[24:27], v1, s[12:15], s75 offen offset:1024 sc1
    v_pk_mul_f32 v[86:87], v[86:87], v[110:111] neg_lo:[1,0] neg_hi:[1,0]
    v_exp_f32 v84, v84
    v_exp_f32 v85, v85
    v_exp_f32 v86, v86
    v_exp_f32 v87, v87
    v_pk_fma_f32 v[84:85], v[84:85], v[106:107], v[106:107] op_sel_hi:[1,0,0]
    v_pk_fma_f32 v[86:87], v[86:87], v[106:107], v[106:107] op_sel_hi:[1,0,0]
    v_rcp_f32 v84, v84
    v_rcp_f32 v85, v85
    v_rcp_f32 v86, v86
    v_rcp_f32 v87, v87
    v_pk_mul_f32 v[108:109], v[108:109], v[84:85]
    v_pk_mul_f32 v[110:111], v[110:111], v[86:87]
    v_cvt_pk_bf16_f32 v92, v108, v109
    v_cvt_pk_bf16_f32 v93, v110, v111
    s_waitcnt lgkmcnt(2)
    v_pk_fma_f32 v[112:113], v[112:113], v[104:105], v[72:73] op_sel:[0,1,0] op_sel_hi:[1,1,1]
    v_pk_fma_f32 v[114:115], v[114:115], v[104:105], v[74:75] op_sel:[0,1,0] op_sel_hi:[1,1,1]
    v_pk_fma_f32 v[88:89], v[112:113], v[112:113], v[100:101] op_sel_hi:[1,1,0]
    v_pk_fma_f32 v[90:91], v[114:115], v[114:115], v[100:101] op_sel_hi:[1,1,0]
    v_pk_mul_f32 v[88:89], v[88:89], v[112:113] neg_lo:[1,0] neg_hi:[1,0]
    v_pk_mul_f32 v[90:91], v[90:91], v[114:115] neg_lo:[1,0] neg_hi:[1,0]
    v_exp_f32_e64 v88, v88
    s_add_u32 s75, s90, s17
    buffer_load_dwordx4 v[36:39], v1, s[12:15], s75 offen sc1
    buffer_load_dwordx4 v[40:43], v1, s[12:15], s75 offen offset:1024 sc1
    v_exp_f32 v89, v89
    v_exp_f32 v90, v90
    v_exp_f32_e64 v91, v91
    v_pk_fma_f32 v[88:89], v[88:89], v[106:107], v[106:107] op_sel_hi:[1,0,0]
    v_pk_fma_f32 v[90:91], v[90:91], v[106:107], v[106:107] op_sel_hi:[1,0,0]
    v_rcp_f32 v88, v88
    v_rcp_f32 v89, v89
    v_rcp_f32 v90, v90
    v_rcp_f32 v91, v91
    v_pk_mul_f32 v[112:113], v[112:113], v[88:89]
    v_pk_mul_f32 v[114:115], v[114:115], v[90:91]
    v_cvt_pk_bf16_f32 v94, v112, v113
    v_cvt_pk_bf16_f32 v95, v114, v115
    buffer_store_dwordx4 v[92:95], v1, s[12:15], s33 offen sc1
    s_waitcnt lgkmcnt(1)
    v_pk_fma_f32 v[116:117], v[116:117], v[104:105], v[76:77] op_sel:[0,1,0] op_sel_hi:[1,1,1]
    v_pk_fma_f32 v[118:119], v[118:119], v[104:105], v[78:79] op_sel:[0,1,0] op_sel_hi:[1,1,1]
    v_pk_fma_f32 v[84:85], v[116:117], v[116:117], v[100:101] op_sel_hi:[1,1,0]
    v_pk_fma_f32 v[86:87], v[118:119], v[118:119], v[100:101] op_sel_hi:[1,1,0]
    v_pk_mul_f32 v[84:85], v[84:85], v[116:117] neg_lo:[1,0] neg_hi:[1,0]
    v_pk_mul_f32 v[86:87], v[86:87], v[118:119] neg_lo:[1,0] neg_hi:[1,0]
    v_exp_f32 v84, v84
    v_exp_f32 v85, v85
    s_add_u32 s75, s90, s18
    buffer_load_dwordx4 v[52:55], v1, s[12:15], s75 offen sc1
    buffer_load_dwordx4 v[56:59], v1, s[12:15], s75 offen offset:1024 sc1
    v_exp_f32 v86, v86
    v_exp_f32 v87, v87
    v_pk_fma_f32 v[84:85], v[84:85], v[106:107], v[106:107] op_sel_hi:[1,0,0]
    v_pk_fma_f32 v[86:87], v[86:87], v[106:107], v[106:107] op_sel_hi:[1,0,0]
    v_rcp_f32 v84, v84
    v_rcp_f32 v85, v85
    v_rcp_f32 v86, v86
    v_rcp_f32 v87, v87
    v_pk_mul_f32 v[116:117], v[116:117], v[84:85]
    v_pk_mul_f32 v[118:119], v[118:119], v[86:87]
    v_cvt_pk_bf16_f32 v96, v116, v117
    v_cvt_pk_bf16_f32 v97, v118, v119
    s_waitcnt lgkmcnt(0)
    v_pk_fma_f32 v[120:121], v[120:121], v[104:105], v[80:81] op_sel:[0,1,0] op_sel_hi:[1,1,1]
    v_pk_fma_f32 v[122:123], v[122:123], v[104:105], v[82:83] op_sel:[0,1,0] op_sel_hi:[1,1,1]
    v_pk_fma_f32 v[88:89], v[120:121], v[120:121], v[100:101] op_sel_hi:[1,1,0]
    v_pk_fma_f32 v[90:91], v[122:123], v[122:123], v[100:101] op_sel_hi:[1,1,0]
    v_pk_mul_f32 v[88:89], v[88:89], v[120:121] neg_lo:[1,0] neg_hi:[1,0]
    v_pk_mul_f32 v[90:91], v[90:91], v[122:123] neg_lo:[1,0] neg_hi:[1,0]
    v_exp_f32 v88, v88
    v_exp_f32 v89, v89
    v_exp_f32 v90, v90
    v_exp_f32 v91, v91
    s_add_u32 s75, s90, s19
    buffer_load_dwordx4 v[196:199], v1, s[12:15], s75 offen sc1
    buffer_load_dwordx4 v[200:203], v1, s[12:15], s75 offen offset:1024 sc1
    v_pk_fma_f32 v[88:89], v[88:89], v[106:107], v[106:107] op_sel_hi:[1,0,0]
    v_pk_fma_f32 v[90:91], v[90:91], v[106:107], v[106:107] op_sel_hi:[1,0,0]
    v_rcp_f32 v88, v88
    v_rcp_f32 v89, v89
    v_rcp_f32 v90, v90
    v_rcp_f32 v91, v91
    v_pk_mul_f32 v[120:121], v[120:121], v[88:89]
    v_pk_mul_f32 v[122:123], v[122:123], v[90:91]
    v_cvt_pk_bf16_f32 v98, v120, v121
    v_cvt_pk_bf16_f32 v99, v122, v123
    buffer_store_dwordx4 v[96:99], v1, s[12:15], s33 offen offset:1024 sc1
    ds_read_b128 v[68:71], v107 offset:896
    ds_read_b128 v[72:75], v107 offset:928
    ds_read_b128 v[76:79], v107 offset:960
    ds_read_b128 v[80:83], v107 offset:992
    s_waitcnt lgkmcnt(3)
    v_pk_fma_f32 v[124:125], v[124:125], v[104:105], v[68:69] op_sel:[0,1,0] op_sel_hi:[1,1,1]
    v_pk_fma_f32 v[126:127], v[126:127], v[104:105], v[70:71] op_sel:[0,1,0] op_sel_hi:[1,1,1]
    v_pk_fma_f32 v[84:85], v[124:125], v[124:125], v[100:101] op_sel_hi:[1,1,0]
    v_pk_fma_f32 v[86:87], v[126:127], v[126:127], v[100:101] op_sel_hi:[1,1,0]
    v_pk_mul_f32 v[84:85], v[84:85], v[124:125] neg_lo:[1,0] neg_hi:[1,0]
    v_pk_mul_f32 v[86:87], v[86:87], v[126:127] neg_lo:[1,0] neg_hi:[1,0]
    s_add_u32 s75, s90, s20
    buffer_load_dwordx4 v[212:215], v1, s[12:15], s75 offen sc1
    buffer_load_dwordx4 v[216:219], v1, s[12:15], s75 offen offset:1024 sc1
    v_exp_f32 v84, v84
    v_exp_f32 v85, v85
    v_exp_f32 v86, v86
    v_exp_f32 v87, v87
    v_pk_fma_f32 v[84:85], v[84:85], v[106:107], v[106:107] op_sel_hi:[1,0,0]
    v_pk_fma_f32 v[86:87], v[86:87], v[106:107], v[106:107] op_sel_hi:[1,0,0]
    v_rcp_f32 v84, v84
    v_rcp_f32 v85, v85
    v_rcp_f32 v86, v86
    v_rcp_f32 v87, v87
    v_pk_mul_f32 v[124:125], v[124:125], v[84:85]
    v_pk_mul_f32 v[126:127], v[126:127], v[86:87]
    v_cvt_pk_bf16_f32 v92, v124, v125
    v_cvt_pk_bf16_f32 v93, v126, v127
    s_waitcnt lgkmcnt(2)
    v_pk_fma_f32 v[128:129], v[128:129], v[104:105], v[72:73] op_sel:[0,1,0] op_sel_hi:[1,1,1]
    v_pk_fma_f32 v[130:131], v[130:131], v[104:105], v[74:75] op_sel:[0,1,0] op_sel_hi:[1,1,1]
    v_pk_fma_f32 v[88:89], v[128:129], v[128:129], v[100:101] op_sel_hi:[1,1,0]
    v_pk_fma_f32 v[90:91], v[130:131], v[130:131], v[100:101] op_sel_hi:[1,1,0]
    v_pk_mul_f32 v[88:89], v[88:89], v[128:129] neg_lo:[1,0] neg_hi:[1,0]
    v_pk_mul_f32 v[90:91], v[90:91], v[130:131] neg_lo:[1,0] neg_hi:[1,0]
    v_exp_f32 v88, v88
    v_exp_f32 v89, v89
    s_add_u32 s75, s90, s21
    buffer_load_dwordx4 v[228:231], v1, s[12:15], s75 offen sc1
    buffer_load_dwordx4 v[232:235], v1, s[12:15], s75 offen offset:1024 sc1
    v_exp_f32 v90, v90
    v_exp_f32 v91, v91
    v_pk_fma_f32 v[88:89], v[88:89], v[106:107], v[106:107] op_sel_hi:[1,0,0]
    v_pk_fma_f32 v[90:91], v[90:91], v[106:107], v[106:107] op_sel_hi:[1,0,0]
    v_rcp_f32 v88, v88
    v_rcp_f32 v89, v89
    v_rcp_f32 v90, v90
    v_rcp_f32 v91, v91
    v_pk_mul_f32 v[128:129], v[128:129], v[88:89]
    v_pk_mul_f32 v[130:131], v[130:131], v[90:91]
    v_cvt_pk_bf16_f32 v94, v128, v129
    v_cvt_pk_bf16_f32 v95, v130, v131
    buffer_store_dwordx4 v[92:95], v1, s[12:15], s33 offen offset:2048 sc1
    s_waitcnt lgkmcnt(1)
    v_pk_fma_f32 v[132:133], v[132:133], v[104:105], v[76:77] op_sel:[0,1,0] op_sel_hi:[1,1,1]
    v_pk_fma_f32 v[134:135], v[134:135], v[104:105], v[78:79] op_sel:[0,1,0] op_sel_hi:[1,1,1]
    v_pk_fma_f32 v[84:85], v[132:133], v[132:133], v[100:101] op_sel_hi:[1,1,0]
    v_pk_fma_f32 v[86:87], v[134:135], v[134:135], v[100:101] op_sel_hi:[1,1,0]
    v_pk_mul_f32 v[84:85], v[84:85], v[132:133] neg_lo:[1,0] neg_hi:[1,0]
    v_pk_mul_f32 v[86:87], v[86:87], v[134:135] neg_lo:[1,0] neg_hi:[1,0]
    v_exp_f32 v84, v84
    v_exp_f32 v85, v85
    v_exp_f32_e64 v86, v86
    s_add_u32 s75, s90, s16
    buffer_load_dwordx4 v[28:31], v1, s[12:15], s75 offen offset:2048 sc1
    buffer_load_dwordx4 v[32:35], v1, s[12:15], s75 offen offset:3072 sc1
    v_exp_f32_e64 v87, v87
    v_pk_fma_f32 v[84:85], v[84:85], v[106:107], v[106:107] op_sel_hi:[1,0,0]
    v_pk_fma_f32 v[86:87], v[86:87], v[106:107], v[106:107] op_sel_hi:[1,0,0]
    v_rcp_f32 v84, v84
    v_rcp_f32 v85, v85
    v_rcp_f32 v86, v86
    v_rcp_f32 v87, v87
    v_pk_mul_f32 v[132:133], v[132:133], v[84:85]
    v_pk_mul_f32 v[134:135], v[134:135], v[86:87]
    v_cvt_pk_bf16_f32 v96, v132, v133
    v_cvt_pk_bf16_f32 v97, v134, v135
    s_waitcnt lgkmcnt(0)
    v_pk_fma_f32 v[136:137], v[136:137], v[104:105], v[80:81] op_sel:[0,1,0] op_sel_hi:[1,1,1]
    v_pk_fma_f32 v[138:139], v[138:139], v[104:105], v[82:83] op_sel:[0,1,0] op_sel_hi:[1,1,1]
    v_pk_fma_f32 v[88:89], v[136:137], v[136:137], v[100:101] op_sel_hi:[1,1,0]
    v_pk_fma_f32 v[90:91], v[138:139], v[138:139], v[100:101] op_sel_hi:[1,1,0]
    v_pk_mul_f32 v[88:89], v[88:89], v[136:137] neg_lo:[1,0] neg_hi:[1,0]
    v_pk_mul_f32 v[90:91], v[90:91], v[138:139] neg_lo:[1,0] neg_hi:[1,0]
    v_exp_f32 v88, v88
    v_exp_f32 v89, v89
    v_exp_f32 v90, v90
    v_exp_f32_e64 v91, v91
    v_pk_fma_f32 v[88:89], v[88:89], v[106:107], v[106:107] op_sel_hi:[1,0,0]
    s_add_u32 s75, s90, s17
    buffer_load_dwordx4 v[44:47], v1, s[12:15], s75 offen offset:2048 sc1
    buffer_load_dwordx4 v[48:51], v1, s[12:15], s75 offen offset:3072 sc1
    v_pk_fma_f32 v[90:91], v[90:91], v[106:107], v[106:107] op_sel_hi:[1,0,0]
    v_rcp_f32 v88, v88
    v_rcp_f32 v89, v89
    v_rcp_f32 v90, v90
    v_rcp_f32_e64 v91, v91
    v_pk_mul_f32 v[136:137], v[136:137], v[88:89]
    v_pk_mul_f32 v[138:139], v[138:139], v[90:91]
    v_cvt_pk_bf16_f32 v98, v136, v137
    v_cvt_pk_bf16_f32 v99, v138, v139
    buffer_store_dwordx4 v[96:99], v1, s[12:15], s33 offen offset:3072 sc1
    s_mov_b32 s94, 0
L_p5a_body:
    s_waitcnt vmcnt(18)
    v_mfma_f32_32x32x16_bf16 a[160:175], a[112:115], v[20:23], 0
    v_mfma_f32_32x32x16_bf16 a[176:191], a[116:119], v[20:23], 0
    s_add_u32 s75, s90, s22
    buffer_load_dwordx4 v[68:71], v1, s[12:15], s75 offen sc1
    buffer_load_dwordx4 v[72:75], v1, s[12:15], s75 offen offset:1024 sc1
    ds_read_b64_tr_b16 a[56:57], v18 offset:4096
    ds_read_b64_tr_b16 a[58:59], v18 offset:5120
    ds_read_b64_tr_b16 a[60:61], v19 offset:4096
    ds_read_b64_tr_b16 a[62:63], v19 offset:5120
    v_mfma_f32_32x32x16_bf16 a[160:175], a[120:123], v[24:27], a[160:175]
    v_mfma_f32_32x32x16_bf16 a[176:191], a[124:127], v[24:27], a[176:191]
    ds_read_b64_tr_b16 a[64:65], v18 offset:6144
    ds_read_b64_tr_b16 a[66:67], v18 offset:7168
    ds_read_b64_tr_b16 a[68:69], v19 offset:6144
    ds_read_b64_tr_b16 a[70:71], v19 offset:7168
    s_waitcnt vmcnt(18)
    v_mfma_f32_32x32x16_bf16 a[160:175], a[144:147], v[36:39], a[160:175]
    v_mfma_f32_32x32x16_bf16 a[176:191], a[148:151], v[36:39], a[176:191]
    s_add_u32 s75, s90, s18
    buffer_load_dwordx4 v[60:63], v1, s[12:15], s75 offen offset:2048 sc1
    buffer_load_dwordx4 v[64:67], v1, s[12:15], s75 offen offset:3072 sc1
    ds_read_b64_tr_b16 a[40:41], v18 offset:0
    ds_read_b64_tr_b16 a[42:43], v18 offset:1024
    ds_read_b64_tr_b16 a[44:45], v19 offset:0
    ds_read_b64_tr_b16 a[46:47], v19 offset:1024
    v_mfma_f32_32x32x16_bf16 a[160:175], a[152:155], v[40:43], a[160:175]
    v_mfma_f32_32x32x16_bf16 a[176:191], a[156:159], v[40:43], a[176:191]
    ds_read_b64_tr_b16 a[48:49], v18 offset:2048
    ds_read_b64_tr_b16 a[50:51], v18 offset:3072
    ds_read_b64_tr_b16 a[52:53], v19 offset:2048
    ds_read_b64_tr_b16 a[54:55], v19 offset:3072
    s_waitcnt vmcnt(17)
    v_mfma_f32_32x32x16_bf16 a[160:175], a[240:243], v[52:55], a[160:175]
    v_mfma_f32_32x32x16_bf16 a[176:191], a[244:247], v[52:55], a[176:191]
    s_add_u32 s75, s90, s19
    buffer_load_dwordx4 v[204:207], v1, s[12:15], s75 offen offset:2048 sc1
    buffer_load_dwordx4 v[208:211], v1, s[12:15], s75 offen offset:3072 sc1
    ds_read_b64_tr_b16 a[72:73], v18 offset:8192
    ds_read_b64_tr_b16 a[74:75], v18 offset:9216
    ds_read_b64_tr_b16 a[76:77], v19 offset:8192
    ds_read_b64_tr_b16 a[78:79], v19 offset:9216
    v_mfma_f32_32x32x16_bf16 a[160:175], a[248:251], v[56:59], a[160:175]
    v_mfma_f32_32x32x16_bf16 a[176:191], a[252:255], v[56:59], a[176:191]
    ds_read_b64_tr_b16 a[80:81], v18 offset:10240
    ds_read_b64_tr_b16 a[82:83], v18 offset:11264
    ds_read_b64_tr_b16 a[84:85], v19 offset:10240
    ds_read_b64_tr_b16 a[86:87], v19 offset:11264
    s_waitcnt vmcnt(17)
    v_mfma_f32_32x32x16_bf16 a[160:175], v[156:159], v[196:199], a[160:175]
    v_mfma_f32_32x32x16_bf16 a[176:191], v[160:163], v[196:199], a[176:191]
    s_add_u32 s75, s90, s20
    buffer_load_dwordx4 v[220:223], v1, s[12:15], s75 offen offset:2048 sc1
    buffer_load_dwordx4 v[224:227], v1, s[12:15], s75 offen offset:3072 sc1
    s_xor_b32 s70, s4, 1
    s_mul_i32 s70, s70, 36864
    v_mfma_f32_32x32x16_bf16 a[160:175], v[164:167], v[200:203], a[160:175]
    v_mfma_f32_32x32x16_bf16 a[176:191], v[168:171], v[200:203], a[176:191]
    s_add_u32 s70, s70, 28672
    v_add_u32 v8, s70, v1
    s_xor_b32 s70, s4, 2
    s_waitcnt vmcnt(16)
    v_mfma_f32_32x32x16_bf16 a[160:175], v[188:191], v[212:215], a[160:175]
    v_mfma_f32_32x32x16_bf16 a[176:191], v[192:195], v[212:215], a[176:191]
    s_add_u32 s75, s90, s21
    buffer_load_dwordx4 v[236:239], v1, s[12:15], s75 offen offset:2048 sc1
    buffer_load_dwordx4 v[240:243], v1, s[12:15], s75 offen offset:3072 sc1
    s_mul_i32 s70, s70, 36864
    s_add_u32 s70, s70, 32768
    v_add_u32 v9, s70, v1
    v_mfma_f32_32x32x16_bf16 a[160:175], a[0:3], v[216:219], a[160:175]
    v_mfma_f32_32x32x16_bf16 a[176:191], a[4:7], v[216:219], a[176:191]
    s_xor_b32 s70, s4, 3
    s_mul_i32 s70, s70, 36864
    s_add_u32 s70, s70, 36864
    s_waitcnt vmcnt(16)
    v_mfma_f32_32x32x16_bf16 a[160:175], a[24:27], v[228:231], a[160:175]
    v_mfma_f32_32x32x16_bf16 a[176:191], a[28:31], v[228:231], a[176:191]
    s_add_u32 s75, s90, s22
    buffer_load_dwordx4 v[76:79], v1, s[12:15], s75 offen offset:2048 sc1
    buffer_load_dwordx4 v[80:83], v1, s[12:15], s75 offen offset:3072 sc1
    v_add_u32 v253, s70, v1
    s_lshl_b32 s70, s5, 7
    v_mfma_f32_32x32x16_bf16 a[160:175], a[32:35], v[232:235], a[160:175]
    v_mfma_f32_32x32x16_bf16 a[176:191], a[36:39], v[232:235], a[176:191]
    s_sub_u32 s70, s97, s70
    s_lshl_b32 s70, s70, 1
    v_lshrrev_b32 v252, 5, v0
    s_waitcnt vmcnt(10)
    s_waitcnt lgkmcnt(15)
    v_mfma_f32_32x32x16_bf16 a[160:175], a[56:59], v[68:71], a[160:175]
    v_mfma_f32_32x32x16_bf16 a[176:191], a[60:63], v[68:71], a[176:191]
    v_lshl_add_u32 v7, v252, 4, s70
    ds_read_b128 v[100:103], v7 offset:1792
    ds_read_b128 v[104:107], v7 offset:1824
    v_mfma_f32_32x32x16_bf16 a[160:175], a[64:67], v[72:75], a[160:175]
    v_mfma_f32_32x32x16_bf16 a[176:191], a[68:71], v[72:75], a[176:191]
    v_lshlrev_b32 v84, 16, v10
    v_and_b32 v85, 0xffff0000, v10
    v_lshlrev_b32 v86, 16, v11
    v_mfma_f32_32x32x16_bf16 a[160:175], a[128:131], v[28:31], a[160:175]
    v_mfma_f32_32x32x16_bf16 a[176:191], a[132:135], v[28:31], a[176:191]
    s_add_u32 s75, s90, s16
    buffer_load_dwordx4 v[20:23], v254, s[12:15], s75 offen sc1
    buffer_load_dwordx4 v[24:27], v254, s[12:15], s75 offen offset:1024 sc1
    v_and_b32 v87, 0xffff0000, v11
    v_lshlrev_b32 v88, 16, v12
    v_mfma_f32_32x32x16_bf16 a[160:175], a[136:139], v[32:35], a[160:175]
    v_mfma_f32_32x32x16_bf16 a[176:191], a[140:143], v[32:35], a[176:191]
    v_and_b32 v89, 0xffff0000, v12
    v_lshlrev_b32 v90, 16, v13
    v_and_b32 v91, 0xffff0000, v13
    v_mfma_f32_32x32x16_bf16 a[160:175], a[224:227], v[44:47], a[160:175]
    v_mfma_f32_32x32x16_bf16 a[176:191], a[228:231], v[44:47], a[176:191]
    s_add_u32 s75, s90, s17
    buffer_load_dwordx4 v[36:39], v254, s[12:15], s75 offen sc1
    buffer_load_dwordx4 v[40:43], v254, s[12:15], s75 offen offset:1024 sc1
    s_waitcnt lgkmcnt(1)
    v_add_f32 v84, v84, v100
    v_add_f32 v85, v85, v101
    v_add_f32 v86, v86, v102
    v_mfma_f32_32x32x16_bf16 a[160:175], a[232:235], v[48:51], a[160:175]
    v_mfma_f32_32x32x16_bf16 a[176:191], a[236:239], v[48:51], a[176:191]
    v_add_f32 v87, v87, v103
    s_waitcnt lgkmcnt(0)
    v_add_f32 v88, v88, v104
    v_add_f32 v89, v89, v105
    s_waitcnt vmcnt(12)
    v_mfma_f32_32x32x16_bf16 a[160:175], v[140:143], v[60:63], a[160:175]
    v_mfma_f32_32x32x16_bf16 a[176:191], v[144:147], v[60:63], a[176:191]
    s_add_u32 s75, s90, s18
    buffer_load_dwordx4 v[52:55], v254, s[12:15], s75 offen sc1
    buffer_load_dwordx4 v[56:59], v254, s[12:15], s75 offen offset:1024 sc1
    v_add_f32 v90, v90, v106
    v_add_f32 v91, v91, v107
    v_mfma_f32_32x32x16_bf16 a[160:175], v[148:151], v[64:67], a[160:175]
    v_mfma_f32_32x32x16_bf16 a[176:191], v[152:155], v[64:67], a[176:191]
    v_lshlrev_b32 v92, 16, v14
    v_and_b32 v93, 0xffff0000, v14
    v_lshlrev_b32 v94, 16, v15
    s_waitcnt vmcnt(12)
    v_mfma_f32_32x32x16_bf16 a[160:175], v[172:175], v[204:207], a[160:175]
    v_mfma_f32_32x32x16_bf16 a[176:191], v[176:179], v[204:207], a[176:191]
    s_add_u32 s75, s90, s19
    buffer_load_dwordx4 v[196:199], v254, s[12:15], s75 offen sc1
    buffer_load_dwordx4 v[200:203], v254, s[12:15], s75 offen offset:1024 sc1
    v_and_b32 v95, 0xffff0000, v15
    v_lshlrev_b32 v96, 16, v16
    v_and_b32 v97, 0xffff0000, v16
    v_mfma_f32_32x32x16_bf16 a[160:175], v[180:183], v[208:211], a[160:175]
    v_mfma_f32_32x32x16_bf16 a[176:191], v[184:187], v[208:211], a[176:191]
    v_lshlrev_b32 v98, 16, v17
    v_and_b32 v99, 0xffff0000, v17
    v_add_f32 v92, v92, v100
    s_waitcnt vmcnt(12)
    v_mfma_f32_32x32x16_bf16 a[160:175], a[8:11], v[220:223], a[160:175]
    v_mfma_f32_32x32x16_bf16 a[176:191], a[12:15], v[220:223], a[176:191]
    s_add_u32 s75, s90, s20
    buffer_load_dwordx4 v[212:215], v254, s[12:15], s75 offen sc1
    buffer_load_dwordx4 v[216:219], v254, s[12:15], s75 offen offset:1024 sc1
    v_add_f32 v93, v93, v101
    v_add_f32 v94, v94, v102
    v_mfma_f32_32x32x16_bf16 a[160:175], a[16:19], v[224:227], a[160:175]
    v_mfma_f32_32x32x16_bf16 a[176:191], a[20:23], v[224:227], a[176:191]
    v_add_f32 v95, v95, v103
    v_add_f32 v96, v96, v104
    v_add_f32 v97, v97, v105
    s_waitcnt vmcnt(12)
    v_mfma_f32_32x32x16_bf16 a[160:175], a[40:43], v[236:239], a[160:175]
    v_mfma_f32_32x32x16_bf16 a[176:191], a[44:47], v[236:239], a[176:191]
    s_add_u32 s75, s90, s21
    buffer_load_dwordx4 v[228:231], v254, s[12:15], s75 offen sc1
    buffer_load_dwordx4 v[232:235], v254, s[12:15], s75 offen offset:1024 sc1
    v_add_f32 v98, v98, v106
    v_add_f32 v99, v99, v107
    v_and_b32 v7, 31, v0
    v_mfma_f32_32x32x16_bf16 a[160:175], a[48:51], v[240:243], a[160:175]
    v_mfma_f32_32x32x16_bf16 a[176:191], a[52:55], v[240:243], a[176:191]
    v_mul_u32_u24 v7, 896, v7
    v_lshl_add_u32 v252, v252, 4, v7
    v_add_u32 v7, s100, v1
    s_waitcnt vmcnt(12)
    v_mfma_f32_32x32x16_bf16 a[160:175], a[72:75], v[76:79], a[160:175]
    v_mfma_f32_32x32x16_bf16 a[176:191], a[76:79], v[76:79], a[176:191]
    s_add_u32 s75, s90, s22
    buffer_load_dwordx4 v[68:71], v254, s[12:15], s75 offen sc1
    buffer_load_dwordx4 v[72:75], v254, s[12:15], s75 offen offset:1024 sc1
    s_mul_i32 s71, s6, 57344
    s_add_u32 s71, s71, s97
    s_add_u32 s72, s71, 28672
    v_mfma_f32_32x32x16_bf16 a[160:175], a[80:83], v[80:83], a[160:175]
    v_mfma_f32_32x32x16_bf16 a[176:191], a[84:87], v[80:83], a[176:191]
    s_nop 10
    v_accvgpr_read_b32 v108, a160
    v_cmp_u_f32 vcc, v108, v108
    s_nop 0
    s_cbranch_vccz L_p5a_ok
    s_add_u32 s94, s94, 1
    s_cmp_gt_u32 s94, 131072
    s_cbranch_scc1 L_p5a_ok
    s_waitcnt vmcnt(0)
    s_sleep 2
    s_add_u32 s75, s90, s16
    buffer_load_dwordx4 v[20:23], v1, s[12:15], s75 offen sc1
    buffer_load_dwordx4 v[24:27], v1, s[12:15], s75 offen offset:1024 sc1
    s_add_u32 s75, s90, s17
    buffer_load_dwordx4 v[36:39], v1, s[12:15], s75 offen sc1
    buffer_load_dwordx4 v[40:43], v1, s[12:15], s75 offen offset:1024 sc1
    s_add_u32 s75, s90, s18
    buffer_load_dwordx4 v[52:55], v1, s[12:15], s75 offen sc1
    buffer_load_dwordx4 v[56:59], v1, s[12:15], s75 offen offset:1024 sc1
    s_add_u32 s75, s90, s19
    buffer_load_dwordx4 v[196:199], v1, s[12:15], s75 offen sc1
    buffer_load_dwordx4 v[200:203], v1, s[12:15], s75 offen offset:1024 sc1
    s_add_u32 s75, s90, s20
    buffer_load_dwordx4 v[212:215], v1, s[12:15], s75 offen sc1
    buffer_load_dwordx4 v[216:219], v1, s[12:15], s75 offen offset:1024 sc1
    s_add_u32 s75, s90, s21
    buffer_load_dwordx4 v[228:231], v1, s[12:15], s75 offen sc1
    buffer_load_dwordx4 v[232:235], v1, s[12:15], s75 offen offset:1024 sc1
    s_add_u32 s75, s90, s16
    buffer_load_dwordx4 v[28:31], v1, s[12:15], s75 offen offset:2048 sc1
    buffer_load_dwordx4 v[32:35], v1, s[12:15], s75 offen offset:3072 sc1
    s_add_u32 s75, s90, s17
    buffer_load_dwordx4 v[44:47], v1, s[12:15], s75 offen offset:2048 sc1
    buffer_load_dwordx4 v[48:51], v1, s[12:15], s75 offen offset:3072 sc1
    s_waitcnt vmcnt(0)
    s_branch L_p5a_body
L_p5a_ok:
    s_mov_b32 s94, 0
    s_waitcnt vmcnt(12)
    v_mfma_f32_32x32x16_bf16 a[192:207], a[112:115], v[20:23], 0
    v_mfma_f32_32x32x16_bf16 a[208:223], a[116:119], v[20:23], 0
    s_add_u32 s75, s90, s16
    buffer_load_dwordx4 v[28:31], v254, s[12:15], s75 offen offset:2048 sc1
    buffer_load_dwordx4 v[32:35], v254, s[12:15], s75 offen offset:3072 sc1
    v_mfma_f32_32x32x16_bf16 a[192:207], a[120:123], v[24:27], a[192:207]
    v_mfma_f32_32x32x16_bf16 a[208:223], a[124:127], v[24:27], a[208:223]
    ds_write_b128 v8, a[176:179] offset:0
    s_waitcnt vmcnt(12)
    v_mfma_f32_32x32x16_bf16 a[192:207], a[144:147], v[36:39], a[192:207]
    v_mfma_f32_32x32x16_bf16 a[208:223], a[148:151], v[36:39], a[208:223]
    s_add_u32 s75, s90, s17
    buffer_load_dwordx4 v[44:47], v254, s[12:15], s75 offen offset:2048 sc1
    buffer_load_dwordx4 v[48:51], v254, s[12:15], s75 offen offset:3072 sc1
    ds_write_b128 v8, a[180:183] offset:1024
    ds_write_b128 v9, a[168:171] offset:0
    v_mfma_f32_32x32x16_bf16 a[192:207], a[152:155], v[40:43], a[192:207]
    v_mfma_f32_32x32x16_bf16 a[208:223], a[156:159], v[40:43], a[208:223]
    ds_write_b128 v9, a[172:175] offset:1024
    s_waitcnt vmcnt(12)
    v_mfma_f32_32x32x16_bf16 a[192:207], a[240:243], v[52:55], a[192:207]
    v_mfma_f32_32x32x16_bf16 a[208:223], a[244:247], v[52:55], a[208:223]
    s_add_u32 s75, s90, s18
    buffer_load_dwordx4 v[60:63], v254, s[12:15], s75 offen offset:2048 sc1
    buffer_load_dwordx4 v[64:67], v254, s[12:15], s75 offen offset:3072 sc1
    ds_write_b128 v253, a[184:187] offset:0
    ds_write_b128 v253, a[188:191] offset:1024
    v_mfma_f32_32x32x16_bf16 a[192:207], a[248:251], v[56:59], a[192:207]
    v_mfma_f32_32x32x16_bf16 a[208:223], a[252:255], v[56:59], a[208:223]
    v_accvgpr_read_b32 v108, a160
    v_add_f32 v108, v108, v84
    s_waitcnt vmcnt(12)
    v_mfma_f32_32x32x16_bf16 a[192:207], v[156:159], v[196:199], a[192:207]
    v_mfma_f32_32x32x16_bf16 a[208:223], v[160:163], v[196:199], a[208:223]
    s_add_u32 s75, s90, s19
    buffer_load_dwordx4 v[204:207], v254, s[12:15], s75 offen offset:2048 sc1
    buffer_load_dwordx4 v[208:211], v254, s[12:15], s75 offen offset:3072 sc1
    v_accvgpr_read_b32 v109, a161
    v_add_f32 v109, v109, v85
    v_accvgpr_read_b32 v110, a162
    v_add_f32 v110, v110, v86
    v_mfma_f32_32x32x16_bf16 a[192:207], v[164:167], v[200:203], a[192:207]
    v_mfma_f32_32x32x16_bf16 a[208:223], v[168:171], v[200:203], a[208:223]
    v_accvgpr_read_b32 v111, a163
    v_add_f32 v111, v111, v87
    s_waitcnt vmcnt(12)
    v_mfma_f32_32x32x16_bf16 a[192:207], v[188:191], v[212:215], a[192:207]
    v_mfma_f32_32x32x16_bf16 a[208:223], v[192:195], v[212:215], a[208:223]
    s_add_u32 s75, s90, s20
    buffer_load_dwordx4 v[220:223], v254, s[12:15], s75 offen offset:2048 sc1
    buffer_load_dwordx4 v[224:227], v254, s[12:15], s75 offen offset:3072 sc1
    v_accvgpr_read_b32 v112, a164
    v_add_f32 v112, v112, v88
    v_accvgpr_read_b32 v113, a165
    v_add_f32 v113, v113, v89
    v_mfma_f32_32x32x16_bf16 a[192:207], a[0:3], v[216:219], a[192:207]
    v_mfma_f32_32x32x16_bf16 a[208:223], a[4:7], v[216:219], a[208:223]
    v_accvgpr_read_b32 v114, a166
    v_add_f32 v114, v114, v90
    v_accvgpr_read_b32 v115, a167
    v_add_f32 v115, v115, v91
    s_waitcnt vmcnt(12)
    v_mfma_f32_32x32x16_bf16 a[192:207], a[24:27], v[228:231], a[192:207]
    v_mfma_f32_32x32x16_bf16 a[208:223], a[28:31], v[228:231], a[208:223]
    s_add_u32 s75, s90, s21
    buffer_load_dwordx4 v[236:239], v254, s[12:15], s75 offen offset:2048 sc1
    buffer_load_dwordx4 v[240:243], v254, s[12:15], s75 offen offset:3072 sc1
    v_mfma_f32_32x32x16_bf16 a[192:207], a[32:35], v[232:235], a[192:207]
    v_mfma_f32_32x32x16_bf16 a[208:223], a[36:39], v[232:235], a[208:223]
    s_waitcnt vmcnt(12)
    v_mfma_f32_32x32x16_bf16 a[192:207], a[56:59], v[68:71], a[192:207]
    v_mfma_f32_32x32x16_bf16 a[208:223], a[60:63], v[68:71], a[208:223]
    s_add_u32 s75, s90, s22
    buffer_load_dwordx4 v[76:79], v254, s[12:15], s75 offen offset:2048 sc1
    buffer_load_dwordx4 v[80:83], v254, s[12:15], s75 offen offset:3072 sc1
    s_waitcnt lgkmcnt(0)
    s_barrier
    ds_read_b128 v[84:87], v7 offset:12288
    ds_read_b128 v[88:91], v7 offset:13312
    ds_read_b128 v[100:103], v7 offset:16384
    ds_read_b128 v[104:107], v7 offset:17408
    ds_read_b128 v[132:135], v7 offset:20480
    ds_read_b128 v[136:139], v7 offset:21504
    v_mfma_f32_32x32x16_bf16 a[192:207], a[64:67], v[72:75], a[192:207]
    v_mfma_f32_32x32x16_bf16 a[208:223], a[68:71], v[72:75], a[208:223]
    s_waitcnt vmcnt(12)
    v_mfma_f32_32x32x16_bf16 a[192:207], a[128:131], v[28:31], a[192:207]
    v_mfma_f32_32x32x16_bf16 a[208:223], a[132:135], v[28:31], a[208:223]
    v_mfma_f32_32x32x16_bf16 a[192:207], a[136:139], v[32:35], a[192:207]
    v_mfma_f32_32x32x16_bf16 a[208:223], a[140:143], v[32:35], a[208:223]
    s_waitcnt lgkmcnt(5)
    v_add_f32 v108, v108, v84
    v_add_f32 v109, v109, v85
    s_waitcnt vmcnt(10)
    v_mfma_f32_32x32x16_bf16 a[192:207], a[224:227], v[44:47], a[192:207]
    v_mfma_f32_32x32x16_bf16 a[208:223], a[228:231], v[44:47], a[208:223]
    v_add_f32 v110, v110, v86
    v_add_f32 v111, v111, v87
    s_waitcnt lgkmcnt(4)
    v_add_f32 v112, v112, v88
    v_mfma_f32_32x32x16_bf16 a[192:207], a[232:235], v[48:51], a[192:207]
    v_mfma_f32_32x32x16_bf16 a[208:223], a[236:239], v[48:51], a[208:223]
    v_add_f32 v113, v113, v89
    v_add_f32 v114, v114, v90
    v_add_f32 v115, v115, v91
    s_waitcnt vmcnt(8)
    v_mfma_f32_32x32x16_bf16 a[192:207], v[140:143], v[60:63], a[192:207]
    v_mfma_f32_32x32x16_bf16 a[208:223], v[144:147], v[60:63], a[208:223]
    s_waitcnt lgkmcnt(3)
    v_add_f32 v108, v108, v100
    v_add_f32 v109, v109, v101
    v_add_f32 v110, v110, v102
    v_mfma_f32_32x32x16_bf16 a[192:207], v[148:151], v[64:67], a[192:207]
    v_mfma_f32_32x32x16_bf16 a[208:223], v[152:155], v[64:67], a[208:223]
    v_add_f32 v111, v111, v103
    s_waitcnt lgkmcnt(2)
    v_add_f32 v112, v112, v104
    v_add_f32 v113, v113, v105
    s_waitcnt vmcnt(6)
    v_mfma_f32_32x32x16_bf16 a[192:207], v[172:175], v[204:207], a[192:207]
    v_mfma_f32_32x32x16_bf16 a[208:223], v[176:179], v[204:207], a[208:223]
    v_add_f32 v114, v114, v106
    v_add_f32 v115, v115, v107
    v_mfma_f32_32x32x16_bf16 a[192:207], v[180:183], v[208:211], a[192:207]
    v_mfma_f32_32x32x16_bf16 a[208:223], v[184:187], v[208:211], a[208:223]
    s_waitcnt lgkmcnt(1)
    v_add_f32 v108, v108, v132
    v_add_f32 v109, v109, v133
    v_add_f32 v110, v110, v134
    s_waitcnt vmcnt(4)
    v_mfma_f32_32x32x16_bf16 a[192:207], a[8:11], v[220:223], a[192:207]
    v_mfma_f32_32x32x16_bf16 a[208:223], a[12:15], v[220:223], a[208:223]
    v_add_f32 v111, v111, v135
    s_waitcnt lgkmcnt(0)
    v_add_f32 v112, v112, v136
    v_add_f32 v113, v113, v137
    v_mfma_f32_32x32x16_bf16 a[192:207], a[16:19], v[224:227], a[192:207]
    v_mfma_f32_32x32x16_bf16 a[208:223], a[20:23], v[224:227], a[208:223]
    v_add_f32 v114, v114, v138
    v_add_f32 v115, v115, v139
    v_cvt_pk_bf16_f32 v124, v108, v109
    s_waitcnt vmcnt(2)
    v_mfma_f32_32x32x16_bf16 a[192:207], a[40:43], v[236:239], a[192:207]
    v_mfma_f32_32x32x16_bf16 a[208:223], a[44:47], v[236:239], a[208:223]
    v_cvt_pk_bf16_f32 v125, v110, v111
    v_cvt_pk_bf16_f32 v126, v112, v113
    v_cvt_pk_bf16_f32 v127, v114, v115
    v_mfma_f32_32x32x16_bf16 a[192:207], a[48:51], v[240:243], a[192:207]
    v_mfma_f32_32x32x16_bf16 a[208:223], a[52:55], v[240:243], a[208:223]
    v_permlane32_swap_b32 v124, v126
    v_permlane32_swap_b32 v125, v127
    buffer_store_dwordx4 v[124:127], v252, s[56:59], s71 offen
    s_waitcnt vmcnt(1)
    v_mfma_f32_32x32x16_bf16 a[192:207], a[72:75], v[76:79], a[192:207]
    v_mfma_f32_32x32x16_bf16 a[208:223], a[76:79], v[76:79], a[208:223]
    v_mfma_f32_32x32x16_bf16 a[192:207], a[80:83], v[80:83], a[192:207]
    v_mfma_f32_32x32x16_bf16 a[208:223], a[84:87], v[80:83], a[208:223]
    s_nop 10
    v_accvgpr_read_b32 v116, a192
    v_cmp_u_f32 vcc, v116, v116
    s_nop 0
    s_cbranch_vccnz L_p5b_redo
L_p5b_ok:
    s_nop 6
    ds_write_b128 v8, a[208:211] offset:2048
    ds_write_b128 v8, a[212:215] offset:3072
    ds_write_b128 v9, a[200:203] offset:2048
    ds_write_b128 v9, a[204:207] offset:3072
    ds_write_b128 v253, a[216:219] offset:2048
    ds_write_b128 v253, a[220:223] offset:3072
    v_accvgpr_read_b32 v117, a193
    v_accvgpr_read_b32 v118, a194
    v_accvgpr_read_b32 v119, a195
    v_accvgpr_read_b32 v120, a196
    v_accvgpr_read_b32 v121, a197
    v_accvgpr_read_b32 v122, a198
    v_accvgpr_read_b32 v123, a199
    v_pk_add_f32 v[116:117], v[116:117], v[92:93]
    v_pk_add_f32 v[118:119], v[118:119], v[94:95]
    v_pk_add_f32 v[120:121], v[120:121], v[96:97]
    v_pk_add_f32 v[122:123], v[122:123], v[98:99]
    s_waitcnt lgkmcnt(0)
    s_barrier
    ds_read_b128 v[20:23], v7 offset:14336
    ds_read_b128 v[24:27], v7 offset:15360
    ds_read_b128 v[28:31], v7 offset:18432
    ds_read_b128 v[32:35], v7 offset:19456
    ds_read_b128 v[36:39], v7 offset:22528
    ds_read_b128 v[40:43], v7 offset:23552
    s_waitcnt lgkmcnt(5)
    v_pk_add_f32 v[116:117], v[116:117], v[20:21]
    v_pk_add_f32 v[118:119], v[118:119], v[22:23]
    s_waitcnt lgkmcnt(4)
    v_pk_add_f32 v[120:121], v[120:121], v[24:25]
    v_pk_add_f32 v[122:123], v[122:123], v[26:27]
    s_waitcnt lgkmcnt(3)
    v_pk_add_f32 v[116:117], v[116:117], v[28:29]
    v_pk_add_f32 v[118:119], v[118:119], v[30:31]
    s_waitcnt lgkmcnt(2)
    v_pk_add_f32 v[120:121], v[120:121], v[32:33]
    v_pk_add_f32 v[122:123], v[122:123], v[34:35]
    s_waitcnt lgkmcnt(1)
    v_pk_add_f32 v[116:117], v[116:117], v[36:37]
    v_pk_add_f32 v[118:119], v[118:119], v[38:39]
    s_waitcnt lgkmcnt(0)
    v_pk_add_f32 v[120:121], v[120:121], v[40:41]
    v_pk_add_f32 v[122:123], v[122:123], v[42:43]
    v_cvt_pk_bf16_f32 v128, v116, v117
    v_cvt_pk_bf16_f32 v129, v118, v119
    v_cvt_pk_bf16_f32 v130, v120, v121
    v_cvt_pk_bf16_f32 v131, v122, v123
    s_nop 0
    v_permlane32_swap_b32 v128, v130
    v_permlane32_swap_b32 v129, v131
    buffer_store_dwordx4 v[128:131], v252, s[56:59], s72 offen
L_fin7:
    s_waitcnt vmcnt(0)
L_end:
    s_endpgm
L_slow:
    s_waitcnt vmcnt(0) lgkmcnt(0)
    buffer_store_dwordx4 v[244:247], v1, s[12:15], s85 offen sc1
    buffer_store_dwordx4 v[244:247], v1, s[12:15], s38 offen sc1
    buffer_store_dwordx4 v[244:247], v248, s[12:15], s87 offen sc1
    buffer_store_dwordx4 v[244:247], v248, s[12:15], s39 offen sc1
    buffer_store_dwordx4 v[244:247], v248, s[12:15], s89 offen sc1
    buffer_store_dwordx4 v[244:247], v248, s[12:15], s89 offen offset:1024 sc1
    buffer_store_dwordx4 v[244:247], v248, s[12:15], s89 offen offset:2048 sc1
    buffer_store_dwordx4 v[244:247], v248, s[12:15], s89 offen offset:3072 sc1
    buffer_store_dwordx4 v[244:247], v248, s[12:15], s33 offen sc1
    buffer_store_dwordx4 v[244:247], v248, s[12:15], s33 offen offset:1024 sc1
    buffer_store_dwordx4 v[244:247], v248, s[12:15], s33 offen offset:2048 sc1
    buffer_store_dwordx4 v[244:247], v248, s[12:15], s33 offen offset:3072 sc1
    s_waitcnt vmcnt(0)
    s_lshl2_add_u32 s70, s5, s4
    s_lshl2_add_u32 s70, s70, s32
    v_mov_b32 v249, s7
    s_mov_b64 exec, 1
    buffer_store_dword v249, v2, s[12:15], s70 offen sc1
    s_mov_b64 exec, -1
    s_add_u32 m0, s100, 12288
    s_add_u32 s74, s91, 0
    buffer_load_dwordx4 v3, s[44:47], s74 offen lds
    buffer_load_dwordx4 v6, s[44:47], s74 offen offset:1024 lds
    s_add_u32 m0, s100, 14336
    s_add_u32 s74, s91, 14336
    buffer_load_dwordx4 v3, s[44:47], s74 offen lds
    buffer_load_dwordx4 v6, s[44:47], s74 offen offset:1024 lds
    s_add_u32 m0, s100, 16384
    s_add_u32 s74, s91, 28672
    buffer_load_dwordx4 v3, s[44:47], s74 offen lds
    buffer_load_dwordx4 v6, s[44:47], s74 offen offset:1024 lds
    s_add_u32 m0, s100, 18432
    s_add_u32 s74, s91, 43008
    buffer_load_dwordx4 v3, s[44:47], s74 offen lds
    buffer_load_dwordx4 v6, s[44:47], s74 offen offset:1024 lds
    s_add_u32 m0, s100, 20480
    s_add_u32 s74, s91, 57344
    buffer_load_dwordx4 v3, s[44:47], s74 offen lds
    buffer_load_dwordx4 v6, s[44:47], s74 offen offset:1024 lds
    s_add_u32 m0, s100, 22528
    s_add_u32 s74, s91, 71680
    buffer_load_dwordx4 v3, s[44:47], s74 offen lds
    buffer_load_dwordx4 v6, s[44:47], s74 offen offset:1024 lds
    s_add_u32 m0, s100, 24576
    s_add_u32 s74, s91, 86016
    buffer_load_dwordx4 v3, s[44:47], s74 offen lds
    buffer_load_dwordx4 v6, s[44:47], s74 offen offset:1024 lds
    s_add_u32 m0, s100, 26624
    s_add_u32 s74, s92, 0
    buffer_load_dwordx4 v4, s[48:51], s74 offen lds
    buffer_load_dwordx4 v251, s[48:51], s74 offen offset:1024 lds
    s_add_u32 m0, s100, 28672
    s_add_u32 s74, s92, 57344
    buffer_load_dwordx4 v4, s[48:51], s74 offen lds
    buffer_load_dwordx4 v251, s[48:51], s74 offen offset:1024 lds
    s_add_u32 m0, s100, 30720
    s_add_u32 s74, s92, 114688
    buffer_load_dwordx4 v4, s[48:51], s74 offen lds
    buffer_load_dwordx4 v251, s[48:51], s74 offen offset:1024 lds
    s_add_u32 m0, s100, 32768
    s_add_u32 s74, s92, 172032
    buffer_load_dwordx4 v4, s[48:51], s74 offen lds
    buffer_load_dwordx4 v251, s[48:51], s74 offen offset:1024 lds
    s_add_u32 m0, s100, 34816
    s_add_u32 s74, s92, 229376
    buffer_load_dwordx4 v4, s[48:51], s74 offen lds
    buffer_load_dwordx4 v251, s[48:51], s74 offen offset:1024 lds
    s_waitcnt vmcnt(0)
    ds_read_b64_tr_b16 a[0:1], v5 offset:26624
    ds_read_b64_tr_b16 a[2:3], v5 offset:27648
    ds_read_b64_tr_b16 a[4:5], v250 offset:26624
    ds_read_b64_tr_b16 a[6:7], v250 offset:27648
    ds_read_b64_tr_b16 a[8:9], v5 offset:28672
    ds_read_b64_tr_b16 a[10:11], v5 offset:29696
    ds_read_b64_tr_b16 a[12:13], v250 offset:28672
    ds_read_b64_tr_b16 a[14:15], v250 offset:29696
    ds_read_b64_tr_b16 a[16:17], v5 offset:30720
    ds_read_b64_tr_b16 a[18:19], v5 offset:31744
    ds_read_b64_tr_b16 a[20:21], v250 offset:30720
    ds_read_b64_tr_b16 a[22:23], v250 offset:31744
    ds_read_b64_tr_b16 a[24:25], v5 offset:32768
    ds_read_b64_tr_b16 a[26:27], v5 offset:33792
    ds_read_b64_tr_b16 a[28:29], v250 offset:32768
    ds_read_b64_tr_b16 a[30:31], v250 offset:33792
    ds_read_b64_tr_b16 a[32:33], v5 offset:34816
    ds_read_b64_tr_b16 a[34:35], v5 offset:35840
    ds_read_b64_tr_b16 a[36:37], v250 offset:34816
    ds_read_b64_tr_b16 a[38:39], v250 offset:35840
    s_waitcnt lgkmcnt(0)
    s_add_u32 m0, s100, 26624
    s_add_u32 s74, s92, 286720
    buffer_load_dwordx4 v4, s[48:51], s74 offen lds
    buffer_load_dwordx4 v251, s[48:51], s74 offen offset:1024 lds
    s_add_u32 m0, s100, 28672
    s_add_u32 s74, s92, 344064
    buffer_load_dwordx4 v4, s[48:51], s74 offen lds
    buffer_load_dwordx4 v251, s[48:51], s74 offen offset:1024 lds
    s_add_u32 m0, s100, 30720
    s_add_u32 s74, s92, 401408
    buffer_load_dwordx4 v4, s[48:51], s74 offen lds
    buffer_load_dwordx4 v251, s[48:51], s74 offen offset:1024 lds
    s_add_u32 m0, s100, 32768
    s_add_u32 s74, s92, 458752
    buffer_load_dwordx4 v4, s[48:51], s74 offen lds
    buffer_load_dwordx4 v251, s[48:51], s74 offen offset:1024 lds
    s_add_u32 m0, s100, 34816
    s_add_u32 s74, s92, 516096
    buffer_load_dwordx4 v4, s[48:51], s74 offen lds
    buffer_load_dwordx4 v251, s[48:51], s74 offen offset:1024 lds
    s_waitcnt vmcnt(0)
    ds_read_b64_tr_b16 a[40:41], v5 offset:26624
    ds_read_b64_tr_b16 a[42:43], v5 offset:27648
    ds_read_b64_tr_b16 a[44:45], v250 offset:26624
    ds_read_b64_tr_b16 a[46:47], v250 offset:27648
    ds_read_b64_tr_b16 a[48:49], v5 offset:28672
    ds_read_b64_tr_b16 a[50:51], v5 offset:29696
    ds_read_b64_tr_b16 a[52:53], v250 offset:28672
    ds_read_b64_tr_b16 a[54:55], v250 offset:29696
    ds_read_b64_tr_b16 a[56:57], v5 offset:30720
    ds_read_b64_tr_b16 a[58:59], v5 offset:31744
    ds_read_b64_tr_b16 a[60:61], v250 offset:30720
    ds_read_b64_tr_b16 a[62:63], v250 offset:31744
    ds_read_b64_tr_b16 a[64:65], v5 offset:32768
    ds_read_b64_tr_b16 a[66:67], v5 offset:33792
    ds_read_b64_tr_b16 a[68:69], v250 offset:32768
    ds_read_b64_tr_b16 a[70:71], v250 offset:33792
    ds_read_b64_tr_b16 a[72:73], v5 offset:34816
    ds_read_b64_tr_b16 a[74:75], v5 offset:35840
    ds_read_b64_tr_b16 a[76:77], v250 offset:34816
    ds_read_b64_tr_b16 a[78:79], v250 offset:35840
    s_waitcnt lgkmcnt(0)
    s_add_u32 m0, s100, 26624
    s_add_u32 s74, s92, 573440
    buffer_load_dwordx4 v4, s[48:51], s74 offen lds
    buffer_load_dwordx4 v251, s[48:51], s74 offen offset:1024 lds
    s_add_u32 m0, s100, 28672
    s_add_u32 s74, s92, 630784
    buffer_load_dwordx4 v4, s[48:51], s74 offen lds
    buffer_load_dwordx4 v251, s[48:51], s74 offen offset:1024 lds
    s_add_u32 m0, s100, 30720
    s_add_u32 s74, s92, 688128
    buffer_load_dwordx4 v4, s[48:51], s74 offen lds
    buffer_load_dwordx4 v251, s[48:51], s74 offen offset:1024 lds
    s_add_u32 m0, s100, 32768
    s_add_u32 s74, s92, 745472
    buffer_load_dwordx4 v4, s[48:51], s74 offen lds
    buffer_load_dwordx4 v251, s[48:51], s74 offen offset:1024 lds
    s_add_u32 m0, s100, 34816
    s_add_u32 s74, s92, 1089536
    buffer_load_dwordx4 v4, s[48:51], s74 offen lds
    buffer_load_dwordx4 v251, s[48:51], s74 offen offset:1024 lds
    s_waitcnt vmcnt(0)
    ds_read_b64_tr_b16 a[80:81], v5 offset:26624
    ds_read_b64_tr_b16 a[82:83], v5 offset:27648
    ds_read_b64_tr_b16 a[84:85], v250 offset:26624
    ds_read_b64_tr_b16 a[86:87], v250 offset:27648
    ds_read_b64_tr_b16 a[88:89], v5 offset:28672
    ds_read_b64_tr_b16 a[90:91], v5 offset:29696
    ds_read_b64_tr_b16 a[92:93], v250 offset:28672
    ds_read_b64_tr_b16 a[94:95], v250 offset:29696
    ds_read_b64_tr_b16 a[96:97], v5 offset:30720
    ds_read_b64_tr_b16 a[98:99], v5 offset:31744
    ds_read_b64_tr_b16 a[100:101], v250 offset:30720
    ds_read_b64_tr_b16 a[102:103], v250 offset:31744
    ds_read_b64_tr_b16 a[104:105], v5 offset:32768
    ds_read_b64_tr_b16 a[106:107], v5 offset:33792
    ds_read_b64_tr_b16 a[108:109], v250 offset:32768
    ds_read_b64_tr_b16 a[110:111], v250 offset:33792
    ds_read_b64_tr_b16 a[200:201], v5 offset:34816
    ds_read_b64_tr_b16 a[202:203], v5 offset:35840
    ds_read_b64_tr_b16 a[204:205], v250 offset:34816
    ds_read_b64_tr_b16 a[206:207], v250 offset:35840
    s_waitcnt lgkmcnt(0)
    s_add_u32 m0, s100, 26624
    s_add_u32 s74, s92, 1146880
    buffer_load_dwordx4 v4, s[48:51], s74 offen lds
    buffer_load_dwordx4 v251, s[48:51], s74 offen offset:1024 lds
    s_add_u32 m0, s100, 28672
    s_add_u32 s74, s92, 1204224
    buffer_load_dwordx4 v4, s[48:51], s74 offen lds
    buffer_load_dwordx4 v251, s[48:51], s74 offen offset:1024 lds
    s_add_u32 m0, s100, 30720
    s_add_u32 s74, s92, 1261568
    buffer_load_dwordx4 v4, s[48:51], s74 offen lds
    buffer_load_dwordx4 v251, s[48:51], s74 offen offset:1024 lds
    s_add_u32 m0, s100, 32768
    s_add_u32 s74, s92, 1318912
    buffer_load_dwordx4 v4, s[48:51], s74 offen lds
    buffer_load_dwordx4 v251, s[48:51], s74 offen offset:1024 lds
    s_add_u32 m0, s100, 34816
    s_add_u32 s74, s92, 1376256
    buffer_load_dwordx4 v4, s[48:51], s74 offen lds
    buffer_load_dwordx4 v251, s[48:51], s74 offen offset:1024 lds
    s_waitcnt vmcnt(0)
    ds_read_b64_tr_b16 a[208:209], v5 offset:26624
    ds_read_b64_tr_b16 a[210:211], v5 offset:27648
    ds_read_b64_tr_b16 a[212:213], v250 offset:26624
    ds_read_b64_tr_b16 a[214:215], v250 offset:27648
    ds_read_b64_tr_b16 a[216:217], v5 offset:28672
    ds_read_b64_tr_b16 a[218:219], v5 offset:29696
    ds_read_b64_tr_b16 a[220:221], v250 offset:28672
    ds_read_b64_tr_b16 a[222:223], v250 offset:29696
    ds_read_b64_tr_b16 v[196:197], v5 offset:30720
    ds_read_b64_tr_b16 v[198:199], v5 offset:31744
    ds_read_b64_tr_b16 v[200:201], v250 offset:30720
    ds_read_b64_tr_b16 v[202:203], v250 offset:31744
    ds_read_b64_tr_b16 v[204:205], v5 offset:32768
    ds_read_b64_tr_b16 v[206:207], v5 offset:33792
    ds_read_b64_tr_b16 v[208:209], v250 offset:32768
    ds_read_b64_tr_b16 v[210:211], v250 offset:33792
    ds_read_b64_tr_b16 v[212:213], v5 offset:34816
    ds_read_b64_tr_b16 v[214:215], v5 offset:35840
    ds_read_b64_tr_b16 v[216:217], v250 offset:34816
    ds_read_b64_tr_b16 v[218:219], v250 offset:35840
    s_waitcnt lgkmcnt(0)
    s_add_u32 m0, s100, 26624
    s_add_u32 s74, s92, 1433600
    buffer_load_dwordx4 v4, s[48:51], s74 offen lds
    buffer_load_dwordx4 v251, s[48:51], s74 offen offset:1024 lds
    s_add_u32 m0, s100, 28672
    s_add_u32 s74, s92, 1490944
    buffer_load_dwordx4 v4, s[48:51], s74 offen lds
    buffer_load_dwordx4 v251, s[48:51], s74 offen offset:1024 lds
    s_add_u32 m0, s100, 30720
    s_add_u32 s74, s92, 1548288
    buffer_load_dwordx4 v4, s[48:51], s74 offen lds
    buffer_load_dwordx4 v251, s[48:51], s74 offen offset:1024 lds
    s_waitcnt vmcnt(0)
    ds_read_b64_tr_b16 v[220:221], v5 offset:26624
    ds_read_b64_tr_b16 v[222:223], v5 offset:27648
    ds_read_b64_tr_b16 v[224:225], v250 offset:26624
    ds_read_b64_tr_b16 v[226:227], v250 offset:27648
    ds_read_b64_tr_b16 v[228:229], v5 offset:28672
    ds_read_b64_tr_b16 v[230:231], v5 offset:29696
    ds_read_b64_tr_b16 v[232:233], v250 offset:28672
    ds_read_b64_tr_b16 v[234:235], v250 offset:29696
    ds_read_b64_tr_b16 v[236:237], v5 offset:30720
    ds_read_b64_tr_b16 v[238:239], v5 offset:31744
    ds_read_b64_tr_b16 v[240:241], v250 offset:30720
    ds_read_b64_tr_b16 v[242:243], v250 offset:31744
    s_waitcnt lgkmcnt(0)
    s_add_u32 m0, s100, 26624
    s_add_u32 s74, s92, 802816
    buffer_load_dwordx4 v4, s[48:51], s74 offen lds
    buffer_load_dwordx4 v251, s[48:51], s74 offen offset:1024 lds
    s_add_u32 m0, s100, 28672
    s_add_u32 s74, s92, 860160
    buffer_load_dwordx4 v4, s[48:51], s74 offen lds
    buffer_load_dwordx4 v251, s[48:51], s74 offen offset:1024 lds
    s_add_u32 m0, s100, 30720
    s_add_u32 s74, s92, 917504
    buffer_load_dwordx4 v4, s[48:51], s74 offen lds
    buffer_load_dwordx4 v251, s[48:51], s74 offen offset:1024 lds
    s_add_u32 m0, s100, 32768
    s_add_u32 s74, s92, 974848
    buffer_load_dwordx4 v4, s[48:51], s74 offen lds
    buffer_load_dwordx4 v251, s[48:51], s74 offen offset:1024 lds
    s_add_u32 m0, s100, 34816
    s_add_u32 s74, s92, 1032192
    buffer_load_dwordx4 v4, s[48:51], s74 offen lds
    buffer_load_dwordx4 v251, s[48:51], s74 offen offset:1024 lds
    v_and_b32 v253, 31, v0
    v_lshlrev_b32 v253, 2, v253
    buffer_load_dword v254, v253, s[12:15], s32 offen sc1
    s_mov_b32 s94, 0
L_p3c_b:
    s_waitcnt vmcnt(0)
    v_cmp_ne_u32 vcc, s7, v254
    s_nop 0
    s_cbranch_vccz L_p3k_b
    s_add_u32 s94, s94, 1
    s_cmp_gt_u32 s94, 131072
    s_cbranch_scc1 L_p3k_b
    s_sleep 4
    v_and_b32 v253, 31, v0
    v_lshlrev_b32 v253, 2, v253
    buffer_load_dword v254, v253, s[12:15], s32 offen sc1
    s_waitcnt vmcnt(0)
    s_branch L_p3c_b
L_p3k_b:
    v_mov_b32 v60, 0xff7fffff
    v_mov_b32 v68, 0
    v_mov_b32 v69, 0
    v_mov_b32 v70, 0
    v_mov_b32 v71, 0
    v_mov_b32 v72, 0
    v_mov_b32 v73, 0
    v_mov_b32 v74, 0
    v_mov_b32 v75, 0
    v_mov_b32 v76, 0
    v_mov_b32 v77, 0
    v_mov_b32 v78, 0
    v_mov_b32 v79, 0
    v_mov_b32 v80, 0
    v_mov_b32 v81, 0
    v_mov_b32 v82, 0
    v_mov_b32 v83, 0
    v_mov_b32 v61, 0xff7fffff
    v_mov_b32 v84, 0
    v_mov_b32 v85, 0
    v_mov_b32 v86, 0
    v_mov_b32 v87, 0
    v_mov_b32 v88, 0
    v_mov_b32 v89, 0
    v_mov_b32 v90, 0
    v_mov_b32 v91, 0
    v_mov_b32 v92, 0
    v_mov_b32 v93, 0
    v_mov_b32 v94, 0
    v_mov_b32 v95, 0
    v_mov_b32 v96, 0
    v_mov_b32 v97, 0
    v_mov_b32 v98, 0
    v_mov_b32 v99, 0
    v_mov_b32 v62, 0xff7fffff
    v_mov_b32 v100, 0
    v_mov_b32 v101, 0
    v_mov_b32 v102, 0
    v_mov_b32 v103, 0
    v_mov_b32 v104, 0
    v_mov_b32 v105, 0
    v_mov_b32 v106, 0
    v_mov_b32 v107, 0
    v_mov_b32 v108, 0
    v_mov_b32 v109, 0
    v_mov_b32 v110, 0
    v_mov_b32 v111, 0
    v_mov_b32 v112, 0
    v_mov_b32 v113, 0
    v_mov_b32 v114, 0
    v_mov_b32 v115, 0
    v_mov_b32 v63, 0xff7fffff
    v_mov_b32 v116, 0
    v_mov_b32 v117, 0
    v_mov_b32 v118, 0
    v_mov_b32 v119, 0
    v_mov_b32 v120, 0
    v_mov_b32 v121, 0
    v_mov_b32 v122, 0
    v_mov_b32 v123, 0
    v_mov_b32 v124, 0
    v_mov_b32 v125, 0
    v_mov_b32 v126, 0
    v_mov_b32 v127, 0
    v_mov_b32 v128, 0
    v_mov_b32 v129, 0
    v_mov_b32 v130, 0
    v_mov_b32 v131, 0
    s_mov_b32 s76, 0
L_slow_loop:
    buffer_load_dwordx4 v[132:135], v1, s[12:15], s84 offen sc1
    buffer_load_dwordx4 v[136:139], v1, s[12:15], s84 offen offset:1024 sc1
    buffer_load_dwordx4 v[140:143], v195, s[12:15], s84 offen offset:2048 sc1
    buffer_load_dwordx4 v[144:147], v195, s[12:15], s84 offen offset:3072 sc1
    s_waitcnt vmcnt(0)
    v_mfma_f32_32x32x16_bf16 v[20:35], v[132:135], a[224:227], 0
    v_mfma_f32_32x32x16_bf16 v[20:35], v[136:139], a[228:231], v[20:35]
    s_nop 11
    v_max3_f32 v64, v20, v21, v60
    v_max3_f32 v64, v22, v23, v64
    v_max3_f32 v64, v24, v25, v64
    v_max3_f32 v64, v26, v27, v64
    v_max3_f32 v64, v28, v29, v64
    v_max3_f32 v64, v30, v31, v64
    v_max3_f32 v64, v32, v33, v64
    v_max3_f32 v64, v34, v35, v64
    v_mov_b32 v65, v64
    s_nop 1
    v_permlane32_swap_b32 v64, v65
    v_max_f32 v64, v64, v65
    v_sub_f32 v65, v60, v64
    v_exp_f32 v65, v65
    v_mov_b32 v60, v64
    v_sub_f32 v20, v20, v64
    v_exp_f32 v20, v20
    v_mul_f32 v68, v65, v68
    v_sub_f32 v21, v21, v64
    v_exp_f32 v21, v21
    v_mul_f32 v69, v65, v69
    v_sub_f32 v22, v22, v64
    v_exp_f32 v22, v22
    v_mul_f32 v70, v65, v70
    v_sub_f32 v23, v23, v64
    v_exp_f32 v23, v23
    v_mul_f32 v71, v65, v71
    v_sub_f32 v24, v24, v64
    v_exp_f32 v24, v24
    v_mul_f32 v72, v65, v72
    v_sub_f32 v25, v25, v64
    v_exp_f32 v25, v25
    v_mul_f32 v73, v65, v73
    v_sub_f32 v26, v26, v64
    v_exp_f32 v26, v26
    v_mul_f32 v74, v65, v74
    v_sub_f32 v27, v27, v64
    v_exp_f32 v27, v27
    v_mul_f32 v75, v65, v75
    v_sub_f32 v28, v28, v64
    v_exp_f32 v28, v28
    v_mul_f32 v76, v65, v76
    v_sub_f32 v29, v29, v64
    v_exp_f32 v29, v29
    v_mul_f32 v77, v65, v77
    v_sub_f32 v30, v30, v64
    v_exp_f32 v30, v30
    v_mul_f32 v78, v65, v78
    v_sub_f32 v31, v31, v64
    v_exp_f32 v31, v31
    v_mul_f32 v79, v65, v79
    v_sub_f32 v32, v32, v64
    v_exp_f32 v32, v32
    v_mul_f32 v80, v65, v80
    v_sub_f32 v33, v33, v64
    v_exp_f32 v33, v33
    v_mul_f32 v81, v65, v81
    v_sub_f32 v34, v34, v64
    v_exp_f32 v34, v34
    v_mul_f32 v82, v65, v82
    v_sub_f32 v35, v35, v64
    v_exp_f32 v35, v35
    v_mul_f32 v83, v65, v83
    v_cvt_pk_bf16_f32 v52, v20, v21
    v_cvt_pk_bf16_f32 v53, v22, v23
    v_cvt_pk_bf16_f32 v54, v24, v25
    v_cvt_pk_bf16_f32 v55, v26, v27
    v_cvt_pk_bf16_f32 v56, v28, v29
    v_cvt_pk_bf16_f32 v57, v30, v31
    v_cvt_pk_bf16_f32 v58, v32, v33
    v_cvt_pk_bf16_f32 v59, v34, v35
    v_mfma_f32_32x32x16_bf16 v[68:83], v[140:143], v[52:55], v[68:83]
    s_nop 0
    v_mfma_f32_32x32x16_bf16 v[68:83], v[144:147], v[56:59], v[68:83]
    v_mfma_f32_32x32x16_bf16 v[20:35], v[132:135], a[232:235], 0
    v_mfma_f32_32x32x16_bf16 v[20:35], v[136:139], a[236:239], v[20:35]
    s_nop 11
    v_max3_f32 v64, v20, v21, v61
    v_max3_f32 v64, v22, v23, v64
    v_max3_f32 v64, v24, v25, v64
    v_max3_f32 v64, v26, v27, v64
    v_max3_f32 v64, v28, v29, v64
    v_max3_f32 v64, v30, v31, v64
    v_max3_f32 v64, v32, v33, v64
    v_max3_f32 v64, v34, v35, v64
    v_mov_b32 v65, v64
    s_nop 1
    v_permlane32_swap_b32 v64, v65
    v_max_f32 v64, v64, v65
    v_sub_f32 v65, v61, v64
    v_exp_f32 v65, v65
    v_mov_b32 v61, v64
    v_sub_f32 v20, v20, v64
    v_exp_f32 v20, v20
    v_mul_f32 v84, v65, v84
    v_sub_f32 v21, v21, v64
    v_exp_f32 v21, v21
    v_mul_f32 v85, v65, v85
    v_sub_f32 v22, v22, v64
    v_exp_f32 v22, v22
    v_mul_f32 v86, v65, v86
    v_sub_f32 v23, v23, v64
    v_exp_f32 v23, v23
    v_mul_f32 v87, v65, v87
    v_sub_f32 v24, v24, v64
    v_exp_f32 v24, v24
    v_mul_f32 v88, v65, v88
    v_sub_f32 v25, v25, v64
    v_exp_f32 v25, v25
    v_mul_f32 v89, v65, v89
    v_sub_f32 v26, v26, v64
    v_exp_f32 v26, v26
    v_mul_f32 v90, v65, v90
    v_sub_f32 v27, v27, v64
    v_exp_f32 v27, v27
    v_mul_f32 v91, v65, v91
    v_sub_f32 v28, v28, v64
    v_exp_f32 v28, v28
    v_mul_f32 v92, v65, v92
    v_sub_f32 v29, v29, v64
    v_exp_f32 v29, v29
    v_mul_f32 v93, v65, v93
    v_sub_f32 v30, v30, v64
    v_exp_f32 v30, v30
    v_mul_f32 v94, v65, v94
    v_sub_f32 v31, v31, v64
    v_exp_f32 v31, v31
    v_mul_f32 v95, v65, v95
    v_sub_f32 v32, v32, v64
    v_exp_f32 v32, v32
    v_mul_f32 v96, v65, v96
    v_sub_f32 v33, v33, v64
    v_exp_f32 v33, v33
    v_mul_f32 v97, v65, v97
    v_sub_f32 v34, v34, v64
    v_exp_f32 v34, v34
    v_mul_f32 v98, v65, v98
    v_sub_f32 v35, v35, v64
    v_exp_f32 v35, v35
    v_mul_f32 v99, v65, v99
    v_cvt_pk_bf16_f32 v52, v20, v21
    v_cvt_pk_bf16_f32 v53, v22, v23
    v_cvt_pk_bf16_f32 v54, v24, v25
    v_cvt_pk_bf16_f32 v55, v26, v27
    v_cvt_pk_bf16_f32 v56, v28, v29
    v_cvt_pk_bf16_f32 v57, v30, v31
    v_cvt_pk_bf16_f32 v58, v32, v33
    v_cvt_pk_bf16_f32 v59, v34, v35
    v_mfma_f32_32x32x16_bf16 v[84:99], v[140:143], v[52:55], v[84:99]
    s_nop 0
    v_mfma_f32_32x32x16_bf16 v[84:99], v[144:147], v[56:59], v[84:99]
    v_mfma_f32_32x32x16_bf16 v[20:35], v[132:135], a[240:243], 0
    v_mfma_f32_32x32x16_bf16 v[20:35], v[136:139], a[244:247], v[20:35]
    s_nop 11
    v_max3_f32 v64, v20, v21, v62
    v_max3_f32 v64, v22, v23, v64
    v_max3_f32 v64, v24, v25, v64
    v_max3_f32 v64, v26, v27, v64
    v_max3_f32 v64, v28, v29, v64
    v_max3_f32 v64, v30, v31, v64
    v_max3_f32 v64, v32, v33, v64
    v_max3_f32 v64, v34, v35, v64
    v_mov_b32 v65, v64
    s_nop 1
    v_permlane32_swap_b32 v64, v65
    v_max_f32 v64, v64, v65
    v_sub_f32 v65, v62, v64
    v_exp_f32 v65, v65
    v_mov_b32 v62, v64
    v_sub_f32 v20, v20, v64
    v_exp_f32 v20, v20
    v_mul_f32 v100, v65, v100
    v_sub_f32 v21, v21, v64
    v_exp_f32 v21, v21
    v_mul_f32 v101, v65, v101
    v_sub_f32 v22, v22, v64
    v_exp_f32 v22, v22
    v_mul_f32 v102, v65, v102
    v_sub_f32 v23, v23, v64
    v_exp_f32 v23, v23
    v_mul_f32 v103, v65, v103
    v_sub_f32 v24, v24, v64
    v_exp_f32 v24, v24
    v_mul_f32 v104, v65, v104
    v_sub_f32 v25, v25, v64
    v_exp_f32 v25, v25
    v_mul_f32 v105, v65, v105
    v_sub_f32 v26, v26, v64
    v_exp_f32 v26, v26
    v_mul_f32 v106, v65, v106
    v_sub_f32 v27, v27, v64
    v_exp_f32 v27, v27
    v_mul_f32 v107, v65, v107
    v_sub_f32 v28, v28, v64
    v_exp_f32 v28, v28
    v_mul_f32 v108, v65, v108
    v_sub_f32 v29, v29, v64
    v_exp_f32 v29, v29
    v_mul_f32 v109, v65, v109
    v_sub_f32 v30, v30, v64
    v_exp_f32 v30, v30
    v_mul_f32 v110, v65, v110
    v_sub_f32 v31, v31, v64
    v_exp_f32 v31, v31
    v_mul_f32 v111, v65, v111
    v_sub_f32 v32, v32, v64
    v_exp_f32 v32, v32
    v_mul_f32 v112, v65, v112
    v_sub_f32 v33, v33, v64
    v_exp_f32 v33, v33
    v_mul_f32 v113, v65, v113
    v_sub_f32 v34, v34, v64
    v_exp_f32 v34, v34
    v_mul_f32 v114, v65, v114
    v_sub_f32 v35, v35, v64
    v_exp_f32 v35, v35
    v_mul_f32 v115, v65, v115
    v_cvt_pk_bf16_f32 v52, v20, v21
    v_cvt_pk_bf16_f32 v53, v22, v23
    v_cvt_pk_bf16_f32 v54, v24, v25
    v_cvt_pk_bf16_f32 v55, v26, v27
    v_cvt_pk_bf16_f32 v56, v28, v29
    v_cvt_pk_bf16_f32 v57, v30, v31
    v_cvt_pk_bf16_f32 v58, v32, v33
    v_cvt_pk_bf16_f32 v59, v34, v35
    v_mfma_f32_32x32x16_bf16 v[100:115], v[140:143], v[52:55], v[100:115]
    s_nop 0
    v_mfma_f32_32x32x16_bf16 v[100:115], v[144:147], v[56:59], v[100:115]
    v_mfma_f32_32x32x16_bf16 v[20:35], v[132:135], a[248:251], 0
    v_mfma_f32_32x32x16_bf16 v[20:35], v[136:139], a[252:255], v[20:35]
    s_nop 11
    v_max3_f32 v64, v20, v21, v63
    v_max3_f32 v64, v22, v23, v64
    v_max3_f32 v64, v24, v25, v64
    v_max3_f32 v64, v26, v27, v64
    v_max3_f32 v64, v28, v29, v64
    v_max3_f32 v64, v30, v31, v64
    v_max3_f32 v64, v32, v33, v64
    v_max3_f32 v64, v34, v35, v64
    v_mov_b32 v65, v64
    s_nop 1
    v_permlane32_swap_b32 v64, v65
    v_max_f32 v64, v64, v65
    v_sub_f32 v65, v63, v64
    v_exp_f32 v65, v65
    v_mov_b32 v63, v64
    v_sub_f32 v20, v20, v64
    v_exp_f32 v20, v20
    v_mul_f32 v116, v65, v116
    v_sub_f32 v21, v21, v64
    v_exp_f32 v21, v21
    v_mul_f32 v117, v65, v117
    v_sub_f32 v22, v22, v64
    v_exp_f32 v22, v22
    v_mul_f32 v118, v65, v118
    v_sub_f32 v23, v23, v64
    v_exp_f32 v23, v23
    v_mul_f32 v119, v65, v119
    v_sub_f32 v24, v24, v64
    v_exp_f32 v24, v24
    v_mul_f32 v120, v65, v120
    v_sub_f32 v25, v25, v64
    v_exp_f32 v25, v25
    v_mul_f32 v121, v65, v121
    v_sub_f32 v26, v26, v64
    v_exp_f32 v26, v26
    v_mul_f32 v122, v65, v122
    v_sub_f32 v27, v27, v64
    v_exp_f32 v27, v27
    v_mul_f32 v123, v65, v123
    v_sub_f32 v28, v28, v64
    v_exp_f32 v28, v28
    v_mul_f32 v124, v65, v124
    v_sub_f32 v29, v29, v64
    v_exp_f32 v29, v29
    v_mul_f32 v125, v65, v125
    v_sub_f32 v30, v30, v64
    v_exp_f32 v30, v30
    v_mul_f32 v126, v65, v126
    v_sub_f32 v31, v31, v64
    v_exp_f32 v31, v31
    v_mul_f32 v127, v65, v127
    v_sub_f32 v32, v32, v64
    v_exp_f32 v32, v32
    v_mul_f32 v128, v65, v128
    v_sub_f32 v33, v33, v64
    v_exp_f32 v33, v33
    v_mul_f32 v129, v65, v129
    v_sub_f32 v34, v34, v64
    v_exp_f32 v34, v34
    v_mul_f32 v130, v65, v130
    v_sub_f32 v35, v35, v64
    v_exp_f32 v35, v35
    v_mul_f32 v131, v65, v131
    v_cvt_pk_bf16_f32 v52, v20, v21
    v_cvt_pk_bf16_f32 v53, v22, v23
    v_cvt_pk_bf16_f32 v54, v24, v25
    v_cvt_pk_bf16_f32 v55, v26, v27
    v_cvt_pk_bf16_f32 v56, v28, v29
    v_cvt_pk_bf16_f32 v57, v30, v31
    v_cvt_pk_bf16_f32 v58, v32, v33
    v_cvt_pk_bf16_f32 v59, v34, v35
    v_mfma_f32_32x32x16_bf16 v[116:131], v[140:143], v[52:55], v[116:131]
    s_nop 0
    v_mfma_f32_32x32x16_bf16 v[116:131], v[144:147], v[56:59], v[116:131]
    s_addk_i32 s84, 4096
    s_bitset0_b32 s84, 16
    s_add_u32 s76, s76, 1
    s_cmp_lt_u32 s76, 16
    s_cbranch_scc1 L_slow_loop
    v_lshlrev_b32 v8, 2, v0
    s_xor_b32 s70, s69, 0
    s_lshl_b32 s70, s70, 10
    v_add_u32 v64, s70, v8
    s_lshl_b32 s71, s4, 8
    v_add_u32 v7, s71, v64
    ds_write_b32 v7, v60 offset:4096
    s_xor_b32 s70, s69, 1
    s_lshl_b32 s70, s70, 10
    v_add_u32 v65, s70, v8
    s_lshl_b32 s71, s4, 8
    v_add_u32 v7, s71, v65
    ds_write_b32 v7, v61 offset:4096
    s_xor_b32 s70, s69, 2
    s_lshl_b32 s70, s70, 10
    v_add_u32 v66, s70, v8
    s_lshl_b32 s71, s4, 8
    v_add_u32 v7, s71, v66
    ds_write_b32 v7, v62 offset:4096
    s_xor_b32 s70, s69, 3
    s_lshl_b32 s70, s70, 10
    v_add_u32 v67, s70, v8
    s_lshl_b32 s71, s4, 8
    v_add_u32 v7, s71, v67
    ds_write_b32 v7, v63 offset:4096
    s_waitcnt lgkmcnt(0)
    s_barrier
    ds_read_b32 v20, v64 offset:4096
    ds_read_b32 v21, v64 offset:4352
    ds_read_b32 v22, v64 offset:4608
    ds_read_b32 v23, v64 offset:4864
    s_waitcnt lgkmcnt(1)
    v_max3_f32 v20, v20, v21, v22
    s_waitcnt lgkmcnt(0)
    v_max_f32 v20, v20, v23
    v_sub_f32 v20, v60, v20
    v_exp_f32 v20, v20
    s_nop 0
    v_mul_f32 v68, v20, v68
    v_mul_f32 v69, v20, v69
    v_mul_f32 v70, v20, v70
    v_mul_f32 v71, v20, v71
    v_mul_f32 v72, v20, v72
    v_mul_f32 v73, v20, v73
    v_mul_f32 v74, v20, v74
    v_mul_f32 v75, v20, v75
    v_mul_f32 v76, v20, v76
    v_mul_f32 v77, v20, v77
    v_mul_f32 v78, v20, v78
    v_mul_f32 v79, v20, v79
    v_mul_f32 v80, v20, v80
    v_mul_f32 v81, v20, v81
    v_mul_f32 v82, v20, v82
    v_mul_f32 v83, v20, v83
    ds_read_b32 v20, v65 offset:4096
    ds_read_b32 v21, v65 offset:4352
    ds_read_b32 v22, v65 offset:4608
    ds_read_b32 v23, v65 offset:4864
    s_waitcnt lgkmcnt(1)
    v_max3_f32 v20, v20, v21, v22
    s_waitcnt lgkmcnt(0)
    v_max_f32 v20, v20, v23
    v_sub_f32 v20, v61, v20
    v_exp_f32 v20, v20
    s_nop 0
    v_mul_f32 v84, v20, v84
    v_mul_f32 v85, v20, v85
    v_mul_f32 v86, v20, v86
    v_mul_f32 v87, v20, v87
    v_mul_f32 v88, v20, v88
    v_mul_f32 v89, v20, v89
    v_mul_f32 v90, v20, v90
    v_mul_f32 v91, v20, v91
    v_mul_f32 v92, v20, v92
    v_mul_f32 v93, v20, v93
    v_mul_f32 v94, v20, v94
    v_mul_f32 v95, v20, v95
    v_mul_f32 v96, v20, v96
    v_mul_f32 v97, v20, v97
    v_mul_f32 v98, v20, v98
    v_mul_f32 v99, v20, v99
    ds_read_b32 v20, v66 offset:4096
    ds_read_b32 v21, v66 offset:4352
    ds_read_b32 v22, v66 offset:4608
    ds_read_b32 v23, v66 offset:4864
    s_waitcnt lgkmcnt(1)
    v_max3_f32 v20, v20, v21, v22
    s_waitcnt lgkmcnt(0)
    v_max_f32 v20, v20, v23
    v_sub_f32 v20, v62, v20
    v_exp_f32 v20, v20
    s_nop 0
    v_mul_f32 v100, v20, v100
    v_mul_f32 v101, v20, v101
    v_mul_f32 v102, v20, v102
    v_mul_f32 v103, v20, v103
    v_mul_f32 v104, v20, v104
    v_mul_f32 v105, v20, v105
    v_mul_f32 v106, v20, v106
    v_mul_f32 v107, v20, v107
    v_mul_f32 v108, v20, v108
    v_mul_f32 v109, v20, v109
    v_mul_f32 v110, v20, v110
    v_mul_f32 v111, v20, v111
    v_mul_f32 v112, v20, v112
    v_mul_f32 v113, v20, v113
    v_mul_f32 v114, v20, v114
    v_mul_f32 v115, v20, v115
    ds_read_b32 v20, v67 offset:4096
    ds_read_b32 v21, v67 offset:4352
    ds_read_b32 v22, v67 offset:4608
    ds_read_b32 v23, v67 offset:4864
    s_waitcnt lgkmcnt(1)
    v_max3_f32 v20, v20, v21, v22
    s_waitcnt lgkmcnt(0)
    v_max_f32 v20, v20, v23
    v_sub_f32 v20, v63, v20
    v_exp_f32 v20, v20
    s_nop 0
    v_mul_f32 v116, v20, v116
    v_mul_f32 v117, v20, v117
    v_mul_f32 v118, v20, v118
    v_mul_f32 v119, v20, v119
    v_mul_f32 v120, v20, v120
    v_mul_f32 v121, v20, v121
    v_mul_f32 v122, v20, v122
    v_mul_f32 v123, v20, v123
    v_mul_f32 v124, v20, v124
    v_mul_f32 v125, v20, v125
    v_mul_f32 v126, v20, v126
    v_mul_f32 v127, v20, v127
    v_mul_f32 v128, v20, v128
    v_mul_f32 v129, v20, v129
    v_mul_f32 v130, v20, v130
    v_mul_f32 v131, v20, v131
    s_barrier
    ds_write_b128 v188, v[84:87] offset:0
    ds_write_b128 v188, v[88:91] offset:1024
    ds_write_b128 v189, v[76:79] offset:0
    ds_write_b128 v189, v[80:83] offset:1024
    ds_write_b128 v190, v[92:95] offset:0
    ds_write_b128 v190, v[96:99] offset:1024
    v_cndmask_b32 v132, v80, v72, s[34:35]
    v_cndmask_b32 v133, v96, v88, s[34:35]
    v_xor_b32 v8, 0x400, v191
    ds_write_b32 v191, v132 offset:4096
    ds_write_b32 v8, v133 offset:4096
    s_waitcnt lgkmcnt(0)
    s_barrier
    v_and_b32 v8, 31, v0
    s_lshl_b32 s70, s69, 10
    s_add_u32 s70, s70, 4224
    v_lshl_add_u32 v8, v8, 2, s70
    ds_read2st64_b32 v[132:133], v8 offset0:0 offset1:1
    ds_read2st64_b32 v[134:135], v8 offset0:2 offset1:3
    v_add_u32 v7, s100, v1
    ds_read_b128 v[84:87], v7 offset:0
    ds_read_b128 v[88:91], v7 offset:1024
    ds_read_b128 v[76:79], v7 offset:2048
    ds_read_b128 v[80:83], v7 offset:3072
    ds_read_b128 v[92:95], v7 offset:4096
    ds_read_b128 v[96:99], v7 offset:5120
    s_waitcnt lgkmcnt(7)
    v_add_f32 v132, v132, v133
    s_waitcnt lgkmcnt(6)
    v_add_f32 v134, v134, v135
    v_add_f32 v132, v132, v134
    v_rcp_f32 v132, v132
    s_waitcnt lgkmcnt(5)
    v_pk_add_f32 v[68:69], v[68:69], v[84:85]
    v_pk_add_f32 v[70:71], v[70:71], v[86:87]
    s_waitcnt lgkmcnt(4)
    v_pk_add_f32 v[72:73], v[72:73], v[88:89]
    v_pk_add_f32 v[74:75], v[74:75], v[90:91]
    s_waitcnt lgkmcnt(3)
    v_pk_add_f32 v[68:69], v[68:69], v[76:77]
    v_pk_add_f32 v[70:71], v[70:71], v[78:79]
    s_waitcnt lgkmcnt(2)
    v_pk_add_f32 v[72:73], v[72:73], v[80:81]
    v_pk_add_f32 v[74:75], v[74:75], v[82:83]
    s_waitcnt lgkmcnt(1)
    v_pk_add_f32 v[68:69], v[68:69], v[92:93]
    v_pk_add_f32 v[70:71], v[70:71], v[94:95]
    s_waitcnt lgkmcnt(0)
    v_pk_add_f32 v[72:73], v[72:73], v[96:97]
    v_pk_add_f32 v[74:75], v[74:75], v[98:99]
    v_pk_mul_f32 v[68:69], v[68:69], v[132:133] op_sel_hi:[1,0]
    v_pk_mul_f32 v[70:71], v[70:71], v[132:133] op_sel_hi:[1,0]
    v_pk_mul_f32 v[72:73], v[72:73], v[132:133] op_sel_hi:[1,0]
    v_pk_mul_f32 v[74:75], v[74:75], v[132:133] op_sel_hi:[1,0]
    v_cvt_pk_bf16_f32 v136, v68, v69
    v_cvt_pk_bf16_f32 v137, v70, v71
    v_cvt_pk_bf16_f32 v138, v72, v73
    v_cvt_pk_bf16_f32 v139, v74, v75
    v_cndmask_b32 v138, v138, v2, s[36:37]
    v_cndmask_b32 v139, v139, v2, s[36:37]
    buffer_store_dwordx4 v[136:139], v1, s[12:15], s85 offen sc1
    v_add_u32 v192, s27, v18
    v_add_u32 v193, s27, v19
    ds_read_b64_tr_b16 v[140:141], v192 offset:12288
    ds_read_b64_tr_b16 v[142:143], v192 offset:13312
    ds_read_b64_tr_b16 v[144:145], v193 offset:12288
    ds_read_b64_tr_b16 v[146:147], v193 offset:13312
    ds_read_b64_tr_b16 v[148:149], v192 offset:14336
    ds_read_b64_tr_b16 v[150:151], v192 offset:15360
    ds_read_b64_tr_b16 v[152:153], v193 offset:14336
    ds_read_b64_tr_b16 v[154:155], v193 offset:15360
    v_add_u32 v192, s28, v18
    v_add_u32 v193, s28, v19
    ds_read_b64_tr_b16 v[156:157], v192 offset:12288
    ds_read_b64_tr_b16 v[158:159], v192 offset:13312
    ds_read_b64_tr_b16 v[160:161], v193 offset:12288
    ds_read_b64_tr_b16 v[162:163], v193 offset:13312
    ds_read_b64_tr_b16 v[164:165], v192 offset:14336
    ds_read_b64_tr_b16 v[166:167], v192 offset:15360
    ds_read_b64_tr_b16 v[168:169], v193 offset:14336
    ds_read_b64_tr_b16 v[170:171], v193 offset:15360
    v_add_u32 v192, s29, v18
    v_add_u32 v193, s29, v19
    ds_read_b64_tr_b16 v[172:173], v192 offset:12288
    ds_read_b64_tr_b16 v[174:175], v192 offset:13312
    ds_read_b64_tr_b16 v[176:177], v193 offset:12288
    ds_read_b64_tr_b16 v[178:179], v193 offset:13312
    ds_read_b64_tr_b16 v[180:181], v192 offset:14336
    ds_read_b64_tr_b16 v[182:183], v192 offset:15360
    ds_read_b64_tr_b16 v[184:185], v193 offset:14336
    ds_read_b64_tr_b16 v[186:187], v193 offset:15360
    v_add_u32 v192, s30, v18
    v_add_u32 v193, s30, v19
    ds_read_b64_tr_b16 a[224:225], v192 offset:12288
    ds_read_b64_tr_b16 a[226:227], v192 offset:13312
    ds_read_b64_tr_b16 a[228:229], v193 offset:12288
    ds_read_b64_tr_b16 a[230:231], v193 offset:13312
    ds_read_b64_tr_b16 a[232:233], v192 offset:14336
    ds_read_b64_tr_b16 a[234:235], v192 offset:15360
    ds_read_b64_tr_b16 a[236:237], v193 offset:14336
    ds_read_b64_tr_b16 a[238:239], v193 offset:15360
    s_waitcnt vmcnt(0) lgkmcnt(0)
    s_branch L_comb2
L_p41_redo:
    s_add_u32 s94, s94, 1
    s_cmp_gt_u32 s94, 131072
    s_cbranch_scc1 L_p41_ok
    s_waitcnt vmcnt(0) lgkmcnt(0)
    s_sleep 2
    s_add_u32 s71, s88, 28672
    buffer_load_dwordx4 v[168:171], v1, s[12:15], s71 offen sc1
    buffer_load_dwordx4 v[172:175], v1, s[12:15], s71 offen offset:1024 sc1
    buffer_load_dwordx4 v[176:179], v1, s[12:15], s71 offen offset:2048 sc1
    buffer_load_dwordx4 v[180:183], v1, s[12:15], s71 offen offset:3072 sc1
    s_add_u32 s71, s88, 32768
    buffer_load_dwordx4 v[184:187], v1, s[12:15], s71 offen sc1
    buffer_load_dwordx4 v[188:191], v1, s[12:15], s71 offen offset:1024 sc1
    buffer_load_dwordx4 v[192:195], v1, s[12:15], s71 offen offset:2048 sc1
    s_waitcnt vmcnt(0)
    ds_write_b128 v252, v[168:171] offset:19456
    ds_write_b128 v252, v[172:175] offset:20480
    ds_write_b128 v252, v[176:179] offset:21504
    ds_write_b128 v252, v[180:183] offset:22528
    ds_write_b128 v252, v[184:187] offset:23552
    ds_write_b128 v252, v[188:191] offset:24576
    ds_write_b128 v252, v[192:195] offset:25600
    v_dot2_f32_bf16 v102, v168, v168, 0
    v_dot2_f32_bf16 v102, v169, v169, v102
    v_dot2_f32_bf16 v102, v170, v170, v102
    v_dot2_f32_bf16 v102, v171, v171, v102
    v_dot2_f32_bf16 v102, v172, v172, v102
    v_dot2_f32_bf16 v102, v173, v173, v102
    v_dot2_f32_bf16 v102, v174, v174, v102
    v_dot2_f32_bf16 v102, v175, v175, v102
    v_dot2_f32_bf16 v102, v176, v176, v102
    v_dot2_f32_bf16 v102, v177, v177, v102
    v_dot2_f32_bf16 v102, v178, v178, v102
    v_dot2_f32_bf16 v102, v179, v179, v102
    v_dot2_f32_bf16 v102, v180, v180, v102
    v_dot2_f32_bf16 v102, v181, v181, v102
    v_dot2_f32_bf16 v102, v182, v182, v102
    v_dot2_f32_bf16 v102, v183, v183, v102
    v_dot2_f32_bf16 v102, v184, v184, v102
    v_dot2_f32_bf16 v102, v185, v185, v102
    v_dot2_f32_bf16 v102, v186, v186, v102
    v_dot2_f32_bf16 v102, v187, v187, v102
    v_dot2_f32_bf16 v102, v188, v188, v102
    v_dot2_f32_bf16 v102, v189, v189, v102
    v_dot2_f32_bf16 v102, v190, v190, v102
    v_dot2_f32_bf16 v102, v191, v191, v102
    v_dot2_f32_bf16 v102, v192, v192, v102
    v_dot2_f32_bf16 v102, v193, v193, v102
    v_dot2_f32_bf16 v102, v194, v194, v102
    v_dot2_f32_bf16 v102, v195, v195, v102
    s_waitcnt vmcnt(0) lgkmcnt(0)
    s_nop 1
    v_cmp_u_f32 vcc, v102, v102
    s_nop 0
    s_cbranch_vccnz L_p41_redo
    s_branch L_p41_ok
L_p5b_redo:
    s_add_u32 s94, s94, 1
    s_cmp_gt_u32 s94, 131072
    s_cbranch_scc1 L_p5b_ok
    s_waitcnt vmcnt(0) lgkmcnt(0)
    s_sleep 2
    s_add_u32 s75, s90, s16
    buffer_load_dwordx4 v[20:23], v254, s[12:15], s75 offen sc1
    buffer_load_dwordx4 v[24:27], v254, s[12:15], s75 offen offset:1024 sc1
    s_add_u32 s75, s90, s17
    buffer_load_dwordx4 v[36:39], v254, s[12:15], s75 offen sc1
    buffer_load_dwordx4 v[40:43], v254, s[12:15], s75 offen offset:1024 sc1
    s_add_u32 s75, s90, s18
    buffer_load_dwordx4 v[52:55], v254, s[12:15], s75 offen sc1
    buffer_load_dwordx4 v[56:59], v254, s[12:15], s75 offen offset:1024 sc1
    s_add_u32 s75, s90, s19
    buffer_load_dwordx4 v[196:199], v254, s[12:15], s75 offen sc1
    buffer_load_dwordx4 v[200:203], v254, s[12:15], s75 offen offset:1024 sc1
    s_add_u32 s75, s90, s20
    buffer_load_dwordx4 v[212:215], v254, s[12:15], s75 offen sc1
    buffer_load_dwordx4 v[216:219], v254, s[12:15], s75 offen offset:1024 sc1
    s_add_u32 s75, s90, s21
    buffer_load_dwordx4 v[228:231], v254, s[12:15], s75 offen sc1
    buffer_load_dwordx4 v[232:235], v254, s[12:15], s75 offen offset:1024 sc1
    s_add_u32 s75, s90, s22
    buffer_load_dwordx4 v[68:71], v254, s[12:15], s75 offen sc1
    buffer_load_dwordx4 v[72:75], v254, s[12:15], s75 offen offset:1024 sc1
    s_add_u32 s75, s90, s16
    buffer_load_dwordx4 v[28:31], v254, s[12:15], s75 offen offset:2048 sc1
    buffer_load_dwordx4 v[32:35], v254, s[12:15], s75 offen offset:3072 sc1
    s_add_u32 s75, s90, s17
    buffer_load_dwordx4 v[44:47], v254, s[12:15], s75 offen offset:2048 sc1
    buffer_load_dwordx4 v[48:51], v254, s[12:15], s75 offen offset:3072 sc1
    s_add_u32 s75, s90, s18
    buffer_load_dwordx4 v[60:63], v254, s[12:15], s75 offen offset:2048 sc1
    buffer_load_dwordx4 v[64:67], v254, s[12:15], s75 offen offset:3072 sc1
    s_add_u32 s75, s90, s19
    buffer_load_dwordx4 v[204:207], v254, s[12:15], s75 offen offset:2048 sc1
    buffer_load_dwordx4 v[208:211], v254, s[12:15], s75 offen offset:3072 sc1
    s_add_u32 s75, s90, s20
    buffer_load_dwordx4 v[220:223], v254, s[12:15], s75 offen offset:2048 sc1
    buffer_load_dwordx4 v[224:227], v254, s[12:15], s75 offen offset:3072 sc1
    s_add_u32 s75, s90, s21
    buffer_load_dwordx4 v[236:239], v254, s[12:15], s75 offen offset:2048 sc1
    buffer_load_dwordx4 v[240:243], v254, s[12:15], s75 offen offset:3072 sc1
    s_add_u32 s75, s90, s22
    buffer_load_dwordx4 v[76:79], v254, s[12:15], s75 offen offset:2048 sc1
    buffer_load_dwordx4 v[80:83], v254, s[12:15], s75 offen offset:3072 sc1
    s_waitcnt vmcnt(0)
    v_mfma_f32_32x32x16_bf16 a[192:207], a[112:115], v[20:23], 0
    v_mfma_f32_32x32x16_bf16 a[208:223], a[116:119], v[20:23], 0
    v_mfma_f32_32x32x16_bf16 a[192:207], a[120:123], v[24:27], a[192:207]
    v_mfma_f32_32x32x16_bf16 a[208:223], a[124:127], v[24:27], a[208:223]
    v_mfma_f32_32x32x16_bf16 a[192:207], a[144:147], v[36:39], a[192:207]
    v_mfma_f32_32x32x16_bf16 a[208:223], a[148:151], v[36:39], a[208:223]
    v_mfma_f32_32x32x16_bf16 a[192:207], a[152:155], v[40:43], a[192:207]
    v_mfma_f32_32x32x16_bf16 a[208:223], a[156:159], v[40:43], a[208:223]
    v_mfma_f32_32x32x16_bf16 a[192:207], a[240:243], v[52:55], a[192:207]
    v_mfma_f32_32x32x16_bf16 a[208:223], a[244:247], v[52:55], a[208:223]
    v_mfma_f32_32x32x16_bf16 a[192:207], a[248:251], v[56:59], a[192:207]
    v_mfma_f32_32x32x16_bf16 a[208:223], a[252:255], v[56:59], a[208:223]
    v_mfma_f32_32x32x16_bf16 a[192:207], v[156:159], v[196:199], a[192:207]
    v_mfma_f32_32x32x16_bf16 a[208:223], v[160:163], v[196:199], a[208:223]
    v_mfma_f32_32x32x16_bf16 a[192:207], v[164:167], v[200:203], a[192:207]
    v_mfma_f32_32x32x16_bf16 a[208:223], v[168:171], v[200:203], a[208:223]
    v_mfma_f32_32x32x16_bf16 a[192:207], v[188:191], v[212:215], a[192:207]
    v_mfma_f32_32x32x16_bf16 a[208:223], v[192:195], v[212:215], a[208:223]
    v_mfma_f32_32x32x16_bf16 a[192:207], a[0:3], v[216:219], a[192:207]
    v_mfma_f32_32x32x16_bf16 a[208:223], a[4:7], v[216:219], a[208:223]
    v_mfma_f32_32x32x16_bf16 a[192:207], a[24:27], v[228:231], a[192:207]
    v_mfma_f32_32x32x16_bf16 a[208:223], a[28:31], v[228:231], a[208:223]
    v_mfma_f32_32x32x16_bf16 a[192:207], a[32:35], v[232:235], a[192:207]
    v_mfma_f32_32x32x16_bf16 a[208:223], a[36:39], v[232:235], a[208:223]
    v_mfma_f32_32x32x16_bf16 a[192:207], a[56:59], v[68:71], a[192:207]
    v_mfma_f32_32x32x16_bf16 a[208:223], a[60:63], v[68:71], a[208:223]
    v_mfma_f32_32x32x16_bf16 a[192:207], a[64:67], v[72:75], a[192:207]
    v_mfma_f32_32x32x16_bf16 a[208:223], a[68:71], v[72:75], a[208:223]
    v_mfma_f32_32x32x16_bf16 a[192:207], a[128:131], v[28:31], a[192:207]
    v_mfma_f32_32x32x16_bf16 a[208:223], a[132:135], v[28:31], a[208:223]
    v_mfma_f32_32x32x16_bf16 a[192:207], a[136:139], v[32:35], a[192:207]
    v_mfma_f32_32x32x16_bf16 a[208:223], a[140:143], v[32:35], a[208:223]
    v_mfma_f32_32x32x16_bf16 a[192:207], a[224:227], v[44:47], a[192:207]
    v_mfma_f32_32x32x16_bf16 a[208:223], a[228:231], v[44:47], a[208:223]
    v_mfma_f32_32x32x16_bf16 a[192:207], a[232:235], v[48:51], a[192:207]
    v_mfma_f32_32x32x16_bf16 a[208:223], a[236:239], v[48:51], a[208:223]
    v_mfma_f32_32x32x16_bf16 a[192:207], v[140:143], v[60:63], a[192:207]
    v_mfma_f32_32x32x16_bf16 a[208:223], v[144:147], v[60:63], a[208:223]
    v_mfma_f32_32x32x16_bf16 a[192:207], v[148:151], v[64:67], a[192:207]
    v_mfma_f32_32x32x16_bf16 a[208:223], v[152:155], v[64:67], a[208:223]
    v_mfma_f32_32x32x16_bf16 a[192:207], v[172:175], v[204:207], a[192:207]
    v_mfma_f32_32x32x16_bf16 a[208:223], v[176:179], v[204:207], a[208:223]
    v_mfma_f32_32x32x16_bf16 a[192:207], v[180:183], v[208:211], a[192:207]
    v_mfma_f32_32x32x16_bf16 a[208:223], v[184:187], v[208:211], a[208:223]
    v_mfma_f32_32x32x16_bf16 a[192:207], a[8:11], v[220:223], a[192:207]
    v_mfma_f32_32x32x16_bf16 a[208:223], a[12:15], v[220:223], a[208:223]
    v_mfma_f32_32x32x16_bf16 a[192:207], a[16:19], v[224:227], a[192:207]
    v_mfma_f32_32x32x16_bf16 a[208:223], a[20:23], v[224:227], a[208:223]
    v_mfma_f32_32x32x16_bf16 a[192:207], a[40:43], v[236:239], a[192:207]
    v_mfma_f32_32x32x16_bf16 a[208:223], a[44:47], v[236:239], a[208:223]
    v_mfma_f32_32x32x16_bf16 a[192:207], a[48:51], v[240:243], a[192:207]
    v_mfma_f32_32x32x16_bf16 a[208:223], a[52:55], v[240:243], a[208:223]
    v_mfma_f32_32x32x16_bf16 a[192:207], a[72:75], v[76:79], a[192:207]
    v_mfma_f32_32x32x16_bf16 a[208:223], a[76:79], v[76:79], a[208:223]
    v_mfma_f32_32x32x16_bf16 a[192:207], a[80:83], v[80:83], a[192:207]
    v_mfma_f32_32x32x16_bf16 a[208:223], a[84:87], v[80:83], a[208:223]
    s_nop 10
    v_accvgpr_read_b32 v116, a192
    s_waitcnt vmcnt(0) lgkmcnt(0)
    v_cmp_u_f32 vcc, v116, v116
    s_nop 0
    s_cbranch_vccnz L_p5b_redo
    s_branch L_p5b_ok
L_code_end:

.section .rodata,"a"
.p2align 6
.amdhsa_kernel sequential_preLN__grouped_kv_mqa__dense_activation_gelu__prompt_kernel
  .amdhsa_next_free_vgpr 512
  .amdhsa_next_free_sgpr 102
  .amdhsa_accum_offset 256
  .amdhsa_group_segment_fixed_size 0
  .amdhsa_kernarg_size 104
  .amdhsa_user_sgpr_count 2
  .amdhsa_user_sgpr_kernarg_segment_ptr 1
  .amdhsa_system_sgpr_workgroup_id_x 1
  .amdhsa_float_denorm_mode_32 3
.end_amdhsa_kernel
```
